```python
import torch

def _softmax(x, axis=-1):
    return torch.softmax(x, dim=axis)

def _gelu(x):
    return torch.nn.functional.gelu(x, approximate='tanh')

def _silu(x):
    return torch.nn.functional.silu(x)

def _sigmoid(x):
    return torch.sigmoid(x)

def _layernorm(x, axis=-1, eps=1e-05):
    m = x.mean(dim=axis, keepdim=True)
    v = x.var(dim=axis, keepdim=True, unbiased=False)
    return (x - m) / torch.sqrt(v + eps)

def _scatter_add(tgt, idx, src, axis=0):
    return tgt.clone().index_add_(axis, idx, src)

def _segment_sum(src, seg, n):
    out = torch.zeros((n,) + src.shape[1:], dtype=src.dtype)
    return out.index_add_(0, seg, src)

def _pad(x, pw):
    flat = tuple((v for pair in reversed(pw) for v in pair))
    return torch.nn.functional.pad(x, flat)
kernel_name = 'adaLN_cond__mha_block__dense_activation_relu__prompt'

def setup_inputs():

    _w = lambda a: (lambda t: t.to(torch.bfloat16) if t.is_floating_point() else t)(torch.as_tensor(a))

    def _A_setup():
        B, S, D, H = (1, 2048, 512, 32)
        return {'x': _w((lambda *s: torch.randn(*s, dtype=torch.bfloat16) * 0.05)(B, S, D)), 'wqkv': _w((lambda *s: torch.randn(*s, dtype=torch.bfloat16) * 0.05)(D, 3 * D)), 'wo': _w((lambda *s: torch.randn(*s, dtype=torch.bfloat16) * 0.05)(D, D))}
    _A_in = _A_setup()

    def _B_setup():
        B, S, D, Dff = (1, 2048, 512, 1792)
        return {'x': _w((lambda *s: torch.randn(*s, dtype=torch.bfloat16) * 0.05)(B, S, D)), 'w1': _w((lambda *s: torch.randn(*s, dtype=torch.bfloat16) * 0.05)(D, Dff)), 'w2': _w((lambda *s: torch.randn(*s, dtype=torch.bfloat16) * 0.05)(Dff, D))}
    _B_in = _B_setup()
    return {'A_x': _A_in['x'], 'A_wqkv': _A_in['wqkv'], 'A_wo': _A_in['wo'], 'B_x': _B_in['x'], 'B_w1': _B_in['w1'], 'B_w2': _B_in['w2'], 'c': _w((lambda *s: torch.randn(*s, dtype=torch.bfloat16) * 0.1)(1, 512) * 8.0), 'w_mod': _w((lambda *s: torch.randn(*s, dtype=torch.bfloat16) * 0.1)(512, 6 * 512) * 512 ** (-0.5) * 8.0)}

def reference(A_x, A_wqkv, A_wo, B_x, B_w1, B_w2, c, w_mod):

    def _A_ref(x, wqkv, wo):
        B, S, D = x.shape
        H = 32
        Dh = D // H
        qkv = (lambda x, *d: x.permute(*d))((x @ wqkv).reshape(B, S, 3, H, Dh), 2, 0, 3, 1, 4)
        q, k, v = (qkv[0], qkv[1], qkv[2])
        scores = torch.einsum('bhqd,bhkd->bhqk', q, k) * Dh ** (-0.5)
        p = _softmax(scores, axis=-1)
        o = torch.einsum('bhqk,bhkd->bhqd', p, v)
        return (lambda x, *d: x.permute(*d))(o, 0, 2, 1, 3).reshape(B, S, D) @ wo

    def _B_ref(x, w1, w2):
        h = torch.einsum('bsd,df->bsf', x, w1)
        zero = torch.zeros_like(h)
        h = torch.maximum(h, zero)
        return torch.einsum('bsf,fd->bsd', h, w2)
    x = A_x
    mod = (_silu(c) @ w_mod).reshape(c.shape[0], 6, 1, -1)
    sa, ca, ga, sb, cb, gb = (mod[:, 0].clone(), mod[:, 1].clone(), mod[:, 2].clone(), mod[:, 3].clone(), mod[:, 4].clone(), mod[:, 5].clone())
    h = _layernorm(x, axis=-1) * (1 + ca) + sa
    x = x + ga * _A_ref(h, A_wqkv, A_wo)
    h = _layernorm(x, axis=-1) * (1 + cb) + sb
    x = x + gb * _B_ref(h, B_w1, B_w2)
    return x
```

```asm
; @launch grid=(256,1,1) block=(256,1,1) lds=163840
.amdgcn_target "amdgcn-amd-amdhsa--gfx950"
.text
.globl adaLN_cond__mha_block__dense_activation_relu__prompt_kernel
.p2align 8
.type adaLN_cond__mha_block__dense_activation_relu__prompt_kernel,@function
adaLN_cond__mha_block__dense_activation_relu__prompt_kernel:
    s_cmp_ge_u32 s2, 256
    s_cbranch_scc1 L_end_adaLN_cond__mha_block__dense_activation_relu__prompt_kernel
    s_load_dwordx16 s[4:19], s[0:1], 0
    s_load_dwordx4 s[20:23], s[0:1], 64
    s_load_dwordx2 s[24:25], s[0:1], 80
    v_lshrrev_b32 v2, 6, v0
    v_and_b32 v1, 63, v0
    v_readfirstlane_b32 s3, v2
    s_and_b32 s36, s2, 7
    s_lshr_b32 s37, s2, 3
    v_lshlrev_b32 v2, 4, v1
    s_getpc_b64 s[38:39]
L_pc_here:
    s_lshl_b32 s98, s37, 2
    s_add_u32 s98, s98, s3
    s_and_b32 s98, s98, 63
    s_lshl_b32 s98, s98, 10
    s_add_u32 s38, s38, s98
    s_addc_u32 s39, s39, 0
    global_load_dwordx4 a[208:211], v2, s[38:39]
    s_memrealtime s[40:41]
    v_lshrrev_b32 v3, 1, v1
    v_lshlrev_b32 v4, 1, v3
    v_mul_u32_u24 v3, 6144, v3
    v_and_b32 v5, 1, v1
    v_lshl_add_u32 v3, v5, 4, v3
    v_lshrrev_b32 v6, 3, v1
    v_and_b32 v7, 7, v1
    v_and_b32 v248, 2, v6
    v_xor_b32 v7, v7, v248
    s_and_b32 s38, s3, 1
    s_lshl_b32 s38, s38, 2
    v_xor_b32 v7, s38, v7
    v_mul_u32_u24 v5, 3072, v6
    v_lshl_add_u32 v5, v7, 4, v5
    s_and_b32 s93, s37, 7
    s_lshl_b32 s93, s93, 1
    s_lshr_b32 s99, s37, 4
    s_lshl_b32 s99, s99, 3
    s_add_u32 s99, s99, s36
    s_lshl_b32 s99, s99, 2
    s_and_b32 s38, s37, 3
    s_add_u32 s99, s99, s38
    s_bfe_u32 s92, s37, 0x20002
    s_lshl_b32 s100, s92, 2
    s_add_u32 s100, s100, s3
    s_lshl_b32 s101, s100, 6
    s_mul_i32 s100, s100, 196608
    s_lshl_b32 s38, s99, 5
    s_add_u32 s100, s100, s38
    s_lshl_b32 s39, s2, 2
    s_add_u32 s39, s39, s3
    v_lshlrev_b32 v248, 6, v1
    s_waitcnt lgkmcnt(0)
    s_mov_b32 s26, 0x1b14000
    s_mov_b32 s27, 0x00020000
    s_mov_b32 s48, s22
    s_mov_b32 s49, s23
    s_mov_b32 s50, 0x100
    s_mov_b32 s51, 0x00020000
    s_cmp_lg_u32 s39, 3
    s_cbranch_scc1 L_nozw
    s_mul_i32 s41, s41, 0x9e3779b1
    s_xor_b32 s40, s40, s41
    s_or_b32 s40, s40, 1
    v_mov_b32 v249, s40
    s_mov_b64 exec, 15
    buffer_store_dword v249, v248, s[48:51], 0 offen sc1
    s_mov_b64 exec, -1
L_nozw:
    s_mov_b32 s44, s18
    s_mov_b32 s45, s19
    s_mov_b32 s46, 0x300000
    s_mov_b32 s47, 0x00020000
    s_mov_b32 s56, s16
    s_mov_b32 s57, s17
    s_mov_b32 s58, 0x400
    s_mov_b32 s59, 0x00020000
    s_mov_b32 s28, s4
    s_mov_b32 s29, s5
    s_mov_b32 s30, 0x200000
    s_mov_b32 s31, 0x00020000
    buffer_load_ushort v12, v4, s[56:59], s101 offen
    buffer_load_dwordx4 v[8:11], v3, s[44:47], s100 offen
    s_mov_b32 s32, s20
    s_mov_b32 s33, s21
    s_mov_b32 s34, 0x200000
    s_mov_b32 s35, 0x00020000
    s_lshr_b32 s20, s36, 1
    s_lshl_b32 s20, s20, 3
    s_and_b32 s38, s37, 7
    s_add_u32 s20, s20, s38
    s_and_b32 s21, s36, 1
    s_lshl_b32 s21, s21, 2
    s_lshr_b32 s101, s37, 3
    s_add_u32 s21, s21, s101
    s_lshl_b32 s22, s21, 2
    s_add_u32 s22, s22, s3
    s_lshl_b32 s38, s20, 16
    s_lshl_b32 s23, s3, 14
    s_add_u32 s38, s38, s23
    s_mov_b32 s16, s38
    s_xor_b32 s17, s101, 0
    s_lshl_b32 s17, s17, 12
    s_add_u32 s17, s17, s16
    buffer_load_dwordx4 v[24:27], v2, s[28:31], s17 offen offset:0
    buffer_load_dwordx4 v[28:31], v2, s[28:31], s17 offen offset:1024
    buffer_load_dwordx4 v[32:35], v2, s[28:31], s17 offen offset:2048
    buffer_load_dwordx4 v[36:39], v2, s[28:31], s17 offen offset:3072
    s_xor_b32 s17, s101, 1
    s_lshl_b32 s17, s17, 12
    s_add_u32 s17, s17, s16
    buffer_load_dwordx4 v[40:43], v2, s[28:31], s17 offen offset:0
    buffer_load_dwordx4 v[44:47], v2, s[28:31], s17 offen offset:1024
    buffer_load_dwordx4 v[48:51], v2, s[28:31], s17 offen offset:2048
    buffer_load_dwordx4 v[52:55], v2, s[28:31], s17 offen offset:3072
    s_mov_b32 s40, s6
    s_mov_b32 s41, s7
    s_mov_b32 s42, 0x180000
    s_mov_b32 s43, 0x00020000
    s_cmp_lt_u32 s2, 32
    s_cselect_b32 s52, s8, s12
    s_cselect_b32 s53, s9, s13
    s_mov_b32 s54, 0x1c0000
    s_cselect_b32 s54, 0x80000, s54
    s_cmp_ge_u32 s2, 144
    s_cselect_b32 s52, s14, s52
    s_cselect_b32 s53, s15, s53
    s_mov_b32 s55, 0x00020000
    s_lshl_b32 s23, s21, 7
    s_mul_i32 s38, s3, 24576
    s_add_u32 s23, s23, s38
    s_mul_i32 s100, s3, 3072
    s_cmp_lt_u32 s2, 32
    s_cselect_b32 s4, 0, 32
    s_cselect_b32 s5, 0, 1
    s_cmp_ge_u32 s2, 144
    s_cselect_b32 s4, 144, s4
    s_cselect_b32 s5, 2, s5
    s_sub_u32 s4, s2, s4
    s_lshr_b32 s6, s4, 3
    s_and_b32 s7, s4, 7
    s_mul_i32 s9, s4, 2341
    s_lshr_b32 s9, s9, 16
    s_mul_i32 s10, s9, 28
    s_sub_u32 s10, s4, s10
    s_mov_b32 s8, 1024
    s_cmp_eq_u32 s5, 1
    s_cselect_b32 s6, s9, s6
    s_cselect_b32 s7, s10, s7
    s_cselect_b32 s8, 3584, s8
    s_lshl_b32 s9, s6, 2
    s_add_u32 s9, s9, s3
    s_lshl_b32 s12, s8, 5
    s_mul_i32 s12, s12, s9
    s_lshl_b32 s11, s7, 7
    s_add_u32 s12, s12, s11
    s_lshl_b32 s1, s8, 3
    v_lshrrev_b32 v248, 3, v1
    v_mul_lo_u32 v248, v248, s8
    v_and_b32 v249, 7, v1
    v_lshl_add_u32 v248, v249, 4, v248
    v_add_u32 v248, s12, v248
    v_accvgpr_write_b32 a212, v248
    s_lshl_b32 s0, s3, 16
    s_lshl_b32 s4, s2, 8
    s_add_u32 s0, s0, s4
    s_add_u32 s0, s0, 28114944
    s_waitcnt vmcnt(8)
    v_lshlrev_b32 v12, 16, v12
    v_mul_f32 v13, 0xbfb8aa3b, v12
    v_exp_f32 v13, v13
    s_nop 0
    v_add_f32 v13, 1.0, v13
    v_rcp_f32 v13, v13
    s_nop 0
    v_mul_f32 v12, v12, v13
    v_cvt_pk_bf16_f32 v12, v12, v12
    v_and_b32 v12, 0xffff0000, v12
    s_xor_b32 s17, s101, 2
    s_lshl_b32 s17, s17, 12
    s_add_u32 s17, s17, s16
    buffer_load_dwordx4 v[56:59], v2, s[28:31], s17 offen offset:0
    v_lshlrev_b32 v16, 16, v8
    v_and_b32 v17, 0xffff0000, v8
    v_lshlrev_b32 v18, 16, v9
    v_and_b32 v19, 0xffff0000, v9
    v_lshlrev_b32 v20, 16, v10
    v_and_b32 v21, 0xffff0000, v10
    v_lshlrev_b32 v22, 16, v11
    v_and_b32 v23, 0xffff0000, v11
    v_pk_mul_f32 v[16:17], v[16:17], v[12:13] op_sel_hi:[1,0]
    v_pk_mul_f32 v[18:19], v[18:19], v[12:13] op_sel_hi:[1,0]
    buffer_load_dwordx4 v[60:63], v2, s[28:31], s17 offen offset:1024
    v_pk_mul_f32 v[20:21], v[20:21], v[12:13] op_sel_hi:[1,0]
    v_pk_mul_f32 v[22:23], v[22:23], v[12:13] op_sel_hi:[1,0]
    s_nop 0
    v_permlane32_swap_b32 v16, v20
    v_permlane32_swap_b32 v17, v21
    v_permlane32_swap_b32 v18, v22
    v_permlane32_swap_b32 v19, v23
    v_pk_add_f32 v[16:17], v[16:17], v[20:21]
    v_pk_add_f32 v[18:19], v[18:19], v[22:23]
    v_lshrrev_b32 v12, 4, v1
    buffer_load_dwordx4 v[64:67], v2, s[28:31], s17 offen offset:2048
    v_and_b32 v13, 1, v1
    v_permlane16_swap_b32 v16, v18
    v_permlane16_swap_b32 v17, v19
    v_pk_add_f32 v[16:17], v[16:17], v[18:19]
    v_lshlrev_b32 v12, 3, v12
    v_lshl_add_u32 v12, v13, 5, v12
    v_add_f32_dpp v16, v16, v16 row_ror:8 row_mask:0xf bank_mask:0xf
    v_add_f32_dpp v17, v17, v17 row_ror:8 row_mask:0xf bank_mask:0xf
    s_lshl_b32 s38, s3, 6
    v_add_f32_dpp v16, v16, v16 row_ror:4 row_mask:0xf bank_mask:0xf
    buffer_load_dwordx4 v[68:71], v2, s[28:31], s17 offen offset:3072
    v_add_f32_dpp v17, v17, v17 row_ror:4 row_mask:0xf bank_mask:0xf
    v_add_u32 v12, s38, v12
    v_add_f32_dpp v16, v16, v16 row_ror:2 row_mask:0xf bank_mask:0xf
    v_add_f32_dpp v17, v17, v17 row_ror:2 row_mask:0xf bank_mask:0xf
    v_add_u32 v12, 0, v12
    ds_write_b64 v12, v[16:17] offset:49152
    s_waitcnt vmcnt(11)
    v_lshlrev_b32 v88, 16, v24
    v_and_b32 v89, 0xffff0000, v24
    v_lshlrev_b32 v90, 16, v25
    v_and_b32 v91, 0xffff0000, v25
    v_lshlrev_b32 v92, 16, v26
    v_and_b32 v93, 0xffff0000, v26
    v_lshlrev_b32 v94, 16, v27
    v_and_b32 v95, 0xffff0000, v27
    v_pk_add_f32 v[248:249], v[88:89], v[90:91]
    v_pk_mul_f32 v[250:251], v[88:89], v[88:89]
    v_pk_add_f32 v[252:253], v[92:93], v[94:95]
    v_pk_fma_f32 v[250:251], v[90:91], v[90:91], v[250:251]
    s_xor_b32 s17, s101, 3
    s_lshl_b32 s17, s17, 12
    s_add_u32 s17, s17, s16
    buffer_load_dwordx4 v[72:75], v2, s[28:31], s17 offen offset:0
    v_pk_fma_f32 v[250:251], v[92:93], v[92:93], v[250:251]
    v_pk_fma_f32 v[250:251], v[94:95], v[94:95], v[250:251]
    v_pk_add_f32 v[248:249], v[248:249], v[252:253]
    v_add_f32 v232, v250, v251
    v_add_f32 v216, v248, v249
    s_waitcnt vmcnt(11)
    v_lshlrev_b32 v96, 16, v28
    v_and_b32 v97, 0xffff0000, v28
    v_lshlrev_b32 v98, 16, v29
    v_and_b32 v99, 0xffff0000, v29
    v_lshlrev_b32 v100, 16, v30
    v_and_b32 v101, 0xffff0000, v30
    v_lshlrev_b32 v102, 16, v31
    v_and_b32 v103, 0xffff0000, v31
    v_pk_add_f32 v[248:249], v[96:97], v[98:99]
    v_pk_mul_f32 v[250:251], v[96:97], v[96:97]
    v_pk_add_f32 v[252:253], v[100:101], v[102:103]
    v_pk_fma_f32 v[250:251], v[98:99], v[98:99], v[250:251]
    buffer_load_dwordx4 v[76:79], v2, s[28:31], s17 offen offset:1024
    v_pk_fma_f32 v[250:251], v[100:101], v[100:101], v[250:251]
    v_pk_fma_f32 v[250:251], v[102:103], v[102:103], v[250:251]
    v_pk_add_f32 v[248:249], v[248:249], v[252:253]
    v_add_f32 v233, v250, v251
    v_add_f32 v217, v248, v249
    s_waitcnt lgkmcnt(0)
    s_load_dword s98, s[48:49], 0
    s_waitcnt vmcnt(11)
    v_lshlrev_b32 v104, 16, v32
    v_and_b32 v105, 0xffff0000, v32
    v_lshlrev_b32 v106, 16, v33
    v_and_b32 v107, 0xffff0000, v33
    v_lshlrev_b32 v108, 16, v34
    v_and_b32 v109, 0xffff0000, v34
    v_lshlrev_b32 v110, 16, v35
    v_and_b32 v111, 0xffff0000, v35
    v_pk_add_f32 v[248:249], v[104:105], v[106:107]
    v_pk_mul_f32 v[250:251], v[104:105], v[104:105]
    v_pk_add_f32 v[252:253], v[108:109], v[110:111]
    v_pk_fma_f32 v[250:251], v[106:107], v[106:107], v[250:251]
    buffer_load_dwordx4 v[80:83], v2, s[28:31], s17 offen offset:2048
    v_pk_fma_f32 v[250:251], v[108:109], v[108:109], v[250:251]
    v_pk_fma_f32 v[250:251], v[110:111], v[110:111], v[250:251]
    v_pk_add_f32 v[248:249], v[248:249], v[252:253]
    v_add_f32 v234, v250, v251
    v_add_f32 v218, v248, v249
    s_waitcnt vmcnt(11)
    v_lshlrev_b32 v112, 16, v36
    v_and_b32 v113, 0xffff0000, v36
    v_lshlrev_b32 v114, 16, v37
    v_and_b32 v115, 0xffff0000, v37
    v_lshlrev_b32 v116, 16, v38
    v_and_b32 v117, 0xffff0000, v38
    v_lshlrev_b32 v118, 16, v39
    v_and_b32 v119, 0xffff0000, v39
    v_pk_add_f32 v[248:249], v[112:113], v[114:115]
    v_pk_mul_f32 v[250:251], v[112:113], v[112:113]
    v_pk_add_f32 v[252:253], v[116:117], v[118:119]
    v_pk_fma_f32 v[250:251], v[114:115], v[114:115], v[250:251]
    buffer_load_dwordx4 v[84:87], v2, s[28:31], s17 offen offset:3072
    v_pk_fma_f32 v[250:251], v[116:117], v[116:117], v[250:251]
    v_pk_fma_f32 v[250:251], v[118:119], v[118:119], v[250:251]
    v_pk_add_f32 v[248:249], v[248:249], v[252:253]
    v_add_f32 v235, v250, v251
    v_add_f32 v219, v248, v249
    v_lshlrev_b32 v12, 2, v1
    s_waitcnt lgkmcnt(0)
    s_barrier
    ds_read_b32 v16, v12 offset:49152
    s_cmp_eq_u32 s98, 0
    s_cbranch_scc1 L_zspin
L_zpoll_out:
    s_cmp_lg_u32 s3, 0
    s_cbranch_scc1 L_mod_done
    s_lshl_b32 s38, s92, 13
    s_lshl_b32 s4, s99, 7
    s_add_u32 s38, s38, s4
    s_add_u32 s38, s38, 32768
    v_lshlrev_b32 v12, 3, v1
    s_waitcnt lgkmcnt(0)
    v_mov_b32 v17, v16
    s_nop 1
    v_permlane32_swap_b32 v17, v16
    v_add_f32 v16, v17, v16
    v_mov_b32 v17, v16
    s_nop 1
    v_permlane16_swap_b32 v17, v16
    v_add_f32 v16, v17, v16
    v_mov_b32 v17, s98
    s_mov_b64 exec, 0xffff
    buffer_store_dwordx2 v[16:17], v12, s[24:27], s38 offen sc1
    s_mov_b64 exec, -1
L_mod_done:
    s_waitcnt vmcnt(11)
    v_lshlrev_b32 v120, 16, v40
    v_and_b32 v121, 0xffff0000, v40
    v_lshlrev_b32 v122, 16, v41
    v_and_b32 v123, 0xffff0000, v41
    v_lshlrev_b32 v124, 16, v42
    v_and_b32 v125, 0xffff0000, v42
    v_lshlrev_b32 v126, 16, v43
    v_and_b32 v127, 0xffff0000, v43
    v_pk_add_f32 v[248:249], v[120:121], v[122:123]
    v_pk_mul_f32 v[250:251], v[120:121], v[120:121]
    v_pk_add_f32 v[252:253], v[124:125], v[126:127]
    v_pk_fma_f32 v[250:251], v[122:123], v[122:123], v[250:251]
    s_xor_b32 s39, s93, 0
    s_mul_i32 s39, s39, 98304
    s_add_u32 m0, s100, 65536
    s_add_u32 s39, s39, s23
    buffer_load_dwordx4 v5, s[40:43], s39 offen offset:0 lds
    v_pk_fma_f32 v[250:251], v[124:125], v[124:125], v[250:251]
    v_pk_fma_f32 v[250:251], v[126:127], v[126:127], v[250:251]
    v_pk_add_f32 v[248:249], v[248:249], v[252:253]
    v_add_f32 v236, v250, v251
    v_add_f32 v220, v248, v249
    s_waitcnt vmcnt(11)
    v_lshlrev_b32 v128, 16, v44
    v_and_b32 v129, 0xffff0000, v44
    v_lshlrev_b32 v130, 16, v45
    v_and_b32 v131, 0xffff0000, v45
    v_lshlrev_b32 v132, 16, v46
    v_and_b32 v133, 0xffff0000, v46
    v_lshlrev_b32 v134, 16, v47
    v_and_b32 v135, 0xffff0000, v47
    v_pk_add_f32 v[248:249], v[128:129], v[130:131]
    v_pk_mul_f32 v[250:251], v[128:129], v[128:129]
    v_pk_add_f32 v[252:253], v[132:133], v[134:135]
    v_pk_fma_f32 v[250:251], v[130:131], v[130:131], v[250:251]
    buffer_load_dwordx4 v5, s[40:43], s39 offen offset:1024 lds
    v_pk_fma_f32 v[250:251], v[132:133], v[132:133], v[250:251]
    v_pk_fma_f32 v[250:251], v[134:135], v[134:135], v[250:251]
    v_pk_add_f32 v[248:249], v[248:249], v[252:253]
    v_add_f32 v237, v250, v251
    v_add_f32 v221, v248, v249
    s_waitcnt vmcnt(11)
    v_lshlrev_b32 v136, 16, v48
    v_and_b32 v137, 0xffff0000, v48
    v_lshlrev_b32 v138, 16, v49
    v_and_b32 v139, 0xffff0000, v49
    v_lshlrev_b32 v140, 16, v50
    v_and_b32 v141, 0xffff0000, v50
    v_lshlrev_b32 v142, 16, v51
    v_and_b32 v143, 0xffff0000, v51
    v_pk_add_f32 v[248:249], v[136:137], v[138:139]
    v_pk_mul_f32 v[250:251], v[136:137], v[136:137]
    v_pk_add_f32 v[252:253], v[140:141], v[142:143]
    v_pk_fma_f32 v[250:251], v[138:139], v[138:139], v[250:251]
    buffer_load_dwordx4 v5, s[40:43], s39 offen offset:2048 lds
    v_pk_fma_f32 v[250:251], v[140:141], v[140:141], v[250:251]
    v_pk_fma_f32 v[250:251], v[142:143], v[142:143], v[250:251]
    v_pk_add_f32 v[248:249], v[248:249], v[252:253]
    v_add_f32 v238, v250, v251
    v_add_f32 v222, v248, v249
    s_waitcnt vmcnt(11)
    v_lshlrev_b32 v144, 16, v52
    v_and_b32 v145, 0xffff0000, v52
    v_lshlrev_b32 v146, 16, v53
    v_and_b32 v147, 0xffff0000, v53
    v_lshlrev_b32 v148, 16, v54
    v_and_b32 v149, 0xffff0000, v54
    v_lshlrev_b32 v150, 16, v55
    v_and_b32 v151, 0xffff0000, v55
    v_pk_add_f32 v[248:249], v[144:145], v[146:147]
    v_pk_mul_f32 v[250:251], v[144:145], v[144:145]
    v_pk_add_f32 v[252:253], v[148:149], v[150:151]
    v_pk_fma_f32 v[250:251], v[146:147], v[146:147], v[250:251]
    s_xor_b32 s39, s93, 1
    s_mul_i32 s39, s39, 98304
    s_add_u32 m0, s100, 77824
    s_add_u32 s39, s39, s23
    buffer_load_dwordx4 v5, s[40:43], s39 offen offset:0 lds
    v_pk_fma_f32 v[250:251], v[148:149], v[148:149], v[250:251]
    v_pk_fma_f32 v[250:251], v[150:151], v[150:151], v[250:251]
    v_pk_add_f32 v[248:249], v[248:249], v[252:253]
    v_add_f32 v239, v250, v251
    v_add_f32 v223, v248, v249
    s_waitcnt vmcnt(11)
    v_lshlrev_b32 v152, 16, v56
    v_and_b32 v153, 0xffff0000, v56
    v_lshlrev_b32 v154, 16, v57
    v_and_b32 v155, 0xffff0000, v57
    v_lshlrev_b32 v156, 16, v58
    v_and_b32 v157, 0xffff0000, v58
    v_lshlrev_b32 v158, 16, v59
    v_and_b32 v159, 0xffff0000, v59
    v_pk_add_f32 v[248:249], v[152:153], v[154:155]
    v_pk_mul_f32 v[250:251], v[152:153], v[152:153]
    v_pk_add_f32 v[252:253], v[156:157], v[158:159]
    v_pk_fma_f32 v[250:251], v[154:155], v[154:155], v[250:251]
    buffer_load_dwordx4 v5, s[40:43], s39 offen offset:1024 lds
    v_pk_fma_f32 v[250:251], v[156:157], v[156:157], v[250:251]
    v_pk_fma_f32 v[250:251], v[158:159], v[158:159], v[250:251]
    v_pk_add_f32 v[248:249], v[248:249], v[252:253]
    v_add_f32 v240, v250, v251
    v_add_f32 v224, v248, v249
    s_waitcnt vmcnt(11)
    v_lshlrev_b32 v160, 16, v60
    v_and_b32 v161, 0xffff0000, v60
    v_lshlrev_b32 v162, 16, v61
    v_and_b32 v163, 0xffff0000, v61
    v_lshlrev_b32 v164, 16, v62
    v_and_b32 v165, 0xffff0000, v62
    v_lshlrev_b32 v166, 16, v63
    v_and_b32 v167, 0xffff0000, v63
    v_pk_add_f32 v[248:249], v[160:161], v[162:163]
    v_pk_mul_f32 v[250:251], v[160:161], v[160:161]
    v_pk_add_f32 v[252:253], v[164:165], v[166:167]
    v_pk_fma_f32 v[250:251], v[162:163], v[162:163], v[250:251]
    buffer_load_dwordx4 v5, s[40:43], s39 offen offset:2048 lds
    v_pk_fma_f32 v[250:251], v[164:165], v[164:165], v[250:251]
    v_pk_fma_f32 v[250:251], v[166:167], v[166:167], v[250:251]
    v_pk_add_f32 v[248:249], v[248:249], v[252:253]
    v_add_f32 v241, v250, v251
    v_add_f32 v225, v248, v249
    s_waitcnt vmcnt(11)
    v_lshlrev_b32 v168, 16, v64
    v_and_b32 v169, 0xffff0000, v64
    v_lshlrev_b32 v170, 16, v65
    v_and_b32 v171, 0xffff0000, v65
    v_lshlrev_b32 v172, 16, v66
    v_and_b32 v173, 0xffff0000, v66
    v_lshlrev_b32 v174, 16, v67
    v_and_b32 v175, 0xffff0000, v67
    v_pk_add_f32 v[248:249], v[168:169], v[170:171]
    v_pk_mul_f32 v[250:251], v[168:169], v[168:169]
    v_pk_add_f32 v[252:253], v[172:173], v[174:175]
    v_pk_fma_f32 v[250:251], v[170:171], v[170:171], v[250:251]
    s_xor_b32 s39, s93, 2
    s_mul_i32 s39, s39, 98304
    s_add_u32 m0, s100, 90112
    s_add_u32 s39, s39, s23
    buffer_load_dwordx4 v5, s[40:43], s39 offen offset:0 lds
    v_pk_fma_f32 v[250:251], v[172:173], v[172:173], v[250:251]
    v_pk_fma_f32 v[250:251], v[174:175], v[174:175], v[250:251]
    v_pk_add_f32 v[248:249], v[248:249], v[252:253]
    v_add_f32 v242, v250, v251
    v_add_f32 v226, v248, v249
    s_waitcnt vmcnt(11)
    v_lshlrev_b32 v176, 16, v68
    v_and_b32 v177, 0xffff0000, v68
    v_lshlrev_b32 v178, 16, v69
    v_and_b32 v179, 0xffff0000, v69
    v_lshlrev_b32 v180, 16, v70
    v_and_b32 v181, 0xffff0000, v70
    v_lshlrev_b32 v182, 16, v71
    v_and_b32 v183, 0xffff0000, v71
    v_pk_add_f32 v[248:249], v[176:177], v[178:179]
    v_pk_mul_f32 v[250:251], v[176:177], v[176:177]
    v_pk_add_f32 v[252:253], v[180:181], v[182:183]
    v_pk_fma_f32 v[250:251], v[178:179], v[178:179], v[250:251]
    buffer_load_dwordx4 v5, s[40:43], s39 offen offset:1024 lds
    v_pk_fma_f32 v[250:251], v[180:181], v[180:181], v[250:251]
    v_pk_fma_f32 v[250:251], v[182:183], v[182:183], v[250:251]
    v_pk_add_f32 v[248:249], v[248:249], v[252:253]
    v_add_f32 v243, v250, v251
    v_add_f32 v227, v248, v249
    s_waitcnt vmcnt(11)
    v_lshlrev_b32 v184, 16, v72
    v_and_b32 v185, 0xffff0000, v72
    v_lshlrev_b32 v186, 16, v73
    v_and_b32 v187, 0xffff0000, v73
    v_lshlrev_b32 v188, 16, v74
    v_and_b32 v189, 0xffff0000, v74
    v_lshlrev_b32 v190, 16, v75
    v_and_b32 v191, 0xffff0000, v75
    v_pk_add_f32 v[248:249], v[184:185], v[186:187]
    v_pk_mul_f32 v[250:251], v[184:185], v[184:185]
    v_pk_add_f32 v[252:253], v[188:189], v[190:191]
    v_pk_fma_f32 v[250:251], v[186:187], v[186:187], v[250:251]
    buffer_load_dwordx4 v5, s[40:43], s39 offen offset:2048 lds
    v_pk_fma_f32 v[250:251], v[188:189], v[188:189], v[250:251]
    v_pk_fma_f32 v[250:251], v[190:191], v[190:191], v[250:251]
    v_pk_add_f32 v[248:249], v[248:249], v[252:253]
    v_add_f32 v244, v250, v251
    v_add_f32 v228, v248, v249
    s_waitcnt vmcnt(11)
    v_lshlrev_b32 v192, 16, v76
    v_and_b32 v193, 0xffff0000, v76
    v_lshlrev_b32 v194, 16, v77
    v_and_b32 v195, 0xffff0000, v77
    v_lshlrev_b32 v196, 16, v78
    v_and_b32 v197, 0xffff0000, v78
    v_lshlrev_b32 v198, 16, v79
    v_and_b32 v199, 0xffff0000, v79
    v_pk_add_f32 v[248:249], v[192:193], v[194:195]
    v_pk_mul_f32 v[250:251], v[192:193], v[192:193]
    v_pk_add_f32 v[252:253], v[196:197], v[198:199]
    v_pk_fma_f32 v[250:251], v[194:195], v[194:195], v[250:251]
    s_xor_b32 s39, s93, 3
    s_mul_i32 s39, s39, 98304
    s_add_u32 m0, s100, 102400
    s_add_u32 s39, s39, s23
    buffer_load_dwordx4 v5, s[40:43], s39 offen offset:0 lds
    v_pk_fma_f32 v[250:251], v[196:197], v[196:197], v[250:251]
    v_pk_fma_f32 v[250:251], v[198:199], v[198:199], v[250:251]
    v_pk_add_f32 v[248:249], v[248:249], v[252:253]
    v_add_f32 v245, v250, v251
    v_add_f32 v229, v248, v249
    s_waitcnt vmcnt(11)
    v_lshlrev_b32 v200, 16, v80
    v_and_b32 v201, 0xffff0000, v80
    v_lshlrev_b32 v202, 16, v81
    v_and_b32 v203, 0xffff0000, v81
    v_lshlrev_b32 v204, 16, v82
    v_and_b32 v205, 0xffff0000, v82
    v_lshlrev_b32 v206, 16, v83
    v_and_b32 v207, 0xffff0000, v83
    v_pk_add_f32 v[248:249], v[200:201], v[202:203]
    v_pk_mul_f32 v[250:251], v[200:201], v[200:201]
    v_pk_add_f32 v[252:253], v[204:205], v[206:207]
    v_pk_fma_f32 v[250:251], v[202:203], v[202:203], v[250:251]
    buffer_load_dwordx4 v5, s[40:43], s39 offen offset:1024 lds
    v_pk_fma_f32 v[250:251], v[204:205], v[204:205], v[250:251]
    v_pk_fma_f32 v[250:251], v[206:207], v[206:207], v[250:251]
    v_pk_add_f32 v[248:249], v[248:249], v[252:253]
    v_add_f32 v246, v250, v251
    v_add_f32 v230, v248, v249
    s_waitcnt vmcnt(11)
    v_lshlrev_b32 v208, 16, v84
    v_and_b32 v209, 0xffff0000, v84
    v_lshlrev_b32 v210, 16, v85
    v_and_b32 v211, 0xffff0000, v85
    v_lshlrev_b32 v212, 16, v86
    v_and_b32 v213, 0xffff0000, v86
    v_lshlrev_b32 v214, 16, v87
    v_and_b32 v215, 0xffff0000, v87
    v_pk_add_f32 v[248:249], v[208:209], v[210:211]
    v_pk_mul_f32 v[250:251], v[208:209], v[208:209]
    v_pk_add_f32 v[252:253], v[212:213], v[214:215]
    v_pk_fma_f32 v[250:251], v[210:211], v[210:211], v[250:251]
    buffer_load_dwordx4 v5, s[40:43], s39 offen offset:2048 lds
    v_pk_fma_f32 v[250:251], v[212:213], v[212:213], v[250:251]
    v_pk_fma_f32 v[250:251], v[214:215], v[214:215], v[250:251]
    v_pk_add_f32 v[248:249], v[248:249], v[252:253]
    v_add_f32 v247, v250, v251
    v_add_f32 v231, v248, v249
    v_and_b32 v248, 15, v1
    v_lshrrev_b32 v249, 4, v1
    v_mul_u32_u24 v3, 3072, v249
    v_lshrrev_b32 v250, 2, v248
    v_lshl_add_u32 v3, v250, 7, v3
    v_and_b32 v250, 1, v248
    v_lshl_add_u32 v3, v250, 3, v3
    v_bfe_u32 v250, v248, 1, 1
    s_lshl_b32 s38, s3, 1
    v_add_u32 v250, s38, v250
    v_bfe_u32 v251, v248, 3, 1
    v_and_b32 v252, 1, v249
    v_lshl_add_u32 v251, v252, 1, v251
    v_lshlrev_b32 v251, 1, v251
    v_xor_b32 v250, v250, v251
    v_lshl_add_u32 v3, v250, 4, v3
    v_add_u32 v4, 0x10000, v3
    v_add_u32 v6, 0x20000, v3
    v_permlane32_swap_b32 v232, v240
    v_permlane32_swap_b32 v233, v241
    v_permlane32_swap_b32 v234, v242
    v_permlane32_swap_b32 v235, v243
    v_permlane32_swap_b32 v236, v244
    v_permlane32_swap_b32 v237, v245
    v_permlane32_swap_b32 v238, v246
    v_permlane32_swap_b32 v239, v247
    s_xor_b32 s39, s93, 4
    s_mul_i32 s39, s39, 98304
    s_add_u32 m0, s100, 114688
    s_add_u32 s39, s39, s23
    buffer_load_dwordx4 v5, s[40:43], s39 offen offset:0 lds
    v_permlane32_swap_b32 v216, v224
    v_permlane32_swap_b32 v217, v225
    v_permlane32_swap_b32 v218, v226
    v_permlane32_swap_b32 v219, v227
    v_permlane32_swap_b32 v220, v228
    v_permlane32_swap_b32 v221, v229
    v_permlane32_swap_b32 v222, v230
    v_permlane32_swap_b32 v223, v231
    buffer_load_dwordx4 v5, s[40:43], s39 offen offset:1024 lds
    v_pk_add_f32 v[232:233], v[232:233], v[240:241]
    v_pk_add_f32 v[234:235], v[234:235], v[242:243]
    v_pk_add_f32 v[236:237], v[236:237], v[244:245]
    v_pk_add_f32 v[238:239], v[238:239], v[246:247]
    v_pk_add_f32 v[216:217], v[216:217], v[224:225]
    v_pk_add_f32 v[218:219], v[218:219], v[226:227]
    v_pk_add_f32 v[220:221], v[220:221], v[228:229]
    v_pk_add_f32 v[222:223], v[222:223], v[230:231]
    buffer_load_dwordx4 v5, s[40:43], s39 offen offset:2048 lds
    v_permlane16_swap_b32 v232, v236
    v_permlane16_swap_b32 v233, v237
    v_permlane16_swap_b32 v234, v238
    v_permlane16_swap_b32 v235, v239
    v_permlane16_swap_b32 v216, v220
    v_permlane16_swap_b32 v217, v221
    v_permlane16_swap_b32 v218, v222
    v_permlane16_swap_b32 v219, v223
    s_xor_b32 s39, s93, 5
    s_mul_i32 s39, s39, 98304
    s_add_u32 m0, s100, 126976
    s_add_u32 s39, s39, s23
    buffer_load_dwordx4 v5, s[40:43], s39 offen offset:0 lds
    v_pk_add_f32 v[232:233], v[232:233], v[236:237]
    v_pk_add_f32 v[234:235], v[234:235], v[238:239]
    v_pk_add_f32 v[216:217], v[216:217], v[220:221]
    v_pk_add_f32 v[218:219], v[218:219], v[222:223]
    s_mov_b32 s4, 0x00f000f0
    s_mov_b32 s5, 0x00f000f0
    s_mov_b32 s6, 0x0f000f00
    s_mov_b32 s7, 0x0f000f00
    buffer_load_dwordx4 v5, s[40:43], s39 offen offset:1024 lds
    s_mov_b32 s8, 0xf000f000
    s_mov_b32 s9, 0xf000f000
    v_add_f32_dpp v232, v232, v232 row_ror:8 row_mask:0xf bank_mask:0xf
    v_add_f32_dpp v233, v233, v233 row_ror:8 row_mask:0xf bank_mask:0xf
    v_add_f32_dpp v234, v234, v234 row_ror:8 row_mask:0xf bank_mask:0xf
    v_add_f32_dpp v235, v235, v235 row_ror:8 row_mask:0xf bank_mask:0xf
    v_add_f32_dpp v216, v216, v216 row_ror:8 row_mask:0xf bank_mask:0xf
    v_add_f32_dpp v217, v217, v217 row_ror:8 row_mask:0xf bank_mask:0xf
    buffer_load_dwordx4 v5, s[40:43], s39 offen offset:2048 lds
    v_add_f32_dpp v218, v218, v218 row_ror:8 row_mask:0xf bank_mask:0xf
    v_add_f32_dpp v219, v219, v219 row_ror:8 row_mask:0xf bank_mask:0xf
    v_add_f32_dpp v232, v232, v232 row_ror:4 row_mask:0xf bank_mask:0xf
    v_add_f32_dpp v233, v233, v233 row_ror:4 row_mask:0xf bank_mask:0xf
    v_add_f32_dpp v234, v234, v234 row_ror:4 row_mask:0xf bank_mask:0xf
    v_add_f32_dpp v235, v235, v235 row_ror:4 row_mask:0xf bank_mask:0xf
    v_add_f32_dpp v216, v216, v216 row_ror:4 row_mask:0xf bank_mask:0xf
    v_add_f32_dpp v217, v217, v217 row_ror:4 row_mask:0xf bank_mask:0xf
    v_add_f32_dpp v218, v218, v218 row_ror:4 row_mask:0xf bank_mask:0xf
    v_add_f32_dpp v219, v219, v219 row_ror:4 row_mask:0xf bank_mask:0xf
    v_cndmask_b32 v232, v232, v233, s[4:5]
    v_cndmask_b32 v216, v216, v217, s[4:5]
    v_cndmask_b32 v232, v232, v234, s[6:7]
    v_cndmask_b32 v216, v216, v218, s[6:7]
    v_cndmask_b32 v232, v232, v235, s[8:9]
    v_cndmask_b32 v216, v216, v219, s[8:9]
    s_nop 0
    v_add_f32_dpp v232, v232, v232 quad_perm:[1,0,3,2] row_mask:0xf bank_mask:0xf
    v_add_f32_dpp v216, v216, v216 quad_perm:[1,0,3,2] row_mask:0xf bank_mask:0xf
    s_nop 0
    v_add_f32_dpp v232, v232, v232 quad_perm:[2,3,0,1] row_mask:0xf bank_mask:0xf
    v_add_f32_dpp v216, v216, v216 quad_perm:[2,3,0,1] row_mask:0xf bank_mask:0xf
    s_nop 0
    v_mul_f32 v216, 0x3b000000, v216
    v_mul_f32 v232, 0x3b000000, v232
    v_fma_f32 v232, -v216, v216, v232
    v_max_f32 v232, 0, v232
    v_cvt_pk_bf16_f32 v220, v216, v216
    v_and_b32 v220, 0xffff0000, v220
    v_cvt_pk_bf16_f32 v232, v232, v232
    v_and_b32 v232, 0xffff0000, v232
    v_add_f32 v232, 0x3727c5ac, v232
    v_cvt_pk_bf16_f32 v232, v232, v232
    v_and_b32 v232, 0xffff0000, v232
    v_sqrt_f32 v232, v232
    s_nop 0
    v_cvt_pk_bf16_f32 v240, v232, v232
    v_and_b32 v240, 0xffff0000, v240
    v_rcp_f32 v236, v240
    s_nop 0
    v_mul_f32 v220, -v220, v236
    s_lshl_b32 s38, s3, 11
    s_add_u32 s38, s38, 32768
    buffer_load_dwordx4 v[24:27], v2, s[24:27], s38 offen offset:0 sc1
    buffer_load_dwordx4 v[28:31], v2, s[24:27], s38 offen offset:1024 sc1
    s_add_u32 s38, s38, 8192
    buffer_load_dwordx4 v[32:35], v2, s[24:27], s38 offen offset:0 sc1
    buffer_load_dwordx4 v[36:39], v2, s[24:27], s38 offen offset:1024 sc1
    s_add_u32 s38, s38, 8192
    buffer_load_dwordx4 v[40:43], v2, s[24:27], s38 offen offset:0 sc1
    buffer_load_dwordx4 v[44:47], v2, s[24:27], s38 offen offset:1024 sc1
    s_add_u32 s38, s38, 8192
    buffer_load_dwordx4 v[48:51], v2, s[24:27], s38 offen offset:0 sc1
    buffer_load_dwordx4 v[52:55], v2, s[24:27], s38 offen offset:1024 sc1
    v_lshlrev_b32 v56, 7, v1
    s_lshl_b32 s4, s3, 12
    s_add_u32 s4, s4, 28377088
    s_sub_u32 s4, s4, s0
    v_add_u32 v56, s4, v56
    s_cmp_eq_u32 s2, 9
    s_cselect_b32 s4, 32, 0
    v_cmp_gt_u32 vcc, s4, v1
    v_and_b32 v57, 1, v1
    v_lshlrev_b32 v57, 7, v57
    v_cndmask_b32 v56, v57, v56, vcc
    buffer_load_dword a213, v56, s[24:27], s0 offen
    s_waitcnt vmcnt(15)
    s_barrier
    v_readlane_b32 s4, v236, 0
    v_readlane_b32 s5, v220, 0
    v_readlane_b32 s6, v236, 4
    ds_read_b64_tr_b16 a[0:1], v4 offset:0
    v_readlane_b32 s7, v220, 4
    v_readlane_b32 s8, v236, 8
    v_readlane_b32 s9, v220, 8
    ds_read_b64_tr_b16 a[2:3], v4 offset:512
    v_readlane_b32 s10, v236, 12
    v_readlane_b32 s11, v220, 12
    v_readlane_b32 s12, v236, 16
    s_xor_b32 s39, s93, 6
    s_mul_i32 s39, s39, 98304
    s_add_u32 m0, s100, 139264
    s_add_u32 s39, s39, s23
    buffer_load_dwordx4 v5, s[40:43], s39 offen offset:0 lds
    v_readlane_b32 s13, v220, 16
    v_readlane_b32 s14, v236, 20
    v_readlane_b32 s15, v220, 20
    ds_read_b64_tr_b16 a[4:5], v4 offset:1024
    v_readlane_b32 s16, v236, 24
    v_readlane_b32 s17, v220, 24
    v_readlane_b32 s18, v236, 28
    ds_read_b64_tr_b16 a[6:7], v4 offset:1536
    v_readlane_b32 s19, v220, 28
    v_pk_fma_f32 v[88:89], v[88:89], s[4:5], s[4:5] op_sel:[0,0,1] op_sel_hi:[1,0,1]
    v_pk_fma_f32 v[90:91], v[90:91], s[4:5], s[4:5] op_sel:[0,0,1] op_sel_hi:[1,0,1]
    buffer_load_dwordx4 v5, s[40:43], s39 offen offset:1024 lds
    v_pk_fma_f32 v[92:93], v[92:93], s[4:5], s[4:5] op_sel:[0,0,1] op_sel_hi:[1,0,1]
    v_pk_fma_f32 v[94:95], v[94:95], s[4:5], s[4:5] op_sel:[0,0,1] op_sel_hi:[1,0,1]
    v_pk_fma_f32 v[96:97], v[96:97], s[6:7], s[6:7] op_sel:[0,0,1] op_sel_hi:[1,0,1]
    ds_read_b64_tr_b16 a[8:9], v4 offset:2048
    v_pk_fma_f32 v[98:99], v[98:99], s[6:7], s[6:7] op_sel:[0,0,1] op_sel_hi:[1,0,1]
    v_pk_fma_f32 v[100:101], v[100:101], s[6:7], s[6:7] op_sel:[0,0,1] op_sel_hi:[1,0,1]
    v_pk_fma_f32 v[102:103], v[102:103], s[6:7], s[6:7] op_sel:[0,0,1] op_sel_hi:[1,0,1]
    ds_read_b64_tr_b16 a[10:11], v4 offset:2560
    v_pk_fma_f32 v[104:105], v[104:105], s[8:9], s[8:9] op_sel:[0,0,1] op_sel_hi:[1,0,1]
    v_pk_fma_f32 v[106:107], v[106:107], s[8:9], s[8:9] op_sel:[0,0,1] op_sel_hi:[1,0,1]
    v_pk_fma_f32 v[108:109], v[108:109], s[8:9], s[8:9] op_sel:[0,0,1] op_sel_hi:[1,0,1]
    buffer_load_dwordx4 v5, s[40:43], s39 offen offset:2048 lds
    v_pk_fma_f32 v[110:111], v[110:111], s[8:9], s[8:9] op_sel:[0,0,1] op_sel_hi:[1,0,1]
    v_pk_fma_f32 v[112:113], v[112:113], s[10:11], s[10:11] op_sel:[0,0,1] op_sel_hi:[1,0,1]
    v_pk_fma_f32 v[114:115], v[114:115], s[10:11], s[10:11] op_sel:[0,0,1] op_sel_hi:[1,0,1]
    ds_read_b64_tr_b16 a[12:13], v4 offset:12288
    v_pk_fma_f32 v[116:117], v[116:117], s[10:11], s[10:11] op_sel:[0,0,1] op_sel_hi:[1,0,1]
    v_pk_fma_f32 v[118:119], v[118:119], s[10:11], s[10:11] op_sel:[0,0,1] op_sel_hi:[1,0,1]
    v_pk_fma_f32 v[120:121], v[120:121], s[12:13], s[12:13] op_sel:[0,0,1] op_sel_hi:[1,0,1]
    ds_read_b64_tr_b16 a[14:15], v4 offset:12800
    v_pk_fma_f32 v[122:123], v[122:123], s[12:13], s[12:13] op_sel:[0,0,1] op_sel_hi:[1,0,1]
    v_pk_fma_f32 v[124:125], v[124:125], s[12:13], s[12:13] op_sel:[0,0,1] op_sel_hi:[1,0,1]
    v_pk_fma_f32 v[126:127], v[126:127], s[12:13], s[12:13] op_sel:[0,0,1] op_sel_hi:[1,0,1]
    s_xor_b32 s39, s93, 7
    s_mul_i32 s39, s39, 98304
    s_add_u32 m0, s100, 151552
    s_add_u32 s39, s39, s23
    buffer_load_dwordx4 v5, s[40:43], s39 offen offset:0 lds
    v_pk_fma_f32 v[128:129], v[128:129], s[14:15], s[14:15] op_sel:[0,0,1] op_sel_hi:[1,0,1]
    v_pk_fma_f32 v[130:131], v[130:131], s[14:15], s[14:15] op_sel:[0,0,1] op_sel_hi:[1,0,1]
    v_pk_fma_f32 v[132:133], v[132:133], s[14:15], s[14:15] op_sel:[0,0,1] op_sel_hi:[1,0,1]
    ds_read_b64_tr_b16 a[16:17], v4 offset:13312
    v_pk_fma_f32 v[134:135], v[134:135], s[14:15], s[14:15] op_sel:[0,0,1] op_sel_hi:[1,0,1]
    v_pk_fma_f32 v[136:137], v[136:137], s[16:17], s[16:17] op_sel:[0,0,1] op_sel_hi:[1,0,1]
    v_pk_fma_f32 v[138:139], v[138:139], s[16:17], s[16:17] op_sel:[0,0,1] op_sel_hi:[1,0,1]
    ds_read_b64_tr_b16 a[18:19], v4 offset:13824
    v_pk_fma_f32 v[140:141], v[140:141], s[16:17], s[16:17] op_sel:[0,0,1] op_sel_hi:[1,0,1]
    v_pk_fma_f32 v[142:143], v[142:143], s[16:17], s[16:17] op_sel:[0,0,1] op_sel_hi:[1,0,1]
    v_pk_fma_f32 v[144:145], v[144:145], s[18:19], s[18:19] op_sel:[0,0,1] op_sel_hi:[1,0,1]
    buffer_load_dwordx4 v5, s[40:43], s39 offen offset:1024 lds
    v_pk_fma_f32 v[146:147], v[146:147], s[18:19], s[18:19] op_sel:[0,0,1] op_sel_hi:[1,0,1]
    v_pk_fma_f32 v[148:149], v[148:149], s[18:19], s[18:19] op_sel:[0,0,1] op_sel_hi:[1,0,1]
    v_pk_fma_f32 v[150:151], v[150:151], s[18:19], s[18:19] op_sel:[0,0,1] op_sel_hi:[1,0,1]
    ds_read_b64_tr_b16 a[20:21], v4 offset:14336
    v_readlane_b32 s4, v236, 32
    v_readlane_b32 s5, v220, 32
    v_readlane_b32 s6, v236, 36
    ds_read_b64_tr_b16 a[22:23], v4 offset:14848
    v_readlane_b32 s7, v220, 36
    v_readlane_b32 s8, v236, 40
    v_readlane_b32 s9, v220, 40
    buffer_load_dwordx4 v5, s[40:43], s39 offen offset:2048 lds
    v_readlane_b32 s10, v236, 44
    v_readlane_b32 s11, v220, 44
    v_readlane_b32 s12, v236, 48
    ds_read_b64_tr_b16 a[24:25], v4 offset:24576
    v_readlane_b32 s13, v220, 48
    v_readlane_b32 s14, v236, 52
    v_readlane_b32 s15, v220, 52
    ds_read_b64_tr_b16 a[26:27], v4 offset:25088
    v_readlane_b32 s16, v236, 56
    v_readlane_b32 s17, v220, 56
    v_readlane_b32 s18, v236, 60
    ds_read_b64_tr_b16 a[28:29], v4 offset:25600
    v_readlane_b32 s19, v220, 60
    v_pk_fma_f32 v[152:153], v[152:153], s[4:5], s[4:5] op_sel:[0,0,1] op_sel_hi:[1,0,1]
    v_pk_fma_f32 v[154:155], v[154:155], s[4:5], s[4:5] op_sel:[0,0,1] op_sel_hi:[1,0,1]
    ds_read_b64_tr_b16 a[30:31], v4 offset:26112
    v_pk_fma_f32 v[156:157], v[156:157], s[4:5], s[4:5] op_sel:[0,0,1] op_sel_hi:[1,0,1]
    v_pk_fma_f32 v[158:159], v[158:159], s[4:5], s[4:5] op_sel:[0,0,1] op_sel_hi:[1,0,1]
    v_pk_fma_f32 v[160:161], v[160:161], s[6:7], s[6:7] op_sel:[0,0,1] op_sel_hi:[1,0,1]
    ds_read_b64_tr_b16 a[32:33], v4 offset:26624
    v_pk_fma_f32 v[162:163], v[162:163], s[6:7], s[6:7] op_sel:[0,0,1] op_sel_hi:[1,0,1]
    v_pk_fma_f32 v[164:165], v[164:165], s[6:7], s[6:7] op_sel:[0,0,1] op_sel_hi:[1,0,1]
    v_pk_fma_f32 v[166:167], v[166:167], s[6:7], s[6:7] op_sel:[0,0,1] op_sel_hi:[1,0,1]
    ds_read_b64_tr_b16 a[34:35], v4 offset:27136
    v_pk_fma_f32 v[168:169], v[168:169], s[8:9], s[8:9] op_sel:[0,0,1] op_sel_hi:[1,0,1]
    v_pk_fma_f32 v[170:171], v[170:171], s[8:9], s[8:9] op_sel:[0,0,1] op_sel_hi:[1,0,1]
    v_pk_fma_f32 v[172:173], v[172:173], s[8:9], s[8:9] op_sel:[0,0,1] op_sel_hi:[1,0,1]
    ds_read_b64_tr_b16 a[36:37], v4 offset:36864
    v_pk_fma_f32 v[174:175], v[174:175], s[8:9], s[8:9] op_sel:[0,0,1] op_sel_hi:[1,0,1]
    v_pk_fma_f32 v[176:177], v[176:177], s[10:11], s[10:11] op_sel:[0,0,1] op_sel_hi:[1,0,1]
    v_pk_fma_f32 v[178:179], v[178:179], s[10:11], s[10:11] op_sel:[0,0,1] op_sel_hi:[1,0,1]
    ds_read_b64_tr_b16 a[38:39], v4 offset:37376
    v_pk_fma_f32 v[180:181], v[180:181], s[10:11], s[10:11] op_sel:[0,0,1] op_sel_hi:[1,0,1]
    v_pk_fma_f32 v[182:183], v[182:183], s[10:11], s[10:11] op_sel:[0,0,1] op_sel_hi:[1,0,1]
    v_pk_fma_f32 v[184:185], v[184:185], s[12:13], s[12:13] op_sel:[0,0,1] op_sel_hi:[1,0,1]
    ds_read_b64_tr_b16 a[40:41], v4 offset:37888
    v_pk_fma_f32 v[186:187], v[186:187], s[12:13], s[12:13] op_sel:[0,0,1] op_sel_hi:[1,0,1]
    v_pk_fma_f32 v[188:189], v[188:189], s[12:13], s[12:13] op_sel:[0,0,1] op_sel_hi:[1,0,1]
    v_pk_fma_f32 v[190:191], v[190:191], s[12:13], s[12:13] op_sel:[0,0,1] op_sel_hi:[1,0,1]
    ds_read_b64_tr_b16 a[42:43], v4 offset:38400
    v_pk_fma_f32 v[192:193], v[192:193], s[14:15], s[14:15] op_sel:[0,0,1] op_sel_hi:[1,0,1]
    v_pk_fma_f32 v[194:195], v[194:195], s[14:15], s[14:15] op_sel:[0,0,1] op_sel_hi:[1,0,1]
    v_pk_fma_f32 v[196:197], v[196:197], s[14:15], s[14:15] op_sel:[0,0,1] op_sel_hi:[1,0,1]
    ds_read_b64_tr_b16 a[44:45], v4 offset:38912
    v_pk_fma_f32 v[198:199], v[198:199], s[14:15], s[14:15] op_sel:[0,0,1] op_sel_hi:[1,0,1]
    v_pk_fma_f32 v[200:201], v[200:201], s[16:17], s[16:17] op_sel:[0,0,1] op_sel_hi:[1,0,1]
    v_pk_fma_f32 v[202:203], v[202:203], s[16:17], s[16:17] op_sel:[0,0,1] op_sel_hi:[1,0,1]
    ds_read_b64_tr_b16 a[46:47], v4 offset:39424
    v_pk_fma_f32 v[204:205], v[204:205], s[16:17], s[16:17] op_sel:[0,0,1] op_sel_hi:[1,0,1]
    v_pk_fma_f32 v[206:207], v[206:207], s[16:17], s[16:17] op_sel:[0,0,1] op_sel_hi:[1,0,1]
    v_pk_fma_f32 v[208:209], v[208:209], s[18:19], s[18:19] op_sel:[0,0,1] op_sel_hi:[1,0,1]
    v_pk_fma_f32 v[210:211], v[210:211], s[18:19], s[18:19] op_sel:[0,0,1] op_sel_hi:[1,0,1]
    v_pk_fma_f32 v[212:213], v[212:213], s[18:19], s[18:19] op_sel:[0,0,1] op_sel_hi:[1,0,1]
    v_pk_fma_f32 v[214:215], v[214:215], s[18:19], s[18:19] op_sel:[0,0,1] op_sel_hi:[1,0,1]
    s_lshl_b32 s38, s93, 2
    v_xor_b32 v254, s38, v1
    v_lshlrev_b32 v254, 8, v254
    v_and_b32 v253, 7, v1
    v_lshl_add_u32 v254, v253, 4, v254
    s_lshl_b32 s38, s3, 14
    s_lshl_b32 s39, s101, 6
    v_add_u32 v254, s38, v254
    v_xor_b32 v254, s39, v254
    s_lshl_b32 s38, s3, 10
    v_lshlrev_b32 v7, 3, v1
    v_add_u32 v7, s38, v7
    v_lshlrev_b32 v255, 5, v1
    s_cmp_ge_u32 s3, 2
    s_cselect_b32 s5, 1.0, 0
    s_waitcnt vmcnt(7)
    v_and_b32 v252, v25, v27
    v_or_b32 v253, v25, v27
    v_bitop3_b32 v252, v252, v29, v31 bitop3:0x80
    v_or3_b32 v253, v253, v29, v31
    v_bitop3_b32 v252, v252, v33, v35 bitop3:0x80
    v_or3_b32 v253, v253, v33, v35
    v_bitop3_b32 v252, v252, v37, v39 bitop3:0x80
    v_or3_b32 v253, v253, v37, v39
    v_bitop3_b32 v252, v252, v41, v43 bitop3:0x80
    v_or3_b32 v253, v253, v41, v43
    v_bitop3_b32 v252, v252, v45, v47 bitop3:0x80
    v_or3_b32 v253, v253, v45, v47
    v_bitop3_b32 v252, v252, v49, v51 bitop3:0x80
    v_or3_b32 v253, v253, v49, v51
    v_bitop3_b32 v252, v252, v53, v55 bitop3:0x80
    v_or3_b32 v253, v253, v53, v55
    v_xor_b32 v252, s98, v252
    v_xor_b32 v253, s98, v253
    v_or_b32 v252, v252, v253
    v_cmp_ne_u32 vcc, 0, v252
    s_nop 0
    s_cbranch_vccnz L_mod_spin
L_mod_ok:
    v_add_f32 v8, v24, v32
    v_add_f32 v12, v40, v48
    v_add_f32 v9, v26, v34
    v_add_f32 v13, v42, v50
    v_add_f32 v10, v28, v36
    v_add_f32 v14, v44, v52
    v_add_f32 v11, v30, v38
    v_add_f32 v15, v46, v54
    v_pk_add_f32 v[8:9], v[8:9], v[12:13]
    v_pk_add_f32 v[10:11], v[10:11], v[14:15]
    v_cvt_pk_bf16_f32 v12, v8, v9
    v_cvt_pk_bf16_f32 v13, v10, v11
    v_lshlrev_b32 v8, 16, v12
    v_and_b32 v9, 0xffff0000, v12
    v_lshlrev_b32 v10, 16, v13
    v_and_b32 v11, 0xffff0000, v13
    v_add_f32 v8, s5, v8
    v_add_f32 v9, s5, v9
    v_add_f32 v10, s5, v10
    v_add_f32 v11, s5, v11
    v_cvt_pk_bf16_f32 v12, v8, v9
    v_cvt_pk_bf16_f32 v13, v10, v11
    v_lshlrev_b32 v8, 16, v12
    v_and_b32 v9, 0xffff0000, v12
    v_lshlrev_b32 v10, 16, v13
    v_and_b32 v11, 0xffff0000, v13
    ds_write_b64 v7, v[8:9] offset:53248
    ds_write_b64 v7, v[10:11] offset:53760
    s_waitcnt lgkmcnt(0)
    s_barrier
    ds_read_b128 v[16:19], v255 offset:53248
    ds_read_b128 v[20:23], v255 offset:53264
    ds_read_b128 v[8:11], v255 offset:55296
    ds_read_b128 v[12:15], v255 offset:55312
    s_xor_b32 s39, s93, 8
    s_mul_i32 s39, s39, 98304
    s_add_u32 m0, s100, 65536
    s_add_u32 s39, s39, s23
    buffer_load_dwordx4 v5, s[40:43], s39 offen offset:0 lds
    buffer_load_dwordx4 v5, s[40:43], s39 offen offset:1024 lds
    s_waitcnt lgkmcnt(0)
    v_pk_fma_f32 v[88:89], v[88:89], v[8:9], v[16:17]
    v_pk_fma_f32 v[90:91], v[90:91], v[10:11], v[18:19]
    v_pk_fma_f32 v[92:93], v[92:93], v[12:13], v[20:21]
    v_pk_fma_f32 v[94:95], v[94:95], v[14:15], v[22:23]
    v_cvt_pk_bf16_f32 v88, v88, v89
    v_cvt_pk_bf16_f32 v89, v90, v91
    v_cvt_pk_bf16_f32 v90, v92, v93
    v_cvt_pk_bf16_f32 v91, v94, v95
    v_xor_b32 v92, 0, v254
    s_barrier
    ds_write_b128 v92, v[88:91]
    v_pk_fma_f32 v[96:97], v[96:97], v[8:9], v[16:17]
    v_pk_fma_f32 v[98:99], v[98:99], v[10:11], v[18:19]
    v_pk_fma_f32 v[100:101], v[100:101], v[12:13], v[20:21]
    v_pk_fma_f32 v[102:103], v[102:103], v[14:15], v[22:23]
    v_cvt_pk_bf16_f32 v96, v96, v97
    buffer_load_dwordx4 v5, s[40:43], s39 offen offset:2048 lds
    v_cvt_pk_bf16_f32 v97, v98, v99
    v_cvt_pk_bf16_f32 v98, v100, v101
    v_cvt_pk_bf16_f32 v99, v102, v103
    v_xor_b32 v100, 16, v254
    ds_write_b128 v100, v[96:99]
    v_pk_fma_f32 v[104:105], v[104:105], v[8:9], v[16:17]
    v_pk_fma_f32 v[106:107], v[106:107], v[10:11], v[18:19]
    v_pk_fma_f32 v[108:109], v[108:109], v[12:13], v[20:21]
    v_pk_fma_f32 v[110:111], v[110:111], v[14:15], v[22:23]
    v_cvt_pk_bf16_f32 v104, v104, v105
    v_cvt_pk_bf16_f32 v105, v106, v107
    v_cvt_pk_bf16_f32 v106, v108, v109
    v_cvt_pk_bf16_f32 v107, v110, v111
    v_xor_b32 v108, 32, v254
    ds_write_b128 v108, v[104:107]
    v_pk_fma_f32 v[112:113], v[112:113], v[8:9], v[16:17]
    s_xor_b32 s39, s93, 9
    s_mul_i32 s39, s39, 98304
    s_add_u32 m0, s100, 77824
    s_add_u32 s39, s39, s23
    buffer_load_dwordx4 v5, s[40:43], s39 offen offset:0 lds
    v_pk_fma_f32 v[114:115], v[114:115], v[10:11], v[18:19]
    v_pk_fma_f32 v[116:117], v[116:117], v[12:13], v[20:21]
    v_pk_fma_f32 v[118:119], v[118:119], v[14:15], v[22:23]
    v_cvt_pk_bf16_f32 v112, v112, v113
    v_cvt_pk_bf16_f32 v113, v114, v115
    v_cvt_pk_bf16_f32 v114, v116, v117
    v_cvt_pk_bf16_f32 v115, v118, v119
    v_xor_b32 v116, 48, v254
    ds_write_b128 v116, v[112:115]
    v_pk_fma_f32 v[120:121], v[120:121], v[8:9], v[16:17]
    v_pk_fma_f32 v[122:123], v[122:123], v[10:11], v[18:19]
    v_pk_fma_f32 v[124:125], v[124:125], v[12:13], v[20:21]
    v_pk_fma_f32 v[126:127], v[126:127], v[14:15], v[22:23]
    v_cvt_pk_bf16_f32 v120, v120, v121
    v_cvt_pk_bf16_f32 v121, v122, v123
    v_cvt_pk_bf16_f32 v122, v124, v125
    buffer_load_dwordx4 v5, s[40:43], s39 offen offset:1024 lds
    v_cvt_pk_bf16_f32 v123, v126, v127
    v_xor_b32 v124, 64, v254
    ds_write_b128 v124, v[120:123]
    v_pk_fma_f32 v[128:129], v[128:129], v[8:9], v[16:17]
    v_pk_fma_f32 v[130:131], v[130:131], v[10:11], v[18:19]
    v_pk_fma_f32 v[132:133], v[132:133], v[12:13], v[20:21]
    v_pk_fma_f32 v[134:135], v[134:135], v[14:15], v[22:23]
    v_cvt_pk_bf16_f32 v128, v128, v129
    v_cvt_pk_bf16_f32 v129, v130, v131
    v_cvt_pk_bf16_f32 v130, v132, v133
    v_cvt_pk_bf16_f32 v131, v134, v135
    v_xor_b32 v132, 80, v254
    ds_write_b128 v132, v[128:131]
    v_pk_fma_f32 v[136:137], v[136:137], v[8:9], v[16:17]
    v_pk_fma_f32 v[138:139], v[138:139], v[10:11], v[18:19]
    v_pk_fma_f32 v[140:141], v[140:141], v[12:13], v[20:21]
    buffer_load_dwordx4 v5, s[40:43], s39 offen offset:2048 lds
    v_pk_fma_f32 v[142:143], v[142:143], v[14:15], v[22:23]
    v_cvt_pk_bf16_f32 v136, v136, v137
    v_cvt_pk_bf16_f32 v137, v138, v139
    v_cvt_pk_bf16_f32 v138, v140, v141
    v_cvt_pk_bf16_f32 v139, v142, v143
    v_xor_b32 v140, 96, v254
    ds_write_b128 v140, v[136:139]
    v_pk_fma_f32 v[144:145], v[144:145], v[8:9], v[16:17]
    v_pk_fma_f32 v[146:147], v[146:147], v[10:11], v[18:19]
    v_pk_fma_f32 v[148:149], v[148:149], v[12:13], v[20:21]
    v_pk_fma_f32 v[150:151], v[150:151], v[14:15], v[22:23]
    v_cvt_pk_bf16_f32 v144, v144, v145
    v_cvt_pk_bf16_f32 v145, v146, v147
    v_cvt_pk_bf16_f32 v146, v148, v149
    v_cvt_pk_bf16_f32 v147, v150, v151
    v_xor_b32 v148, 112, v254
    s_xor_b32 s39, s93, 10
    s_mul_i32 s39, s39, 98304
    s_add_u32 m0, s100, 90112
    s_add_u32 s39, s39, s23
    buffer_load_dwordx4 v5, s[40:43], s39 offen offset:0 lds
    ds_write_b128 v148, v[144:147]
    v_pk_fma_f32 v[152:153], v[152:153], v[8:9], v[16:17]
    v_pk_fma_f32 v[154:155], v[154:155], v[10:11], v[18:19]
    v_pk_fma_f32 v[156:157], v[156:157], v[12:13], v[20:21]
    v_pk_fma_f32 v[158:159], v[158:159], v[14:15], v[22:23]
    v_cvt_pk_bf16_f32 v152, v152, v153
    v_cvt_pk_bf16_f32 v153, v154, v155
    v_cvt_pk_bf16_f32 v154, v156, v157
    v_cvt_pk_bf16_f32 v155, v158, v159
    v_xor_b32 v156, 128, v254
    ds_write_b128 v156, v[152:155]
    v_pk_fma_f32 v[160:161], v[160:161], v[8:9], v[16:17]
    v_pk_fma_f32 v[162:163], v[162:163], v[10:11], v[18:19]
    v_pk_fma_f32 v[164:165], v[164:165], v[12:13], v[20:21]
    v_pk_fma_f32 v[166:167], v[166:167], v[14:15], v[22:23]
    v_cvt_pk_bf16_f32 v160, v160, v161
    buffer_load_dwordx4 v5, s[40:43], s39 offen offset:1024 lds
    v_cvt_pk_bf16_f32 v161, v162, v163
    v_cvt_pk_bf16_f32 v162, v164, v165
    v_cvt_pk_bf16_f32 v163, v166, v167
    v_xor_b32 v164, 144, v254
    ds_write_b128 v164, v[160:163]
    v_pk_fma_f32 v[168:169], v[168:169], v[8:9], v[16:17]
    v_pk_fma_f32 v[170:171], v[170:171], v[10:11], v[18:19]
    v_pk_fma_f32 v[172:173], v[172:173], v[12:13], v[20:21]
    v_pk_fma_f32 v[174:175], v[174:175], v[14:15], v[22:23]
    v_cvt_pk_bf16_f32 v168, v168, v169
    v_cvt_pk_bf16_f32 v169, v170, v171
    v_cvt_pk_bf16_f32 v170, v172, v173
    v_cvt_pk_bf16_f32 v171, v174, v175
    v_xor_b32 v172, 160, v254
    ds_write_b128 v172, v[168:171]
    v_pk_fma_f32 v[176:177], v[176:177], v[8:9], v[16:17]
    buffer_load_dwordx4 v5, s[40:43], s39 offen offset:2048 lds
    v_pk_fma_f32 v[178:179], v[178:179], v[10:11], v[18:19]
    v_pk_fma_f32 v[180:181], v[180:181], v[12:13], v[20:21]
    v_pk_fma_f32 v[182:183], v[182:183], v[14:15], v[22:23]
    v_cvt_pk_bf16_f32 v176, v176, v177
    v_cvt_pk_bf16_f32 v177, v178, v179
    v_cvt_pk_bf16_f32 v178, v180, v181
    v_cvt_pk_bf16_f32 v179, v182, v183
    v_xor_b32 v180, 176, v254
    ds_write_b128 v180, v[176:179]
    v_pk_fma_f32 v[184:185], v[184:185], v[8:9], v[16:17]
    v_pk_fma_f32 v[186:187], v[186:187], v[10:11], v[18:19]
    v_pk_fma_f32 v[188:189], v[188:189], v[12:13], v[20:21]
    v_pk_fma_f32 v[190:191], v[190:191], v[14:15], v[22:23]
    v_cvt_pk_bf16_f32 v184, v184, v185
    v_cvt_pk_bf16_f32 v185, v186, v187
    v_cvt_pk_bf16_f32 v186, v188, v189
    s_xor_b32 s39, s93, 11
    s_mul_i32 s39, s39, 98304
    s_add_u32 m0, s100, 102400
    s_add_u32 s39, s39, s23
    buffer_load_dwordx4 v5, s[40:43], s39 offen offset:0 lds
    v_cvt_pk_bf16_f32 v187, v190, v191
    v_xor_b32 v188, 192, v254
    ds_write_b128 v188, v[184:187]
    v_pk_fma_f32 v[192:193], v[192:193], v[8:9], v[16:17]
    v_pk_fma_f32 v[194:195], v[194:195], v[10:11], v[18:19]
    v_pk_fma_f32 v[196:197], v[196:197], v[12:13], v[20:21]
    v_pk_fma_f32 v[198:199], v[198:199], v[14:15], v[22:23]
    v_cvt_pk_bf16_f32 v192, v192, v193
    v_cvt_pk_bf16_f32 v193, v194, v195
    v_cvt_pk_bf16_f32 v194, v196, v197
    v_cvt_pk_bf16_f32 v195, v198, v199
    v_xor_b32 v196, 208, v254
    ds_write_b128 v196, v[192:195]
    v_pk_fma_f32 v[200:201], v[200:201], v[8:9], v[16:17]
    v_pk_fma_f32 v[202:203], v[202:203], v[10:11], v[18:19]
    v_pk_fma_f32 v[204:205], v[204:205], v[12:13], v[20:21]
    buffer_load_dwordx4 v5, s[40:43], s39 offen offset:1024 lds
    v_pk_fma_f32 v[206:207], v[206:207], v[14:15], v[22:23]
    v_cvt_pk_bf16_f32 v200, v200, v201
    v_cvt_pk_bf16_f32 v201, v202, v203
    v_cvt_pk_bf16_f32 v202, v204, v205
    v_cvt_pk_bf16_f32 v203, v206, v207
    v_xor_b32 v204, 224, v254
    ds_write_b128 v204, v[200:203]
    v_pk_fma_f32 v[208:209], v[208:209], v[8:9], v[16:17]
    v_pk_fma_f32 v[210:211], v[210:211], v[10:11], v[18:19]
    v_pk_fma_f32 v[212:213], v[212:213], v[12:13], v[20:21]
    v_pk_fma_f32 v[214:215], v[214:215], v[14:15], v[22:23]
    v_cvt_pk_bf16_f32 v208, v208, v209
    v_cvt_pk_bf16_f32 v209, v210, v211
    v_cvt_pk_bf16_f32 v210, v212, v213
    v_cvt_pk_bf16_f32 v211, v214, v215
    v_xor_b32 v212, 240, v254
    buffer_load_dwordx4 v5, s[40:43], s39 offen offset:2048 lds
    ds_write_b128 v212, v[208:211]
    v_and_b32 v8, 15, v1
    v_lshrrev_b32 v9, 4, v1
    v_xor_b32 v10, v8, v9
    v_lshlrev_b32 v10, 4, v10
    v_lshl_add_u32 v8, v9, 8, v10
    v_xor_b32 v9, 64, v8
    v_accvgpr_read_b32 v248, a212
    s_waitcnt vmcnt(12) lgkmcnt(0)
    s_barrier
    ds_read_b128 v[216:219], v8 offset:0
    ds_read_b128 v[220:223], v8 offset:16384
    ds_read_b128 v[224:227], v8 offset:32768
    ds_read_b128 v[228:231], v8 offset:49152
    s_waitcnt lgkmcnt(0)
    v_mfma_f32_16x16x32_bf16 v[24:27], a[0:3], v[216:219], 0
    ds_read_b128 v[232:235], v9 offset:1024
    v_mfma_f32_16x16x32_bf16 v[40:43], a[4:7], v[216:219], 0
    ds_read_b128 v[236:239], v9 offset:17408
    v_mfma_f32_16x16x32_bf16 v[56:59], v[216:219], a[8:11], 0
    ds_read_b128 v[240:243], v9 offset:33792
    v_mfma_f32_16x16x32_bf16 v[28:31], a[0:3], v[220:223], 0
    ds_read_b128 v[244:247], v9 offset:50176
    v_mfma_f32_16x16x32_bf16 v[44:47], a[4:7], v[220:223], 0
    ds_read_b64_tr_b16 a[48:49], v4 offset:49152
    v_mfma_f32_16x16x32_bf16 v[60:63], v[220:223], a[8:11], 0
    ds_read_b64_tr_b16 a[50:51], v4 offset:49664
    v_mfma_f32_16x16x32_bf16 v[32:35], a[0:3], v[224:227], 0
    ds_read_b64_tr_b16 a[52:53], v4 offset:50176
    v_mfma_f32_16x16x32_bf16 v[48:51], a[4:7], v[224:227], 0
    ds_read_b64_tr_b16 a[54:55], v4 offset:50688
    v_mfma_f32_16x16x32_bf16 v[64:67], v[224:227], a[8:11], 0
    ds_read_b64_tr_b16 a[56:57], v4 offset:51200
    v_mfma_f32_16x16x32_bf16 v[36:39], a[0:3], v[228:231], 0
    ds_read_b64_tr_b16 a[58:59], v4 offset:51712
    v_mfma_f32_16x16x32_bf16 v[52:55], a[4:7], v[228:231], 0
    ds_read_b64_tr_b16 a[60:61], v4 offset:61440
    v_mfma_f32_16x16x32_bf16 v[68:71], v[228:231], a[8:11], 0
    ds_read_b64_tr_b16 a[62:63], v4 offset:61952
    s_waitcnt lgkmcnt(0)
    v_mfma_f32_16x16x32_bf16 v[24:27], a[12:15], v[232:235], v[24:27]
    ds_read_b128 v[216:219], v8 offset:2048
    v_mfma_f32_16x16x32_bf16 v[40:43], a[16:19], v[232:235], v[40:43]
    ds_read_b128 v[220:223], v8 offset:18432
    v_mfma_f32_16x16x32_bf16 v[56:59], v[232:235], a[20:23], v[56:59]
    ds_read_b128 v[224:227], v8 offset:34816
    v_mfma_f32_16x16x32_bf16 v[28:31], a[12:15], v[236:239], v[28:31]
    ds_read_b128 v[228:231], v8 offset:51200
    v_mfma_f32_16x16x32_bf16 v[44:47], a[16:19], v[236:239], v[44:47]
    ds_read_b64_tr_b16 a[64:65], v4 offset:62464
    v_mfma_f32_16x16x32_bf16 v[60:63], v[236:239], a[20:23], v[60:63]
    ds_read_b64_tr_b16 a[66:67], v4 offset:62976
    v_mfma_f32_16x16x32_bf16 v[32:35], a[12:15], v[240:243], v[32:35]
    ds_read_b64_tr_b16 a[68:69], v4 offset:63488
    v_mfma_f32_16x16x32_bf16 v[48:51], a[16:19], v[240:243], v[48:51]
    ds_read_b64_tr_b16 a[70:71], v4 offset:64000
    v_mfma_f32_16x16x32_bf16 v[64:67], v[240:243], a[20:23], v[64:67]
    ds_read_b64_tr_b16 a[72:73], v6 offset:8192
    v_mfma_f32_16x16x32_bf16 v[36:39], a[12:15], v[244:247], v[36:39]
    ds_read_b64_tr_b16 a[74:75], v6 offset:8704
    v_mfma_f32_16x16x32_bf16 v[52:55], a[16:19], v[244:247], v[52:55]
    ds_read_b64_tr_b16 a[76:77], v6 offset:9216
    v_mfma_f32_16x16x32_bf16 v[68:71], v[244:247], a[20:23], v[68:71]
    ds_read_b64_tr_b16 a[78:79], v6 offset:9728
    s_waitcnt lgkmcnt(0)
    v_mfma_f32_16x16x32_bf16 v[24:27], a[24:27], v[216:219], v[24:27]
    ds_read_b128 v[232:235], v9 offset:3072
    v_mfma_f32_16x16x32_bf16 v[40:43], a[28:31], v[216:219], v[40:43]
    ds_read_b128 v[236:239], v9 offset:19456
    v_mfma_f32_16x16x32_bf16 v[56:59], v[216:219], a[32:35], v[56:59]
    ds_read_b128 v[240:243], v9 offset:35840
    v_mfma_f32_16x16x32_bf16 v[28:31], a[24:27], v[220:223], v[28:31]
    ds_read_b128 v[244:247], v9 offset:52224
    v_mfma_f32_16x16x32_bf16 v[44:47], a[28:31], v[220:223], v[44:47]
    ds_read_b64_tr_b16 a[80:81], v6 offset:10240
    v_mfma_f32_16x16x32_bf16 v[60:63], v[220:223], a[32:35], v[60:63]
    ds_read_b64_tr_b16 a[82:83], v6 offset:10752
    v_mfma_f32_16x16x32_bf16 v[32:35], a[24:27], v[224:227], v[32:35]
    ds_read_b64_tr_b16 a[84:85], v6 offset:20480
    v_mfma_f32_16x16x32_bf16 v[48:51], a[28:31], v[224:227], v[48:51]
    ds_read_b64_tr_b16 a[86:87], v6 offset:20992
    v_mfma_f32_16x16x32_bf16 v[64:67], v[224:227], a[32:35], v[64:67]
    ds_read_b64_tr_b16 a[88:89], v6 offset:21504
    v_mfma_f32_16x16x32_bf16 v[36:39], a[24:27], v[228:231], v[36:39]
    ds_read_b64_tr_b16 a[90:91], v6 offset:22016
    v_mfma_f32_16x16x32_bf16 v[52:55], a[28:31], v[228:231], v[52:55]
    ds_read_b64_tr_b16 a[92:93], v6 offset:22528
    v_mfma_f32_16x16x32_bf16 v[68:71], v[228:231], a[32:35], v[68:71]
    ds_read_b64_tr_b16 a[94:95], v6 offset:23040
    s_waitcnt lgkmcnt(0)
    s_barrier
    v_mfma_f32_16x16x32_bf16 v[24:27], a[36:39], v[232:235], v[24:27]
    ds_read_b128 v[216:219], v8 offset:4096
    v_mfma_f32_16x16x32_bf16 v[40:43], a[40:43], v[232:235], v[40:43]
    ds_read_b128 v[220:223], v8 offset:20480
    v_mfma_f32_16x16x32_bf16 v[56:59], v[232:235], a[44:47], v[56:59]
    ds_read_b128 v[224:227], v8 offset:36864
    v_mfma_f32_16x16x32_bf16 v[28:31], a[36:39], v[236:239], v[28:31]
    ds_read_b128 v[228:231], v8 offset:53248
    v_mfma_f32_16x16x32_bf16 v[44:47], a[40:43], v[236:239], v[44:47]
    s_xor_b32 s39, s93, 12
    s_mul_i32 s39, s39, 98304
    s_add_u32 m0, s100, 114688
    s_add_u32 s39, s39, s23
    buffer_load_dwordx4 v5, s[40:43], s39 offen offset:0 lds
    v_mfma_f32_16x16x32_bf16 v[60:63], v[236:239], a[44:47], v[60:63]
    buffer_load_dwordx4 v5, s[40:43], s39 offen offset:1024 lds
    v_mfma_f32_16x16x32_bf16 v[32:35], a[36:39], v[240:243], v[32:35]
    buffer_load_dwordx4 v5, s[40:43], s39 offen offset:2048 lds
    v_mfma_f32_16x16x32_bf16 v[48:51], a[40:43], v[240:243], v[48:51]
    s_xor_b32 s39, s93, 13
    s_mul_i32 s39, s39, 98304
    s_add_u32 m0, s100, 126976
    s_add_u32 s39, s39, s23
    buffer_load_dwordx4 v5, s[40:43], s39 offen offset:0 lds
    v_mfma_f32_16x16x32_bf16 v[64:67], v[240:243], a[44:47], v[64:67]
    buffer_load_dwordx4 v5, s[40:43], s39 offen offset:1024 lds
    v_mfma_f32_16x16x32_bf16 v[36:39], a[36:39], v[244:247], v[36:39]
    buffer_load_dwordx4 v5, s[40:43], s39 offen offset:2048 lds
    v_mfma_f32_16x16x32_bf16 v[52:55], a[40:43], v[244:247], v[52:55]
    v_mfma_f32_16x16x32_bf16 v[68:71], v[244:247], a[44:47], v[68:71]
    s_waitcnt lgkmcnt(0)
    v_mfma_f32_16x16x32_bf16 v[24:27], a[48:51], v[216:219], v[24:27]
    ds_read_b128 v[232:235], v9 offset:5120
    v_mfma_f32_16x16x32_bf16 v[40:43], a[52:55], v[216:219], v[40:43]
    ds_read_b128 v[236:239], v9 offset:21504
    v_mfma_f32_16x16x32_bf16 v[56:59], v[216:219], a[56:59], v[56:59]
    ds_read_b128 v[240:243], v9 offset:37888
    v_mfma_f32_16x16x32_bf16 v[28:31], a[48:51], v[220:223], v[28:31]
    ds_read_b128 v[244:247], v9 offset:54272
    v_mfma_f32_16x16x32_bf16 v[44:47], a[52:55], v[220:223], v[44:47]
    s_xor_b32 s39, s93, 14
    s_mul_i32 s39, s39, 98304
    s_add_u32 m0, s100, 139264
    s_add_u32 s39, s39, s23
    buffer_load_dwordx4 v5, s[40:43], s39 offen offset:0 lds
    v_mfma_f32_16x16x32_bf16 v[60:63], v[220:223], a[56:59], v[60:63]
    buffer_load_dwordx4 v5, s[40:43], s39 offen offset:1024 lds
    v_mfma_f32_16x16x32_bf16 v[32:35], a[48:51], v[224:227], v[32:35]
    buffer_load_dwordx4 v5, s[40:43], s39 offen offset:2048 lds
    v_mfma_f32_16x16x32_bf16 v[48:51], a[52:55], v[224:227], v[48:51]
    s_xor_b32 s39, s93, 15
    s_mul_i32 s39, s39, 98304
    s_add_u32 m0, s100, 151552
    s_add_u32 s39, s39, s23
    buffer_load_dwordx4 v5, s[40:43], s39 offen offset:0 lds
    v_mfma_f32_16x16x32_bf16 v[64:67], v[224:227], a[56:59], v[64:67]
    buffer_load_dwordx4 v5, s[40:43], s39 offen offset:1024 lds
    v_mfma_f32_16x16x32_bf16 v[36:39], a[48:51], v[228:231], v[36:39]
    buffer_load_dwordx4 v5, s[40:43], s39 offen offset:2048 lds
    v_mfma_f32_16x16x32_bf16 v[52:55], a[52:55], v[228:231], v[52:55]
    v_mfma_f32_16x16x32_bf16 v[68:71], v[228:231], a[56:59], v[68:71]
    s_waitcnt lgkmcnt(0)
    s_waitcnt vmcnt(12)
    s_barrier
    v_mfma_f32_16x16x32_bf16 v[24:27], a[60:63], v[232:235], v[24:27]
    ds_read_b128 v[216:219], v8 offset:6144
    v_mfma_f32_16x16x32_bf16 v[40:43], a[64:67], v[232:235], v[40:43]
    ds_read_b128 v[220:223], v8 offset:22528
    v_mfma_f32_16x16x32_bf16 v[56:59], v[232:235], a[68:71], v[56:59]
    ds_read_b128 v[224:227], v8 offset:38912
    v_mfma_f32_16x16x32_bf16 v[28:31], a[60:63], v[236:239], v[28:31]
    ds_read_b128 v[228:231], v8 offset:55296
    v_mfma_f32_16x16x32_bf16 v[44:47], a[64:67], v[236:239], v[44:47]
    ds_read_b64_tr_b16 a[96:97], v4 offset:0
    v_mfma_f32_16x16x32_bf16 v[60:63], v[236:239], a[68:71], v[60:63]
    ds_read_b64_tr_b16 a[98:99], v4 offset:512
    v_mfma_f32_16x16x32_bf16 v[32:35], a[60:63], v[240:243], v[32:35]
    ds_read_b64_tr_b16 a[100:101], v4 offset:1024
    v_mfma_f32_16x16x32_bf16 v[48:51], a[64:67], v[240:243], v[48:51]
    ds_read_b64_tr_b16 a[102:103], v4 offset:1536
    v_mfma_f32_16x16x32_bf16 v[64:67], v[240:243], a[68:71], v[64:67]
    ds_read_b64_tr_b16 a[104:105], v4 offset:2048
    v_mfma_f32_16x16x32_bf16 v[36:39], a[60:63], v[244:247], v[36:39]
    ds_read_b64_tr_b16 a[106:107], v4 offset:2560
    v_mfma_f32_16x16x32_bf16 v[52:55], a[64:67], v[244:247], v[52:55]
    v_mfma_f32_16x16x32_bf16 v[68:71], v[244:247], a[68:71], v[68:71]
    s_waitcnt lgkmcnt(0)
    v_mfma_f32_16x16x32_bf16 v[24:27], a[72:75], v[216:219], v[24:27]
    ds_read_b128 v[232:235], v9 offset:7168
    v_mfma_f32_16x16x32_bf16 v[40:43], a[76:79], v[216:219], v[40:43]
    ds_read_b128 v[236:239], v9 offset:23552
    v_mfma_f32_16x16x32_bf16 v[56:59], v[216:219], a[80:83], v[56:59]
    ds_read_b128 v[240:243], v9 offset:39936
    v_mfma_f32_16x16x32_bf16 v[28:31], a[72:75], v[220:223], v[28:31]
    ds_read_b128 v[244:247], v9 offset:56320
    v_mfma_f32_16x16x32_bf16 v[44:47], a[76:79], v[220:223], v[44:47]
    ds_read_b64_tr_b16 a[108:109], v4 offset:12288
    v_mfma_f32_16x16x32_bf16 v[60:63], v[220:223], a[80:83], v[60:63]
    ds_read_b64_tr_b16 a[110:111], v4 offset:12800
    v_mfma_f32_16x16x32_bf16 v[32:35], a[72:75], v[224:227], v[32:35]
    ds_read_b64_tr_b16 a[112:113], v4 offset:13312
    v_mfma_f32_16x16x32_bf16 v[48:51], a[76:79], v[224:227], v[48:51]
    ds_read_b64_tr_b16 a[114:115], v4 offset:13824
    v_mfma_f32_16x16x32_bf16 v[64:67], v[224:227], a[80:83], v[64:67]
    ds_read_b64_tr_b16 a[116:117], v4 offset:14336
    v_mfma_f32_16x16x32_bf16 v[36:39], a[72:75], v[228:231], v[36:39]
    ds_read_b64_tr_b16 a[118:119], v4 offset:14848
    v_mfma_f32_16x16x32_bf16 v[52:55], a[76:79], v[228:231], v[52:55]
    v_mfma_f32_16x16x32_bf16 v[68:71], v[228:231], a[80:83], v[68:71]
    s_waitcnt lgkmcnt(0)
    v_mfma_f32_16x16x32_bf16 v[24:27], a[84:87], v[232:235], v[24:27]
    ds_read_b128 v[216:219], v8 offset:8192
    v_mfma_f32_16x16x32_bf16 v[40:43], a[88:91], v[232:235], v[40:43]
    ds_read_b128 v[220:223], v8 offset:24576
    v_mfma_f32_16x16x32_bf16 v[56:59], v[232:235], a[92:95], v[56:59]
    ds_read_b128 v[224:227], v8 offset:40960
    v_mfma_f32_16x16x32_bf16 v[28:31], a[84:87], v[236:239], v[28:31]
    ds_read_b128 v[228:231], v8 offset:57344
    v_mfma_f32_16x16x32_bf16 v[44:47], a[88:91], v[236:239], v[44:47]
    ds_read_b64_tr_b16 a[120:121], v4 offset:24576
    v_mfma_f32_16x16x32_bf16 v[60:63], v[236:239], a[92:95], v[60:63]
    ds_read_b64_tr_b16 a[122:123], v4 offset:25088
    v_mfma_f32_16x16x32_bf16 v[32:35], a[84:87], v[240:243], v[32:35]
    ds_read_b64_tr_b16 a[124:125], v4 offset:25600
    v_mfma_f32_16x16x32_bf16 v[48:51], a[88:91], v[240:243], v[48:51]
    ds_read_b64_tr_b16 a[126:127], v4 offset:26112
    v_mfma_f32_16x16x32_bf16 v[64:67], v[240:243], a[92:95], v[64:67]
    ds_read_b64_tr_b16 a[128:129], v4 offset:26624
    v_mfma_f32_16x16x32_bf16 v[36:39], a[84:87], v[244:247], v[36:39]
    ds_read_b64_tr_b16 a[130:131], v4 offset:27136
    v_mfma_f32_16x16x32_bf16 v[52:55], a[88:91], v[244:247], v[52:55]
    v_mfma_f32_16x16x32_bf16 v[68:71], v[244:247], a[92:95], v[68:71]
    s_waitcnt lgkmcnt(0)
    v_mfma_f32_16x16x32_bf16 v[24:27], a[96:99], v[216:219], v[24:27]
    ds_read_b128 v[232:235], v9 offset:9216
    v_mfma_f32_16x16x32_bf16 v[40:43], a[100:103], v[216:219], v[40:43]
    ds_read_b128 v[236:239], v9 offset:25600
    v_mfma_f32_16x16x32_bf16 v[56:59], v[216:219], a[104:107], v[56:59]
    ds_read_b128 v[240:243], v9 offset:41984
    v_mfma_f32_16x16x32_bf16 v[28:31], a[96:99], v[220:223], v[28:31]
    ds_read_b128 v[244:247], v9 offset:58368
    v_mfma_f32_16x16x32_bf16 v[44:47], a[100:103], v[220:223], v[44:47]
    ds_read_b64_tr_b16 a[132:133], v4 offset:36864
    v_mfma_f32_16x16x32_bf16 v[60:63], v[220:223], a[104:107], v[60:63]
    ds_read_b64_tr_b16 a[134:135], v4 offset:37376
    v_mfma_f32_16x16x32_bf16 v[32:35], a[96:99], v[224:227], v[32:35]
    ds_read_b64_tr_b16 a[136:137], v4 offset:37888
    v_mfma_f32_16x16x32_bf16 v[48:51], a[100:103], v[224:227], v[48:51]
    ds_read_b64_tr_b16 a[138:139], v4 offset:38400
    v_mfma_f32_16x16x32_bf16 v[64:67], v[224:227], a[104:107], v[64:67]
    ds_read_b64_tr_b16 a[140:141], v4 offset:38912
    v_mfma_f32_16x16x32_bf16 v[36:39], a[96:99], v[228:231], v[36:39]
    ds_read_b64_tr_b16 a[142:143], v4 offset:39424
    v_mfma_f32_16x16x32_bf16 v[52:55], a[100:103], v[228:231], v[52:55]
    v_mfma_f32_16x16x32_bf16 v[68:71], v[228:231], a[104:107], v[68:71]
    s_waitcnt lgkmcnt(0)
    v_mfma_f32_16x16x32_bf16 v[24:27], a[108:111], v[232:235], v[24:27]
    ds_read_b128 v[216:219], v8 offset:10240
    v_mfma_f32_16x16x32_bf16 v[40:43], a[112:115], v[232:235], v[40:43]
    ds_read_b128 v[220:223], v8 offset:26624
    v_mfma_f32_16x16x32_bf16 v[56:59], v[232:235], a[116:119], v[56:59]
    ds_read_b128 v[224:227], v8 offset:43008
    v_mfma_f32_16x16x32_bf16 v[28:31], a[108:111], v[236:239], v[28:31]
    ds_read_b128 v[228:231], v8 offset:59392
    v_mfma_f32_16x16x32_bf16 v[44:47], a[112:115], v[236:239], v[44:47]
    v_mfma_f32_16x16x32_bf16 v[60:63], v[236:239], a[116:119], v[60:63]
    v_mfma_f32_16x16x32_bf16 v[32:35], a[108:111], v[240:243], v[32:35]
    v_mfma_f32_16x16x32_bf16 v[48:51], a[112:115], v[240:243], v[48:51]
    v_mfma_f32_16x16x32_bf16 v[64:67], v[240:243], a[116:119], v[64:67]
    v_mfma_f32_16x16x32_bf16 v[36:39], a[108:111], v[244:247], v[36:39]
    v_mfma_f32_16x16x32_bf16 v[52:55], a[112:115], v[244:247], v[52:55]
    v_mfma_f32_16x16x32_bf16 v[68:71], v[244:247], a[116:119], v[68:71]
    s_waitcnt lgkmcnt(0)
    s_waitcnt vmcnt(0)
    s_barrier
    v_mfma_f32_16x16x32_bf16 v[24:27], a[120:123], v[216:219], v[24:27]
    ds_read_b128 v[232:235], v9 offset:11264
    v_mfma_f32_16x16x32_bf16 v[40:43], a[124:127], v[216:219], v[40:43]
    ds_read_b128 v[236:239], v9 offset:27648
    v_mfma_f32_16x16x32_bf16 v[56:59], v[216:219], a[128:131], v[56:59]
    ds_read_b128 v[240:243], v9 offset:44032
    v_mfma_f32_16x16x32_bf16 v[28:31], a[120:123], v[220:223], v[28:31]
    ds_read_b128 v[244:247], v9 offset:60416
    v_mfma_f32_16x16x32_bf16 v[44:47], a[124:127], v[220:223], v[44:47]
    ds_read_b64_tr_b16 a[144:145], v4 offset:49152
    v_mfma_f32_16x16x32_bf16 v[60:63], v[220:223], a[128:131], v[60:63]
    ds_read_b64_tr_b16 a[146:147], v4 offset:49664
    v_mfma_f32_16x16x32_bf16 v[32:35], a[120:123], v[224:227], v[32:35]
    ds_read_b64_tr_b16 a[148:149], v4 offset:50176
    v_mfma_f32_16x16x32_bf16 v[48:51], a[124:127], v[224:227], v[48:51]
    ds_read_b64_tr_b16 a[150:151], v4 offset:50688
    v_mfma_f32_16x16x32_bf16 v[64:67], v[224:227], a[128:131], v[64:67]
    ds_read_b64_tr_b16 a[152:153], v4 offset:51200
    v_mfma_f32_16x16x32_bf16 v[36:39], a[120:123], v[228:231], v[36:39]
    ds_read_b64_tr_b16 a[154:155], v4 offset:51712
    v_mfma_f32_16x16x32_bf16 v[52:55], a[124:127], v[228:231], v[52:55]
    v_mfma_f32_16x16x32_bf16 v[68:71], v[228:231], a[128:131], v[68:71]
    s_waitcnt lgkmcnt(0)
    v_mfma_f32_16x16x32_bf16 v[24:27], a[132:135], v[232:235], v[24:27]
    ds_read_b128 v[216:219], v8 offset:12288
    v_mfma_f32_16x16x32_bf16 v[40:43], a[136:139], v[232:235], v[40:43]
    ds_read_b128 v[220:223], v8 offset:28672
    v_mfma_f32_16x16x32_bf16 v[56:59], v[232:235], a[140:143], v[56:59]
    ds_read_b128 v[224:227], v8 offset:45056
    v_mfma_f32_16x16x32_bf16 v[28:31], a[132:135], v[236:239], v[28:31]
    ds_read_b128 v[228:231], v8 offset:61440
    v_mfma_f32_16x16x32_bf16 v[44:47], a[136:139], v[236:239], v[44:47]
    ds_read_b64_tr_b16 a[156:157], v4 offset:61440
    v_mfma_f32_16x16x32_bf16 v[60:63], v[236:239], a[140:143], v[60:63]
    ds_read_b64_tr_b16 a[158:159], v4 offset:61952
    v_mfma_f32_16x16x32_bf16 v[32:35], a[132:135], v[240:243], v[32:35]
    ds_read_b64_tr_b16 a[160:161], v4 offset:62464
    v_mfma_f32_16x16x32_bf16 v[48:51], a[136:139], v[240:243], v[48:51]
    ds_read_b64_tr_b16 a[162:163], v4 offset:62976
    v_mfma_f32_16x16x32_bf16 v[64:67], v[240:243], a[140:143], v[64:67]
    ds_read_b64_tr_b16 a[164:165], v4 offset:63488
    v_mfma_f32_16x16x32_bf16 v[36:39], a[132:135], v[244:247], v[36:39]
    ds_read_b64_tr_b16 a[166:167], v4 offset:64000
    v_mfma_f32_16x16x32_bf16 v[52:55], a[136:139], v[244:247], v[52:55]
    v_mfma_f32_16x16x32_bf16 v[68:71], v[244:247], a[140:143], v[68:71]
    s_waitcnt lgkmcnt(0)
    v_mfma_f32_16x16x32_bf16 v[24:27], a[144:147], v[216:219], v[24:27]
    ds_read_b128 v[232:235], v9 offset:13312
    v_mfma_f32_16x16x32_bf16 v[40:43], a[148:151], v[216:219], v[40:43]
    ds_read_b128 v[236:239], v9 offset:29696
    v_mfma_f32_16x16x32_bf16 v[56:59], v[216:219], a[152:155], v[56:59]
    ds_read_b128 v[240:243], v9 offset:46080
    v_mfma_f32_16x16x32_bf16 v[28:31], a[144:147], v[220:223], v[28:31]
    ds_read_b128 v[244:247], v9 offset:62464
    v_mfma_f32_16x16x32_bf16 v[44:47], a[148:151], v[220:223], v[44:47]
    ds_read_b64_tr_b16 a[168:169], v6 offset:8192
    v_mfma_f32_16x16x32_bf16 v[60:63], v[220:223], a[152:155], v[60:63]
    ds_read_b64_tr_b16 a[170:171], v6 offset:8704
    v_mfma_f32_16x16x32_bf16 v[32:35], a[144:147], v[224:227], v[32:35]
    ds_read_b64_tr_b16 a[172:173], v6 offset:9216
    v_mfma_f32_16x16x32_bf16 v[48:51], a[148:151], v[224:227], v[48:51]
    ds_read_b64_tr_b16 a[174:175], v6 offset:9728
    v_mfma_f32_16x16x32_bf16 v[64:67], v[224:227], a[152:155], v[64:67]
    ds_read_b64_tr_b16 a[176:177], v6 offset:10240
    v_mfma_f32_16x16x32_bf16 v[36:39], a[144:147], v[228:231], v[36:39]
    ds_read_b64_tr_b16 a[178:179], v6 offset:10752
    v_mfma_f32_16x16x32_bf16 v[52:55], a[148:151], v[228:231], v[52:55]
    v_mfma_f32_16x16x32_bf16 v[68:71], v[228:231], a[152:155], v[68:71]
    s_waitcnt lgkmcnt(0)
    v_mfma_f32_16x16x32_bf16 v[24:27], a[156:159], v[232:235], v[24:27]
    ds_read_b128 v[216:219], v8 offset:14336
    v_mfma_f32_16x16x32_bf16 v[40:43], a[160:163], v[232:235], v[40:43]
    ds_read_b128 v[220:223], v8 offset:30720
    v_mfma_f32_16x16x32_bf16 v[56:59], v[232:235], a[164:167], v[56:59]
    ds_read_b128 v[224:227], v8 offset:47104
    v_mfma_f32_16x16x32_bf16 v[28:31], a[156:159], v[236:239], v[28:31]
    ds_read_b128 v[228:231], v8 offset:63488
    v_mfma_f32_16x16x32_bf16 v[44:47], a[160:163], v[236:239], v[44:47]
    ds_read_b64_tr_b16 a[180:181], v6 offset:20480
    v_mfma_f32_16x16x32_bf16 v[60:63], v[236:239], a[164:167], v[60:63]
    ds_read_b64_tr_b16 a[182:183], v6 offset:20992
    v_mfma_f32_16x16x32_bf16 v[32:35], a[156:159], v[240:243], v[32:35]
    ds_read_b64_tr_b16 a[184:185], v6 offset:21504
    v_mfma_f32_16x16x32_bf16 v[48:51], a[160:163], v[240:243], v[48:51]
    ds_read_b64_tr_b16 a[186:187], v6 offset:22016
    v_mfma_f32_16x16x32_bf16 v[64:67], v[240:243], a[164:167], v[64:67]
    ds_read_b64_tr_b16 a[188:189], v6 offset:22528
    v_mfma_f32_16x16x32_bf16 v[36:39], a[156:159], v[244:247], v[36:39]
    ds_read_b64_tr_b16 a[190:191], v6 offset:23040
    v_mfma_f32_16x16x32_bf16 v[52:55], a[160:163], v[244:247], v[52:55]
    v_mfma_f32_16x16x32_bf16 v[68:71], v[244:247], a[164:167], v[68:71]
    s_waitcnt lgkmcnt(0)
    v_mfma_f32_16x16x32_bf16 v[24:27], a[168:171], v[216:219], v[24:27]
    ds_read_b128 v[232:235], v9 offset:15360
    v_mfma_f32_16x16x32_bf16 v[40:43], a[172:175], v[216:219], v[40:43]
    ds_read_b128 v[236:239], v9 offset:31744
    v_mfma_f32_16x16x32_bf16 v[56:59], v[216:219], a[176:179], v[56:59]
    ds_read_b128 v[240:243], v9 offset:48128
    v_mfma_f32_16x16x32_bf16 v[28:31], a[168:171], v[220:223], v[28:31]
    ds_read_b128 v[244:247], v9 offset:64512
    v_mfma_f32_16x16x32_bf16 v[44:47], a[172:175], v[220:223], v[44:47]
    v_mfma_f32_16x16x32_bf16 v[60:63], v[220:223], a[176:179], v[60:63]
    v_mfma_f32_16x16x32_bf16 v[32:35], a[168:171], v[224:227], v[32:35]
    v_mfma_f32_16x16x32_bf16 v[48:51], a[172:175], v[224:227], v[48:51]
    v_mfma_f32_16x16x32_bf16 v[64:67], v[224:227], a[176:179], v[64:67]
    v_mfma_f32_16x16x32_bf16 v[36:39], a[168:171], v[228:231], v[36:39]
    v_mfma_f32_16x16x32_bf16 v[52:55], a[172:175], v[228:231], v[52:55]
    v_mfma_f32_16x16x32_bf16 v[68:71], v[228:231], a[176:179], v[68:71]
    s_waitcnt lgkmcnt(0)
    v_mfma_f32_16x16x32_bf16 v[24:27], a[180:183], v[232:235], v[24:27]
    v_mfma_f32_16x16x32_bf16 v[40:43], a[184:187], v[232:235], v[40:43]
    v_mfma_f32_16x16x32_bf16 v[56:59], v[232:235], a[188:191], v[56:59]
    v_mfma_f32_16x16x32_bf16 v[28:31], a[180:183], v[236:239], v[28:31]
    v_mfma_f32_16x16x32_bf16 v[44:47], a[184:187], v[236:239], v[44:47]
    v_mfma_f32_16x16x32_bf16 v[60:63], v[236:239], a[188:191], v[60:63]
    v_mfma_f32_16x16x32_bf16 v[32:35], a[180:183], v[240:243], v[32:35]
    v_mfma_f32_16x16x32_bf16 v[48:51], a[184:187], v[240:243], v[48:51]
    v_mfma_f32_16x16x32_bf16 v[64:67], v[240:243], a[188:191], v[64:67]
    v_mfma_f32_16x16x32_bf16 v[36:39], a[180:183], v[244:247], v[36:39]
    v_mfma_f32_16x16x32_bf16 v[52:55], a[184:187], v[244:247], v[52:55]
    v_mfma_f32_16x16x32_bf16 v[68:71], v[244:247], a[188:191], v[68:71]
    v_lshrrev_b32 v221, 1, v1
    v_lshlrev_b32 v220, 3, v221
    s_lshl_b32 s38, s3, 8
    buffer_load_dwordx2 v[200:201], v220, s[56:59], s38 offen
    s_lshl_b32 s40, s22, 16
    s_lshl_b32 s41, s20, 11
    s_add_u32 s40, s40, s41
    s_add_u32 s40, s40, 3735552
    s_lshl_b32 s42, s22, 17
    s_lshl_b32 s41, s20, 12
    s_add_u32 s42, s42, s41
    s_add_u32 s42, s42, 5832704
    v_mov_b32 v12, 0x3eb8aa3b
    v_mov_b32 v13, 0x3eb8aa3b
    v_cvt_pk_bf16_f32 v96, v40, v41
    v_cvt_pk_bf16_f32 v97, v42, v43
    v_cvt_pk_bf16_f32 v98, v44, v45
    v_cvt_pk_bf16_f32 v99, v46, v47
    v_cvt_pk_bf16_f32 v100, v48, v49
    v_cvt_pk_bf16_f32 v101, v50, v51
    v_cvt_pk_bf16_f32 v102, v52, v53
    v_cvt_pk_bf16_f32 v103, v54, v55
    v_permlane16_swap_b32 v96, v98
    v_permlane16_swap_b32 v97, v99
    buffer_store_dwordx4 v[96:99], v2, s[24:27], s42 offen offset:0 sc1
    s_nop 0
    v_permlane16_swap_b32 v100, v102
    v_permlane16_swap_b32 v101, v103
    buffer_store_dwordx4 v[100:103], v2, s[24:27], s42 offen offset:2048 sc1
    v_cvt_pk_bf16_f32 v104, v56, v57
    v_cvt_pk_bf16_f32 v105, v58, v59
    v_cvt_pk_bf16_f32 v106, v60, v61
    v_cvt_pk_bf16_f32 v107, v62, v63
    v_cvt_pk_bf16_f32 v108, v64, v65
    v_cvt_pk_bf16_f32 v109, v66, v67
    v_cvt_pk_bf16_f32 v110, v68, v69
    v_cvt_pk_bf16_f32 v111, v70, v71
    v_permlane32_swap_b32 v104, v106
    v_permlane32_swap_b32 v105, v107
    buffer_store_dwordx4 v[104:107], v2, s[24:27], s42 offen offset:1024 sc1
    s_nop 0
    v_permlane32_swap_b32 v108, v110
    v_permlane32_swap_b32 v109, v111
    buffer_store_dwordx4 v[108:111], v2, s[24:27], s42 offen offset:3072 sc1
    v_pk_mul_f32 v[24:25], v[12:13], v[24:25]
    v_pk_mul_f32 v[26:27], v[12:13], v[26:27]
    v_cvt_pk_bf16_f32 v88, v24, v25
    v_cvt_pk_bf16_f32 v89, v26, v27
    v_pk_mul_f32 v[28:29], v[12:13], v[28:29]
    v_pk_mul_f32 v[30:31], v[12:13], v[30:31]
    v_cvt_pk_bf16_f32 v90, v28, v29
    v_cvt_pk_bf16_f32 v91, v30, v31
    v_pk_mul_f32 v[32:33], v[12:13], v[32:33]
    v_pk_mul_f32 v[34:35], v[12:13], v[34:35]
    v_cvt_pk_bf16_f32 v92, v32, v33
    v_cvt_pk_bf16_f32 v93, v34, v35
    v_pk_mul_f32 v[36:37], v[12:13], v[36:37]
    v_pk_mul_f32 v[38:39], v[12:13], v[38:39]
    v_cvt_pk_bf16_f32 v94, v36, v37
    v_cvt_pk_bf16_f32 v95, v38, v39
    v_permlane16_swap_b32 v88, v90
    v_permlane16_swap_b32 v89, v91
    buffer_store_dwordx4 v[88:91], v2, s[24:27], s40 offen offset:0 sc1
    s_nop 0
    v_permlane16_swap_b32 v92, v94
    v_permlane16_swap_b32 v93, v95
    buffer_store_dwordx4 v[92:95], v2, s[24:27], s40 offen offset:1024 sc1
    s_mul_i32 s38, s21, 32
    s_add_u32 s38, s38, s20
    s_lshl_b32 s38, s38, 8
    s_add_u32 s38, s38, 28114944
    v_mov_b32 v6, 0
    v_mov_b32 v7, s98
    s_cmp_lg_u32 s3, 0
    s_waitcnt vmcnt(0) lgkmcnt(0)
    s_barrier
    s_cbranch_scc1 L_sig0
    s_mov_b64 exec, 1
    buffer_store_dword v7, v6, s[24:27], s38 offen sc1
    s_mov_b64 exec, -1
L_sig0:
    s_cmp_lt_u32 s2, 32
    s_cselect_b32 s4, 0, 32
    s_cselect_b32 s5, 0, 1
    s_cmp_ge_u32 s2, 144
    s_cselect_b32 s4, 144, s4
    s_cselect_b32 s5, 2, s5
    s_sub_u32 s4, s2, s4
    s_lshr_b32 s6, s4, 3
    s_and_b32 s7, s4, 7
    s_mul_i32 s9, s4, 2341
    s_lshr_b32 s9, s9, 16
    s_mul_i32 s10, s9, 28
    s_sub_u32 s10, s4, s10
    s_mov_b32 s8, 1024
    s_cmp_eq_u32 s5, 1
    s_cselect_b32 s6, s9, s6
    s_cselect_b32 s7, s10, s7
    s_cselect_b32 s8, 3584, s8
    s_lshl_b32 s9, s6, 2
    s_add_u32 s9, s9, s3
    s_lshl_b32 s14, s3, 12
    s_add_u32 s14, s14, 133120
    v_and_b32 v248, 15, v1
    v_lshrrev_b32 v249, 4, v1
    v_lshrrev_b32 v250, 2, v248
    v_and_b32 v248, 3, v248
    v_lshlrev_b32 v248, 3, v248
    v_lshl_add_u32 v248, v250, 7, v248
    v_add_u32 v248, s14, v248
    v_and_b32 v250, 1, v249
    v_lshrrev_b32 v249, 1, v249
    s_cmp_eq_u32 s5, 1
    s_cbranch_scc1 L_rl_c
    v_lshl_add_u32 v248, v250, 5, v248
    s_lshr_b32 s13, s5, 1
    s_add_u32 s23, s13, 9
    v_lshlrev_b32 v249, s23, v249
    v_add_u32 v160, v248, v249
    v_add_u32 v161, 64, v160
    v_add_u32 v162, 0x800, v160
    v_add_u32 v163, 0x840, v160
    s_lshr_b32 s23, 1024, s13
    s_cmp_eq_u32 s5, 0
    s_cselect_b32 s15, 32, 112
    s_mov_b32 s10, 26279936
    s_cselect_b32 s10, 12124160, s10
    s_lshl_b32 s11, s7, 1
    s_mul_i32 s11, s11, s15
    s_lshl_b32 s13, s9, 1
    s_add_u32 s11, s11, s13
    s_lshl_b32 s11, s11, 10
    s_add_u32 s16, s11, s10
    s_lshl_b32 s15, s15, 10
    s_add_u32 s17, s16, s15
    s_add_u32 s18, s16, 1024
    s_add_u32 s19, s17, 1024
    s_branch L_rl_d
L_rl_c:
    v_lshl_add_u32 v248, v249, 11, v248
    v_lshl_add_u32 v160, v250, 9, v248
    v_add_u32 v161, 32, v160
    v_add_u32 v162, 64, v160
    v_add_u32 v163, 0x60, v160
    s_mov_b32 s23, 1024
    s_lshl_b32 s15, s7, 2
    s_mul_i32 s13, s9, 7
    s_mul_i32 s10, s15, 9363
    s_lshr_b32 s10, s10, 16
    s_mul_i32 s11, s10, 105
    s_add_u32 s11, s11, s15
    s_add_u32 s11, s11, s13
    s_lshl_b32 s11, s11, 10
    s_add_u32 s16, s11, 17104896
    s_add_u32 s15, s15, 1
    s_mul_i32 s10, s15, 9363
    s_lshr_b32 s10, s10, 16
    s_mul_i32 s11, s10, 105
    s_add_u32 s11, s11, s15
    s_add_u32 s11, s11, s13
    s_lshl_b32 s11, s11, 10
    s_add_u32 s17, s11, 17104896
    s_add_u32 s15, s15, 1
    s_mul_i32 s10, s15, 9363
    s_lshr_b32 s10, s10, 16
    s_mul_i32 s11, s10, 105
    s_add_u32 s11, s11, s15
    s_add_u32 s11, s11, s13
    s_lshl_b32 s11, s11, 10
    s_add_u32 s18, s11, 17104896
    s_add_u32 s15, s15, 1
    s_mul_i32 s10, s15, 9363
    s_lshr_b32 s10, s10, 16
    s_mul_i32 s11, s10, 105
    s_add_u32 s11, s11, s15
    s_add_u32 s11, s11, s13
    s_lshl_b32 s11, s11, 10
    s_add_u32 s19, s11, 17104896
    s_add_u32 s15, s15, 1
L_rl_d:
    v_add_u32 v164, s23, v160
    v_add_u32 v165, s23, v161
    v_add_u32 v166, s23, v162
    v_add_u32 v167, s23, v163
    v_add_u32 v220, s14, v2
    s_lshr_b32 s99, s37, 2
    s_lshl_b32 s99, s99, 3
    s_add_u32 s99, s99, s36
    s_lshl_b32 s99, s99, 2
    s_and_b32 s38, s37, 3
    s_add_u32 s99, s99, s38
    s_add_u32 s99, s99, 64
    v_mul_u32_u24 v221, 24576, v221
    v_and_b32 v249, 1, v1
    v_lshl_add_u32 v221, v249, 4, v221
    s_mul_i32 s15, s3, 786432
    s_lshl_b32 s4, s99, 5
    s_add_u32 s15, s15, s4
    s_cmp_ge_u32 s37, 16
    s_cselect_b32 s15, 0x7f000000, s15
    s_lshl_b32 s20, s2, 1
    s_lshr_b32 s21, s3, 1
    s_add_u32 s20, s20, s21
    s_mul_i32 s20, s20, 6144
    s_and_b32 s21, s3, 1
    s_lshl_b32 s21, s21, 11
    s_add_u32 s20, s20, s21
    s_add_u32 s20, s20, 2048
    s_mov_b64 s[8:9], s[52:53]
    s_mov_b32 s10, s54
    s_mov_b32 s11, 0x00020000
    v_accvgpr_read_b32 v222, a212
    s_mov_b64 s[4:5], s[44:45]
    s_mov_b32 s6, s46
    s_mov_b32 s7, 0x00020000
    v_lshlrev_b32 v202, 16, v200
    v_and_b32 v203, 0xffff0000, v200
    v_lshlrev_b32 v204, 16, v201
    v_and_b32 v205, 0xffff0000, v201
    v_mul_f32 v208, 0xbfb8aa3b, v202
    v_mul_f32 v209, 0xbfb8aa3b, v203
    v_mul_f32 v210, 0xbfb8aa3b, v204
    v_mul_f32 v211, 0xbfb8aa3b, v205
    v_exp_f32 v208, v208
    v_exp_f32 v209, v209
    v_exp_f32 v210, v210
    v_exp_f32 v211, v211
    s_nop 0
    v_add_f32 v208, 1.0, v208
    v_add_f32 v209, 1.0, v209
    v_add_f32 v210, 1.0, v210
    v_add_f32 v211, 1.0, v211
    v_rcp_f32 v208, v208
    v_rcp_f32 v209, v209
    v_rcp_f32 v210, v210
    v_rcp_f32 v211, v211
    s_nop 0
    v_mul_f32 v202, v202, v208
    v_mul_f32 v203, v203, v209
    v_mul_f32 v204, v204, v210
    v_mul_f32 v205, v205, v211
    v_cvt_pk_bf16_f32 v202, v202, v202
    v_and_b32 v202, 0xffff0000, v202
    v_cvt_pk_bf16_f32 v203, v203, v203
    v_and_b32 v203, 0xffff0000, v203
    v_cvt_pk_bf16_f32 v204, v204, v204
    v_and_b32 v204, 0xffff0000, v204
    v_cvt_pk_bf16_f32 v205, v205, v205
    v_and_b32 v205, 0xffff0000, v205
    s_lshl_b32 s40, s36, 2
    s_and_b32 s42, s37, 3
    s_add_u32 s40, s40, s42
    s_lshr_b32 s54, s37, 2
    s_lshl_b32 s41, s54, 2
    s_add_u32 s41, s41, s3
    s_lshl_b32 s42, s40, 16
    s_lshl_b32 s43, s41, 11
    s_add_u32 s42, s42, s43
    s_add_u32 s42, s42, 3735552
    s_lshl_b32 s44, s40, 17
    s_lshl_b32 s45, s3, 10
    s_add_u32 s47, s44, 5832704
    s_add_u32 s44, s47, s45
    s_lshl_b32 s46, s41, 16
    s_lshl_b32 s43, s40, 10
    s_add_u32 s46, s46, s43
    s_add_u32 s46, s46, 10027008
    s_lshr_b32 s38, s3, 1
    s_mul_i32 s38, s38, 2080
    s_and_b32 s39, s45, 1024
    s_add_u32 s13, s38, s39
    s_mov_b32 m0, s13
    v_and_b32 v3, 15, v1
    v_lshlrev_b32 v3, 4, v3
    v_lshrrev_b32 v4, 5, v1
    v_lshl_add_u32 v3, v4, 8, v3
    v_add_u32 v3, 0x400, v3
    v_add_u32 v156, 0x200, v3
    s_mov_b32 s48, 0x0000ffff
    s_mov_b32 s49, 0x0000ffff
    v_and_b32 v8, 27, v1
    v_cmp_eq_u32 vcc, 16, v8
    v_mov_b32 v9, 0x800
    v_mov_b32 v10, 0x810
    v_cndmask_b32 v9, v10, v9, vcc
    v_cndmask_b32 v3, v9, v3, s[48:49]
    v_cndmask_b32 v156, v9, v156, s[48:49]
    v_add_u32 v4, 0x10000, v2
    v_add_u32 v5, 0x10000, v3
    v_add_u32 v157, 0x10000, v156
    v_mul_u32_u24 v8, 2080, v1
    v_mov_b32 v12, 0x3f803f80
    v_mov_b32 v13, 0x3f803f80
    v_mov_b32 v14, 0x3f803f80
    v_mov_b32 v15, 0x3f803f80
    v_mov_b32 v16, 0
    v_mov_b32 v17, 0
    v_mov_b32 v18, 0
    v_mov_b32 v19, 0
    ds_write_b128 v8, v[12:15] offset:2048
    ds_write_b128 v8, v[16:19] offset:2064
    s_waitcnt lgkmcnt(0)
    s_lshr_b32 s50, s37, 3
    s_lshl_b32 s50, s50, 2
    s_add_u32 s50, s50, s3
    s_lshl_b32 s51, s50, 15
    s_add_u32 s51, s51, 12124160
    s_lshr_b32 s52, s37, 3
    s_lshl_b32 s52, s52, 1
    s_and_b32 s53, s37, 1
    s_add_u32 s52, s52, s53
    s_lshl_b32 s52, s52, 1
    s_lshr_b32 s53, s3, 1
    s_add_u32 s52, s52, s53
    s_xor_b32 s53, s52, 1
    s_mul_i32 s55, s52, 114688
    s_mul_i32 s56, s53, 114688
    s_mul_i32 s53, s3, 28672
    s_add_u32 s53, s53, 26279936
    s_add_u32 s55, s55, s53
    s_add_u32 s56, s56, s53
    s_lshr_b32 s57, s37, 3
    s_lshl_b32 s57, s57, 2
    s_and_b32 s53, s37, 3
    s_add_u32 s57, s57, s53
    s_mul_i32 s58, s57, 114688
    s_add_u32 s58, s58, 17104896
    s_mul_i32 s22, s3, 7168
    s_mul_i32 s23, s3, 21504
    s_add_u32 s21, s58, s23
    s_add_u32 s21, s21, 28672
    v_lshrrev_b32 v8, 5, v1
    v_and_b32 v9, 31, v1
    v_lshlrev_b32 v148, 10, v9
    v_lshl_add_u32 v148, v8, 3, v148
    v_lshlrev_b32 v149, 4, v9
    v_lshl_add_u32 v149, v8, 12, v149
    s_lshl_b32 s59, s36, 3
    s_and_b32 s53, s37, 7
    s_add_u32 s59, s59, s53
    s_lshl_b32 s59, s59, 15
    s_lshl_b32 s53, s50, 6
    s_add_u32 s59, s59, s53
    v_lshlrev_b32 v155, 7, v1
    s_lshr_b32 s0, s2, 2
    s_lshl_b32 s0, s0, 7
    s_and_b32 s53, s2, 3
    s_lshl_b32 s53, s53, 2
    s_add_u32 s0, s0, s53
    s_lshr_b32 s53, s37, 2
    s_cmp_lg_u32 s3, 0
    s_cbranch_scc1 L_wait0
    s_mul_i32 s38, s36, 8192
    s_add_u32 s38, s38, 28114944
    v_lshlrev_b32 v6, 8, v1
    s_mov_b32 exec_lo, 0xffffffff
    s_mov_b32 exec_hi, 0
    s_mov_b32 s39, 0x40000
L_poll0:
    buffer_load_dword v7, v6, s[24:27], s38 offen sc1
    s_sub_u32 s39, s39, 1
    s_cbranch_scc1 L_bail0
    s_waitcnt vmcnt(0)
    v_cmp_ne_u32 vcc, s98, v7
    s_cbranch_vccnz L_poll0
L_bail0:
    s_waitcnt vmcnt(0)
    s_mov_b64 exec, -1
L_wait0:
    s_barrier
    s_lshl_b32 s43, s3, 12
    s_add_u32 s41, s47, s43
    s_mul_i32 s43, s3, 4160
    s_mov_b32 s100, 0x07060302
    buffer_load_dwordx4 v[16:19], v2, s[24:27], s47 offen sc1
    buffer_load_dwordx4 v[8:11], v2, s[24:27], s42 offen sc1
    buffer_load_dwordx4 v[12:15], v2, s[24:27], s42 offen offset:1024 sc1
    buffer_load_dwordx4 v2, s[24:27], s44 offen sc1 lds
    s_add_u32 m0, s13, 4160
    s_add_u32 s44, s44, 4096
    buffer_load_dwordx4 v2, s[24:27], s44 offen sc1 lds
    s_add_u32 m0, s13, 8320
    s_add_u32 s44, s44, 4096
    buffer_load_dwordx4 v2, s[24:27], s44 offen sc1 lds
    s_add_u32 m0, s13, 12480
    s_add_u32 s44, s44, 4096
    buffer_load_dwordx4 v2, s[24:27], s44 offen sc1 lds
    s_waitcnt vmcnt(4)
    v_mfma_f32_32x32x16_bf16 v[36:51], v[16:19], v[8:11], 0
    v_mfma_f32_32x32x16_bf16 v[52:67], v[16:19], v[12:15], 0
    s_nop 10
    v_max3_f32 v6, v36, v37, v38
    v_max_f32 v6, v6, v39
    v_max3_f32 v6, v6, v40, v41
    v_max3_f32 v6, v6, v42, v43
    v_max3_f32 v6, v6, v44, v45
    v_max3_f32 v6, v6, v46, v47
    v_max3_f32 v6, v6, v48, v49
    v_max3_f32 v6, v6, v50, v51
    v_max3_f32 v7, v52, v53, v54
    v_max_f32 v7, v7, v55
    v_max3_f32 v7, v7, v56, v57
    v_max3_f32 v7, v7, v58, v59
    v_max3_f32 v7, v7, v60, v61
    v_max3_f32 v7, v7, v62, v63
    v_max3_f32 v7, v7, v64, v65
    v_max3_f32 v7, v7, v66, v67
    s_nop 1
    v_permlane32_swap_b32 v6, v7
    v_max_f32 v6, v6, v7
    v_sub_f32 v6, 0, v6
    v_mov_b32 v7, v6
    s_nop 1
    v_permlane32_swap_b32 v6, v7
    v_pk_mov_b32 v[108:109], v[6:7], v[6:7] op_sel:[0,0]
    v_pk_mov_b32 v[110:111], v[6:7], v[6:7] op_sel:[0,0]
    v_pk_mov_b32 v[112:113], v[6:7], v[6:7] op_sel:[0,0]
    v_pk_mov_b32 v[114:115], v[6:7], v[6:7] op_sel:[0,0]
    v_pk_mov_b32 v[116:117], v[6:7], v[6:7] op_sel:[0,0]
    v_pk_mov_b32 v[118:119], v[6:7], v[6:7] op_sel:[0,0]
    v_pk_mov_b32 v[120:121], v[6:7], v[6:7] op_sel:[0,0]
    v_pk_mov_b32 v[122:123], v[6:7], v[6:7] op_sel:[0,0]
    v_pk_mov_b32 v[124:125], v[6:7], v[6:7] op_sel:[1,1]
    v_pk_mov_b32 v[126:127], v[6:7], v[6:7] op_sel:[1,1]
    v_mfma_f32_32x32x16_bf16 v[36:51], v[16:19], v[8:11], v[108:123]
    v_pk_mov_b32 v[128:129], v[6:7], v[6:7] op_sel:[1,1]
    v_pk_mov_b32 v[130:131], v[6:7], v[6:7] op_sel:[1,1]
    v_pk_mov_b32 v[132:133], v[6:7], v[6:7] op_sel:[1,1]
    v_pk_mov_b32 v[134:135], v[6:7], v[6:7] op_sel:[1,1]
    v_pk_mov_b32 v[136:137], v[6:7], v[6:7] op_sel:[1,1]
    v_pk_mov_b32 v[138:139], v[6:7], v[6:7] op_sel:[1,1]
    s_waitcnt vmcnt(3)
    s_barrier
    ds_read_b128 v[20:23], v3 offset:0
    ds_read_b128 v[24:27], v156 offset:0
    s_nop 1
    v_exp_f32 v36, v36
    v_exp_f32 v37, v37
    v_exp_f32 v38, v38
    v_cvt_pk_bf16_f32 v68, v36, v37
    v_exp_f32 v39, v39
    s_waitcnt lgkmcnt(0)
    s_add_u32 m0, s43, 16640
    s_add_u32 s44, s41, 16384
    buffer_load_dwordx4 v2, s[24:27], s44 offen offset:0 sc1 lds
    v_exp_f32 v40, v40
    v_cvt_pk_bf16_f32 v69, v38, v39
    v_exp_f32 v41, v41
    v_exp_f32 v42, v42
    v_cvt_pk_bf16_f32 v70, v40, v41
    v_exp_f32 v43, v43
    v_mfma_f32_32x32x16_bf16 v[52:67], v[16:19], v[12:15], v[124:139]
    ds_read_b128 v[16:19], v2 offset:2080
    ds_read_b128 v[28:31], v3 offset:2080
    ds_read_b128 v[32:35], v156 offset:2080
    v_exp_f32 v44, v44
    v_cvt_pk_bf16_f32 v71, v42, v43
    v_exp_f32 v45, v45
    v_exp_f32 v46, v46
    v_cvt_pk_bf16_f32 v72, v44, v45
    v_exp_f32 v47, v47
    v_mfma_f32_32x32x16_bf16 v[76:91], v[20:23], v[68:71], 0
    buffer_load_dwordx4 v2, s[24:27], s44 offen offset:1024 sc1 lds
    v_exp_f32 v48, v48
    v_cvt_pk_bf16_f32 v73, v46, v47
    v_exp_f32 v49, v49
    v_exp_f32 v50, v50
    v_cvt_pk_bf16_f32 v74, v48, v49
    v_exp_f32 v51, v51
    v_exp_f32 v52, v52
    v_exp_f32 v53, v53
    v_cvt_pk_bf16_f32 v75, v50, v51
    v_exp_f32 v54, v54
    v_cvt_pk_bf16_f32 v68, v52, v53
    v_exp_f32 v55, v55
    v_mfma_f32_32x32x16_bf16 v[76:91], v[24:27], v[72:75], v[76:91]
    s_waitcnt lgkmcnt(0)
    v_exp_f32 v56, v56
    v_cvt_pk_bf16_f32 v69, v54, v55
    v_exp_f32 v57, v57
    v_exp_f32 v58, v58
    v_cvt_pk_bf16_f32 v70, v56, v57
    v_exp_f32 v59, v59
    s_add_u32 m0, s43, 16672
    v_mfma_f32_32x32x16_bf16 v[36:51], v[16:19], v[8:11], v[108:123]
    buffer_load_dwordx4 v2, s[24:27], s44 offen offset:2048 sc1 lds
    v_exp_f32 v60, v60
    v_cvt_pk_bf16_f32 v71, v58, v59
    v_exp_f32 v61, v61
    v_exp_f32 v62, v62
    v_cvt_pk_bf16_f32 v72, v60, v61
    v_exp_f32 v63, v63
    v_mfma_f32_32x32x16_bf16 v[92:107], v[20:23], v[68:71], 0
    buffer_load_dwordx4 v2, s[24:27], s44 offen offset:3072 sc1 lds
    v_exp_f32 v64, v64
    v_cvt_pk_bf16_f32 v73, v62, v63
    v_exp_f32 v65, v65
    v_exp_f32 v66, v66
    v_cvt_pk_bf16_f32 v74, v64, v65
    v_exp_f32 v67, v67
    v_exp_f32 v36, v36
    v_exp_f32 v37, v37
    v_cvt_pk_bf16_f32 v75, v66, v67
    v_exp_f32 v38, v38
    v_cvt_pk_bf16_f32 v68, v36, v37
    v_exp_f32 v39, v39
    v_mfma_f32_32x32x16_bf16 v[92:107], v[24:27], v[72:75], v[92:107]
    s_add_u32 m0, s43, 33280
    s_add_u32 s44, s41, 32768
    buffer_load_dwordx4 v2, s[24:27], s44 offen offset:0 sc1 lds
    v_exp_f32 v40, v40
    v_cvt_pk_bf16_f32 v69, v38, v39
    v_exp_f32 v41, v41
    v_exp_f32 v42, v42
    v_cvt_pk_bf16_f32 v70, v40, v41
    v_exp_f32 v43, v43
    v_mfma_f32_32x32x16_bf16 v[52:67], v[16:19], v[12:15], v[124:139]
    s_waitcnt vmcnt(5)
    s_barrier
    ds_read_b128 v[16:19], v2 offset:4160
    ds_read_b128 v[20:23], v3 offset:4160
    ds_read_b128 v[24:27], v156 offset:4160
    v_exp_f32 v44, v44
    v_cvt_pk_bf16_f32 v71, v42, v43
    v_exp_f32 v45, v45
    v_exp_f32 v46, v46
    v_cvt_pk_bf16_f32 v72, v44, v45
    v_exp_f32 v47, v47
    v_mfma_f32_32x32x16_bf16 v[76:91], v[28:31], v[68:71], v[76:91]
    buffer_load_dwordx4 v2, s[24:27], s44 offen offset:1024 sc1 lds
    v_exp_f32 v48, v48
    v_cvt_pk_bf16_f32 v73, v46, v47
    v_exp_f32 v49, v49
    v_exp_f32 v50, v50
    v_cvt_pk_bf16_f32 v74, v48, v49
    v_exp_f32 v51, v51
    v_exp_f32 v52, v52
    v_exp_f32 v53, v53
    v_cvt_pk_bf16_f32 v75, v50, v51
    v_exp_f32 v54, v54
    v_cvt_pk_bf16_f32 v68, v52, v53
    v_exp_f32 v55, v55
    v_mfma_f32_32x32x16_bf16 v[76:91], v[32:35], v[72:75], v[76:91]
    s_waitcnt lgkmcnt(0)
    v_exp_f32 v56, v56
    v_cvt_pk_bf16_f32 v69, v54, v55
    v_exp_f32 v57, v57
    v_exp_f32 v58, v58
    v_cvt_pk_bf16_f32 v70, v56, v57
    v_exp_f32 v59, v59
    s_add_u32 m0, s43, 33312
    v_mfma_f32_32x32x16_bf16 v[36:51], v[16:19], v[8:11], v[108:123]
    buffer_load_dwordx4 v2, s[24:27], s44 offen offset:2048 sc1 lds
    v_exp_f32 v60, v60
    v_cvt_pk_bf16_f32 v71, v58, v59
    v_exp_f32 v61, v61
    v_exp_f32 v62, v62
    v_cvt_pk_bf16_f32 v72, v60, v61
    v_exp_f32 v63, v63
    v_mfma_f32_32x32x16_bf16 v[92:107], v[28:31], v[68:71], v[92:107]
    buffer_load_dwordx4 v2, s[24:27], s44 offen offset:3072 sc1 lds
    v_exp_f32 v64, v64
    v_cvt_pk_bf16_f32 v73, v62, v63
    v_exp_f32 v65, v65
    v_exp_f32 v66, v66
    v_cvt_pk_bf16_f32 v74, v64, v65
    v_exp_f32 v67, v67
    v_exp_f32 v36, v36
    v_exp_f32 v37, v37
    v_cvt_pk_bf16_f32 v75, v66, v67
    v_exp_f32 v38, v38
    v_cvt_pk_bf16_f32 v68, v36, v37
    v_exp_f32 v39, v39
    v_mfma_f32_32x32x16_bf16 v[92:107], v[32:35], v[72:75], v[92:107]
    s_add_u32 m0, s43, 49920
    s_add_u32 s44, s41, 49152
    buffer_load_dwordx4 v2, s[24:27], s44 offen offset:0 sc1 lds
    v_exp_f32 v40, v40
    v_cvt_pk_bf16_f32 v69, v38, v39
    v_exp_f32 v41, v41
    v_exp_f32 v42, v42
    v_cvt_pk_bf16_f32 v70, v40, v41
    v_exp_f32 v43, v43
    v_mfma_f32_32x32x16_bf16 v[52:67], v[16:19], v[12:15], v[124:139]
    ds_read_b128 v[16:19], v2 offset:6240
    ds_read_b128 v[28:31], v3 offset:6240
    ds_read_b128 v[32:35], v156 offset:6240
    v_exp_f32 v44, v44
    v_cvt_pk_bf16_f32 v71, v42, v43
    v_exp_f32 v45, v45
    v_exp_f32 v46, v46
    v_cvt_pk_bf16_f32 v72, v44, v45
    v_exp_f32 v47, v47
    v_mfma_f32_32x32x16_bf16 v[76:91], v[20:23], v[68:71], v[76:91]
    buffer_load_dwordx4 v2, s[24:27], s44 offen offset:1024 sc1 lds
    v_exp_f32 v48, v48
    v_cvt_pk_bf16_f32 v73, v46, v47
    v_exp_f32 v49, v49
    v_exp_f32 v50, v50
    v_cvt_pk_bf16_f32 v74, v48, v49
    v_exp_f32 v51, v51
    v_exp_f32 v52, v52
    v_exp_f32 v53, v53
    v_cvt_pk_bf16_f32 v75, v50, v51
    v_exp_f32 v54, v54
    v_cvt_pk_bf16_f32 v68, v52, v53
    v_exp_f32 v55, v55
    v_mfma_f32_32x32x16_bf16 v[76:91], v[24:27], v[72:75], v[76:91]
    s_waitcnt lgkmcnt(0)
    v_exp_f32 v56, v56
    v_cvt_pk_bf16_f32 v69, v54, v55
    v_exp_f32 v57, v57
    v_exp_f32 v58, v58
    v_cvt_pk_bf16_f32 v70, v56, v57
    v_exp_f32 v59, v59
    s_add_u32 m0, s43, 49952
    v_mfma_f32_32x32x16_bf16 v[36:51], v[16:19], v[8:11], v[108:123]
    buffer_load_dwordx4 v2, s[24:27], s44 offen offset:2048 sc1 lds
    v_exp_f32 v60, v60
    v_cvt_pk_bf16_f32 v71, v58, v59
    v_exp_f32 v61, v61
    v_exp_f32 v62, v62
    v_cvt_pk_bf16_f32 v72, v60, v61
    v_exp_f32 v63, v63
    v_mfma_f32_32x32x16_bf16 v[92:107], v[20:23], v[68:71], v[92:107]
    buffer_load_dwordx4 v2, s[24:27], s44 offen offset:3072 sc1 lds
    v_exp_f32 v64, v64
    v_cvt_pk_bf16_f32 v73, v62, v63
    v_exp_f32 v65, v65
    v_exp_f32 v66, v66
    v_cvt_pk_bf16_f32 v74, v64, v65
    v_exp_f32 v67, v67
    v_exp_f32 v36, v36
    v_exp_f32 v37, v37
    v_cvt_pk_bf16_f32 v75, v66, v67
    v_exp_f32 v38, v38
    v_cvt_pk_bf16_f32 v68, v36, v37
    v_exp_f32 v39, v39
    v_mfma_f32_32x32x16_bf16 v[92:107], v[24:27], v[72:75], v[92:107]
    s_add_u32 m0, s43, 66560
    s_add_u32 s44, s41, 65536
    buffer_load_dwordx4 v2, s[24:27], s44 offen offset:0 sc1 lds
    v_exp_f32 v40, v40
    v_cvt_pk_bf16_f32 v69, v38, v39
    v_exp_f32 v41, v41
    v_exp_f32 v42, v42
    v_cvt_pk_bf16_f32 v70, v40, v41
    v_exp_f32 v43, v43
    v_mfma_f32_32x32x16_bf16 v[52:67], v[16:19], v[12:15], v[124:139]
    ds_read_b128 v[16:19], v2 offset:8320
    ds_read_b128 v[20:23], v3 offset:8320
    ds_read_b128 v[24:27], v156 offset:8320
    v_exp_f32 v44, v44
    v_cvt_pk_bf16_f32 v71, v42, v43
    v_exp_f32 v45, v45
    v_exp_f32 v46, v46
    v_cvt_pk_bf16_f32 v72, v44, v45
    v_exp_f32 v47, v47
    v_mfma_f32_32x32x16_bf16 v[76:91], v[28:31], v[68:71], v[76:91]
    buffer_load_dwordx4 v2, s[24:27], s44 offen offset:1024 sc1 lds
    v_exp_f32 v48, v48
    v_cvt_pk_bf16_f32 v73, v46, v47
    v_exp_f32 v49, v49
    v_exp_f32 v50, v50
    v_cvt_pk_bf16_f32 v74, v48, v49
    v_exp_f32 v51, v51
    v_exp_f32 v52, v52
    v_exp_f32 v53, v53
    v_cvt_pk_bf16_f32 v75, v50, v51
    v_exp_f32 v54, v54
    v_cvt_pk_bf16_f32 v68, v52, v53
    v_exp_f32 v55, v55
    v_mfma_f32_32x32x16_bf16 v[76:91], v[32:35], v[72:75], v[76:91]
    s_waitcnt lgkmcnt(0)
    v_exp_f32 v56, v56
    v_cvt_pk_bf16_f32 v69, v54, v55
    v_exp_f32 v57, v57
    v_exp_f32 v58, v58
    v_cvt_pk_bf16_f32 v70, v56, v57
    v_exp_f32 v59, v59
    s_add_u32 m0, s43, 66592
    v_mfma_f32_32x32x16_bf16 v[36:51], v[16:19], v[8:11], v[108:123]
    buffer_load_dwordx4 v2, s[24:27], s44 offen offset:2048 sc1 lds
    v_exp_f32 v60, v60
    v_cvt_pk_bf16_f32 v71, v58, v59
    v_exp_f32 v61, v61
    v_exp_f32 v62, v62
    v_cvt_pk_bf16_f32 v72, v60, v61
    v_exp_f32 v63, v63
    v_mfma_f32_32x32x16_bf16 v[92:107], v[28:31], v[68:71], v[92:107]
    buffer_load_dwordx4 v2, s[24:27], s44 offen offset:3072 sc1 lds
    v_exp_f32 v64, v64
    v_cvt_pk_bf16_f32 v73, v62, v63
    v_exp_f32 v65, v65
    v_exp_f32 v66, v66
    v_cvt_pk_bf16_f32 v74, v64, v65
    v_exp_f32 v67, v67
    v_exp_f32 v36, v36
    v_exp_f32 v37, v37
    v_cvt_pk_bf16_f32 v75, v66, v67
    v_exp_f32 v38, v38
    v_cvt_pk_bf16_f32 v68, v36, v37
    v_exp_f32 v39, v39
    v_mfma_f32_32x32x16_bf16 v[92:107], v[32:35], v[72:75], v[92:107]
    s_add_u32 m0, s43, 83200
    s_add_u32 s44, s41, 81920
    buffer_load_dwordx4 v2, s[24:27], s44 offen offset:0 sc1 lds
    v_exp_f32 v40, v40
    v_cvt_pk_bf16_f32 v69, v38, v39
    v_exp_f32 v41, v41
    v_exp_f32 v42, v42
    v_cvt_pk_bf16_f32 v70, v40, v41
    v_exp_f32 v43, v43
    v_mfma_f32_32x32x16_bf16 v[52:67], v[16:19], v[12:15], v[124:139]
    ds_read_b128 v[16:19], v2 offset:10400
    ds_read_b128 v[28:31], v3 offset:10400
    ds_read_b128 v[32:35], v156 offset:10400
    v_exp_f32 v44, v44
    v_cvt_pk_bf16_f32 v71, v42, v43
    v_exp_f32 v45, v45
    v_exp_f32 v46, v46
    v_cvt_pk_bf16_f32 v72, v44, v45
    v_exp_f32 v47, v47
    v_mfma_f32_32x32x16_bf16 v[76:91], v[20:23], v[68:71], v[76:91]
    buffer_load_dwordx4 v2, s[24:27], s44 offen offset:1024 sc1 lds
    v_exp_f32 v48, v48
    v_cvt_pk_bf16_f32 v73, v46, v47
    v_exp_f32 v49, v49
    v_exp_f32 v50, v50
    v_cvt_pk_bf16_f32 v74, v48, v49
    v_exp_f32 v51, v51
    v_exp_f32 v52, v52
    v_exp_f32 v53, v53
    v_cvt_pk_bf16_f32 v75, v50, v51
    v_exp_f32 v54, v54
    v_cvt_pk_bf16_f32 v68, v52, v53
    v_exp_f32 v55, v55
    v_mfma_f32_32x32x16_bf16 v[76:91], v[24:27], v[72:75], v[76:91]
    s_waitcnt lgkmcnt(0)
    v_exp_f32 v56, v56
    v_cvt_pk_bf16_f32 v69, v54, v55
    v_exp_f32 v57, v57
    v_exp_f32 v58, v58
    v_cvt_pk_bf16_f32 v70, v56, v57
    v_exp_f32 v59, v59
    s_add_u32 m0, s43, 83232
    v_mfma_f32_32x32x16_bf16 v[36:51], v[16:19], v[8:11], v[108:123]
    buffer_load_dwordx4 v2, s[24:27], s44 offen offset:2048 sc1 lds
    v_exp_f32 v60, v60
    v_cvt_pk_bf16_f32 v71, v58, v59
    v_exp_f32 v61, v61
    v_exp_f32 v62, v62
    v_cvt_pk_bf16_f32 v72, v60, v61
    v_exp_f32 v63, v63
    v_mfma_f32_32x32x16_bf16 v[92:107], v[20:23], v[68:71], v[92:107]
    buffer_load_dwordx4 v2, s[24:27], s44 offen offset:3072 sc1 lds
    v_exp_f32 v64, v64
    v_cvt_pk_bf16_f32 v73, v62, v63
    v_exp_f32 v65, v65
    v_exp_f32 v66, v66
    v_cvt_pk_bf16_f32 v74, v64, v65
    v_exp_f32 v67, v67
    v_exp_f32 v36, v36
    v_exp_f32 v37, v37
    v_cvt_pk_bf16_f32 v75, v66, v67
    v_exp_f32 v38, v38
    v_cvt_pk_bf16_f32 v68, v36, v37
    v_exp_f32 v39, v39
    v_mfma_f32_32x32x16_bf16 v[92:107], v[24:27], v[72:75], v[92:107]
    s_add_u32 m0, s43, 99840
    s_add_u32 s44, s41, 98304
    buffer_load_dwordx4 v2, s[24:27], s44 offen offset:0 sc1 lds
    v_exp_f32 v40, v40
    v_cvt_pk_bf16_f32 v69, v38, v39
    v_exp_f32 v41, v41
    v_exp_f32 v42, v42
    v_cvt_pk_bf16_f32 v70, v40, v41
    v_exp_f32 v43, v43
    v_mfma_f32_32x32x16_bf16 v[52:67], v[16:19], v[12:15], v[124:139]
    ds_read_b128 v[16:19], v2 offset:12480
    ds_read_b128 v[20:23], v3 offset:12480
    ds_read_b128 v[24:27], v156 offset:12480
    v_exp_f32 v44, v44
    v_cvt_pk_bf16_f32 v71, v42, v43
    v_exp_f32 v45, v45
    v_exp_f32 v46, v46
    v_cvt_pk_bf16_f32 v72, v44, v45
    v_exp_f32 v47, v47
    v_mfma_f32_32x32x16_bf16 v[76:91], v[28:31], v[68:71], v[76:91]
    buffer_load_dwordx4 v2, s[24:27], s44 offen offset:1024 sc1 lds
    v_exp_f32 v48, v48
    v_cvt_pk_bf16_f32 v73, v46, v47
    v_exp_f32 v49, v49
    v_exp_f32 v50, v50
    v_cvt_pk_bf16_f32 v74, v48, v49
    v_exp_f32 v51, v51
    v_exp_f32 v52, v52
    v_exp_f32 v53, v53
    v_cvt_pk_bf16_f32 v75, v50, v51
    v_exp_f32 v54, v54
    v_cvt_pk_bf16_f32 v68, v52, v53
    v_exp_f32 v55, v55
    v_mfma_f32_32x32x16_bf16 v[76:91], v[32:35], v[72:75], v[76:91]
    s_waitcnt lgkmcnt(0)
    v_exp_f32 v56, v56
    v_cvt_pk_bf16_f32 v69, v54, v55
    v_exp_f32 v57, v57
    v_exp_f32 v58, v58
    v_cvt_pk_bf16_f32 v70, v56, v57
    v_exp_f32 v59, v59
    s_add_u32 m0, s43, 99872
    v_mfma_f32_32x32x16_bf16 v[36:51], v[16:19], v[8:11], v[108:123]
    buffer_load_dwordx4 v2, s[24:27], s44 offen offset:2048 sc1 lds
    v_exp_f32 v60, v60
    v_cvt_pk_bf16_f32 v71, v58, v59
    v_exp_f32 v61, v61
    v_exp_f32 v62, v62
    v_cvt_pk_bf16_f32 v72, v60, v61
    v_exp_f32 v63, v63
    v_mfma_f32_32x32x16_bf16 v[92:107], v[28:31], v[68:71], v[92:107]
    buffer_load_dwordx4 v2, s[24:27], s44 offen offset:3072 sc1 lds
    v_exp_f32 v64, v64
    v_cvt_pk_bf16_f32 v73, v62, v63
    v_exp_f32 v65, v65
    v_exp_f32 v66, v66
    v_cvt_pk_bf16_f32 v74, v64, v65
    v_exp_f32 v67, v67
    v_exp_f32 v36, v36
    v_exp_f32 v37, v37
    v_cvt_pk_bf16_f32 v75, v66, v67
    v_exp_f32 v38, v38
    v_cvt_pk_bf16_f32 v68, v36, v37
    v_exp_f32 v39, v39
    v_mfma_f32_32x32x16_bf16 v[92:107], v[32:35], v[72:75], v[92:107]
    s_add_u32 m0, s43, 116480
    s_add_u32 s44, s41, 114688
    buffer_load_dwordx4 v2, s[24:27], s44 offen offset:0 sc1 lds
    v_exp_f32 v40, v40
    v_cvt_pk_bf16_f32 v69, v38, v39
    v_exp_f32 v41, v41
    v_exp_f32 v42, v42
    v_cvt_pk_bf16_f32 v70, v40, v41
    v_exp_f32 v43, v43
    v_mfma_f32_32x32x16_bf16 v[52:67], v[16:19], v[12:15], v[124:139]
    ds_read_b128 v[16:19], v2 offset:14560
    ds_read_b128 v[28:31], v3 offset:14560
    ds_read_b128 v[32:35], v156 offset:14560
    v_exp_f32 v44, v44
    v_cvt_pk_bf16_f32 v71, v42, v43
    v_exp_f32 v45, v45
    v_exp_f32 v46, v46
    v_cvt_pk_bf16_f32 v72, v44, v45
    v_exp_f32 v47, v47
    v_mfma_f32_32x32x16_bf16 v[76:91], v[20:23], v[68:71], v[76:91]
    buffer_load_dwordx4 v2, s[24:27], s44 offen offset:1024 sc1 lds
    v_exp_f32 v48, v48
    v_cvt_pk_bf16_f32 v73, v46, v47
    v_exp_f32 v49, v49
    v_exp_f32 v50, v50
    v_cvt_pk_bf16_f32 v74, v48, v49
    v_exp_f32 v51, v51
    v_exp_f32 v52, v52
    v_exp_f32 v53, v53
    v_cvt_pk_bf16_f32 v75, v50, v51
    v_exp_f32 v54, v54
    v_cvt_pk_bf16_f32 v68, v52, v53
    v_exp_f32 v55, v55
    v_mfma_f32_32x32x16_bf16 v[76:91], v[24:27], v[72:75], v[76:91]
    s_waitcnt lgkmcnt(0)
    v_exp_f32 v56, v56
    v_cvt_pk_bf16_f32 v69, v54, v55
    v_exp_f32 v57, v57
    v_exp_f32 v58, v58
    v_cvt_pk_bf16_f32 v70, v56, v57
    v_exp_f32 v59, v59
    s_add_u32 m0, s43, 116512
    v_mfma_f32_32x32x16_bf16 v[36:51], v[16:19], v[8:11], v[108:123]
    buffer_load_dwordx4 v2, s[24:27], s44 offen offset:2048 sc1 lds
    v_exp_f32 v60, v60
    v_cvt_pk_bf16_f32 v71, v58, v59
    v_exp_f32 v61, v61
    v_exp_f32 v62, v62
    v_cvt_pk_bf16_f32 v72, v60, v61
    v_exp_f32 v63, v63
    v_mfma_f32_32x32x16_bf16 v[92:107], v[20:23], v[68:71], v[92:107]
    buffer_load_dwordx4 v2, s[24:27], s44 offen offset:3072 sc1 lds
    v_exp_f32 v64, v64
    v_cvt_pk_bf16_f32 v73, v62, v63
    v_exp_f32 v65, v65
    v_exp_f32 v66, v66
    v_cvt_pk_bf16_f32 v74, v64, v65
    v_exp_f32 v67, v67
    v_exp_f32 v36, v36
    v_exp_f32 v37, v37
    v_cvt_pk_bf16_f32 v75, v66, v67
    v_exp_f32 v38, v38
    v_cvt_pk_bf16_f32 v68, v36, v37
    v_exp_f32 v39, v39
    v_mfma_f32_32x32x16_bf16 v[92:107], v[24:27], v[72:75], v[92:107]
    s_mov_b32 s12, 0
    buffer_load_dwordx4 a[192:195], v222, s[8:11], s12 offen
    v_exp_f32 v40, v40
    v_cvt_pk_bf16_f32 v69, v38, v39
    v_exp_f32 v41, v41
    v_exp_f32 v42, v42
    v_cvt_pk_bf16_f32 v70, v40, v41
    v_exp_f32 v43, v43
    v_mfma_f32_32x32x16_bf16 v[52:67], v[16:19], v[12:15], v[124:139]
    s_waitcnt vmcnt(17)
    s_barrier
    ds_read_b128 v[16:19], v2 offset:16640
    ds_read_b128 v[20:23], v3 offset:16640
    ds_read_b128 v[24:27], v156 offset:16640
    v_exp_f32 v44, v44
    v_cvt_pk_bf16_f32 v71, v42, v43
    v_exp_f32 v45, v45
    v_exp_f32 v46, v46
    v_cvt_pk_bf16_f32 v72, v44, v45
    v_exp_f32 v47, v47
    v_mfma_f32_32x32x16_bf16 v[76:91], v[28:31], v[68:71], v[76:91]
    v_exp_f32 v48, v48
    v_cvt_pk_bf16_f32 v73, v46, v47
    v_exp_f32 v49, v49
    v_exp_f32 v50, v50
    v_cvt_pk_bf16_f32 v74, v48, v49
    v_exp_f32 v51, v51
    v_exp_f32 v52, v52
    v_exp_f32 v53, v53
    v_cvt_pk_bf16_f32 v75, v50, v51
    v_exp_f32 v54, v54
    v_cvt_pk_bf16_f32 v68, v52, v53
    v_exp_f32 v55, v55
    v_mfma_f32_32x32x16_bf16 v[76:91], v[32:35], v[72:75], v[76:91]
    s_waitcnt lgkmcnt(0)
    v_exp_f32 v56, v56
    v_cvt_pk_bf16_f32 v69, v54, v55
    v_exp_f32 v57, v57
    v_exp_f32 v58, v58
    v_cvt_pk_bf16_f32 v70, v56, v57
    v_exp_f32 v59, v59
    v_mfma_f32_32x32x16_bf16 v[36:51], v[16:19], v[8:11], v[108:123]
    s_add_u32 s12, s12, s1
    buffer_load_dwordx4 a[196:199], v222, s[8:11], s12 offen
    v_exp_f32 v60, v60
    v_cvt_pk_bf16_f32 v71, v58, v59
    v_exp_f32 v61, v61
    v_exp_f32 v62, v62
    v_cvt_pk_bf16_f32 v72, v60, v61
    v_exp_f32 v63, v63
    v_mfma_f32_32x32x16_bf16 v[92:107], v[28:31], v[68:71], v[92:107]
    v_exp_f32 v64, v64
    v_cvt_pk_bf16_f32 v73, v62, v63
    v_exp_f32 v65, v65
    v_exp_f32 v66, v66
    v_cvt_pk_bf16_f32 v74, v64, v65
    v_exp_f32 v67, v67
    v_exp_f32 v36, v36
    v_exp_f32 v37, v37
    v_cvt_pk_bf16_f32 v75, v66, v67
    v_exp_f32 v38, v38
    v_cvt_pk_bf16_f32 v68, v36, v37
    v_exp_f32 v39, v39
    v_mfma_f32_32x32x16_bf16 v[92:107], v[32:35], v[72:75], v[92:107]
    s_add_u32 s12, s12, s1
    buffer_load_dwordx4 a[200:203], v222, s[8:11], s12 offen
    v_exp_f32 v40, v40
    v_cvt_pk_bf16_f32 v69, v38, v39
    v_exp_f32 v41, v41
    v_exp_f32 v42, v42
    v_cvt_pk_bf16_f32 v70, v40, v41
    v_exp_f32 v43, v43
    v_mfma_f32_32x32x16_bf16 v[52:67], v[16:19], v[12:15], v[124:139]
    ds_read_b128 v[16:19], v2 offset:18720
    ds_read_b128 v[28:31], v3 offset:18720
    ds_read_b128 v[32:35], v156 offset:18720
    v_exp_f32 v44, v44
    v_cvt_pk_bf16_f32 v71, v42, v43
    v_exp_f32 v45, v45
    v_exp_f32 v46, v46
    v_cvt_pk_bf16_f32 v72, v44, v45
    v_exp_f32 v47, v47
    v_mfma_f32_32x32x16_bf16 v[76:91], v[20:23], v[68:71], v[76:91]
    v_exp_f32 v48, v48
    v_cvt_pk_bf16_f32 v73, v46, v47
    v_exp_f32 v49, v49
    v_exp_f32 v50, v50
    v_cvt_pk_bf16_f32 v74, v48, v49
    v_exp_f32 v51, v51
    v_exp_f32 v52, v52
    v_exp_f32 v53, v53
    v_cvt_pk_bf16_f32 v75, v50, v51
    v_exp_f32 v54, v54
    v_cvt_pk_bf16_f32 v68, v52, v53
    v_exp_f32 v55, v55
    v_mfma_f32_32x32x16_bf16 v[76:91], v[24:27], v[72:75], v[76:91]
    s_waitcnt lgkmcnt(0)
    v_exp_f32 v56, v56
    v_cvt_pk_bf16_f32 v69, v54, v55
    v_exp_f32 v57, v57
    v_exp_f32 v58, v58
    v_cvt_pk_bf16_f32 v70, v56, v57
    v_exp_f32 v59, v59
    v_mfma_f32_32x32x16_bf16 v[36:51], v[16:19], v[8:11], v[108:123]
    s_add_u32 s12, s12, s1
    buffer_load_dwordx4 a[204:207], v222, s[8:11], s12 offen
    v_exp_f32 v60, v60
    v_cvt_pk_bf16_f32 v71, v58, v59
    v_exp_f32 v61, v61
    v_exp_f32 v62, v62
    v_cvt_pk_bf16_f32 v72, v60, v61
    v_exp_f32 v63, v63
    v_mfma_f32_32x32x16_bf16 v[92:107], v[20:23], v[68:71], v[92:107]
    v_exp_f32 v64, v64
    v_cvt_pk_bf16_f32 v73, v62, v63
    v_exp_f32 v65, v65
    v_exp_f32 v66, v66
    v_cvt_pk_bf16_f32 v74, v64, v65
    v_exp_f32 v67, v67
    v_exp_f32 v36, v36
    v_exp_f32 v37, v37
    v_cvt_pk_bf16_f32 v75, v66, v67
    v_exp_f32 v38, v38
    v_cvt_pk_bf16_f32 v68, v36, v37
    v_exp_f32 v39, v39
    v_mfma_f32_32x32x16_bf16 v[92:107], v[24:27], v[72:75], v[92:107]
    buffer_load_dwordx4 v[224:227], v2, s[4:7], s20 offen offset:0
    v_exp_f32 v40, v40
    v_cvt_pk_bf16_f32 v69, v38, v39
    v_exp_f32 v41, v41
    v_exp_f32 v42, v42
    v_cvt_pk_bf16_f32 v70, v40, v41
    v_exp_f32 v43, v43
    v_mfma_f32_32x32x16_bf16 v[52:67], v[16:19], v[12:15], v[124:139]
    ds_read_b128 v[16:19], v2 offset:20800
    ds_read_b128 v[20:23], v3 offset:20800
    ds_read_b128 v[24:27], v156 offset:20800
    v_exp_f32 v44, v44
    v_cvt_pk_bf16_f32 v71, v42, v43
    v_exp_f32 v45, v45
    v_exp_f32 v46, v46
    v_cvt_pk_bf16_f32 v72, v44, v45
    v_exp_f32 v47, v47
    v_mfma_f32_32x32x16_bf16 v[76:91], v[28:31], v[68:71], v[76:91]
    v_exp_f32 v48, v48
    v_cvt_pk_bf16_f32 v73, v46, v47
    v_exp_f32 v49, v49
    v_exp_f32 v50, v50
    v_cvt_pk_bf16_f32 v74, v48, v49
    v_exp_f32 v51, v51
    v_exp_f32 v52, v52
    v_exp_f32 v53, v53
    v_cvt_pk_bf16_f32 v75, v50, v51
    v_exp_f32 v54, v54
    v_cvt_pk_bf16_f32 v68, v52, v53
    v_exp_f32 v55, v55
    v_mfma_f32_32x32x16_bf16 v[76:91], v[32:35], v[72:75], v[76:91]
    s_waitcnt lgkmcnt(0)
    v_exp_f32 v56, v56
    v_cvt_pk_bf16_f32 v69, v54, v55
    v_exp_f32 v57, v57
    v_exp_f32 v58, v58
    v_cvt_pk_bf16_f32 v70, v56, v57
    v_exp_f32 v59, v59
    v_mfma_f32_32x32x16_bf16 v[36:51], v[16:19], v[8:11], v[108:123]
    buffer_load_dwordx4 v[228:231], v2, s[4:7], s20 offen offset:1024
    v_exp_f32 v60, v60
    v_cvt_pk_bf16_f32 v71, v58, v59
    v_exp_f32 v61, v61
    v_exp_f32 v62, v62
    v_cvt_pk_bf16_f32 v72, v60, v61
    v_exp_f32 v63, v63
    v_mfma_f32_32x32x16_bf16 v[92:107], v[28:31], v[68:71], v[92:107]
    v_exp_f32 v64, v64
    v_cvt_pk_bf16_f32 v73, v62, v63
    v_exp_f32 v65, v65
    v_exp_f32 v66, v66
    v_cvt_pk_bf16_f32 v74, v64, v65
    v_exp_f32 v67, v67
    v_exp_f32 v36, v36
    v_exp_f32 v37, v37
    v_cvt_pk_bf16_f32 v75, v66, v67
    v_exp_f32 v38, v38
    v_cvt_pk_bf16_f32 v68, v36, v37
    v_exp_f32 v39, v39
    v_mfma_f32_32x32x16_bf16 v[92:107], v[32:35], v[72:75], v[92:107]
    buffer_load_dwordx2 v[140:141], v148, s[28:31], s59 offen offset:0
    v_exp_f32 v40, v40
    v_cvt_pk_bf16_f32 v69, v38, v39
    v_exp_f32 v41, v41
    v_exp_f32 v42, v42
    v_cvt_pk_bf16_f32 v70, v40, v41
    v_exp_f32 v43, v43
    v_mfma_f32_32x32x16_bf16 v[52:67], v[16:19], v[12:15], v[124:139]
    ds_read_b128 v[16:19], v2 offset:22880
    ds_read_b128 v[28:31], v3 offset:22880
    ds_read_b128 v[32:35], v156 offset:22880
    v_exp_f32 v44, v44
    v_cvt_pk_bf16_f32 v71, v42, v43
    v_exp_f32 v45, v45
    v_exp_f32 v46, v46
    v_cvt_pk_bf16_f32 v72, v44, v45
    v_exp_f32 v47, v47
    v_mfma_f32_32x32x16_bf16 v[76:91], v[20:23], v[68:71], v[76:91]
    v_exp_f32 v48, v48
    v_cvt_pk_bf16_f32 v73, v46, v47
    v_exp_f32 v49, v49
    v_exp_f32 v50, v50
    v_cvt_pk_bf16_f32 v74, v48, v49
    v_exp_f32 v51, v51
    v_exp_f32 v52, v52
    v_exp_f32 v53, v53
    v_cvt_pk_bf16_f32 v75, v50, v51
    v_exp_f32 v54, v54
    v_cvt_pk_bf16_f32 v68, v52, v53
    v_exp_f32 v55, v55
    v_mfma_f32_32x32x16_bf16 v[76:91], v[24:27], v[72:75], v[76:91]
    s_waitcnt lgkmcnt(0)
    v_exp_f32 v56, v56
    v_cvt_pk_bf16_f32 v69, v54, v55
    v_exp_f32 v57, v57
    v_exp_f32 v58, v58
    v_cvt_pk_bf16_f32 v70, v56, v57
    v_exp_f32 v59, v59
    v_mfma_f32_32x32x16_bf16 v[36:51], v[16:19], v[8:11], v[108:123]
    buffer_load_dwordx2 v[142:143], v148, s[28:31], s59 offen offset:16
    v_exp_f32 v60, v60
    v_cvt_pk_bf16_f32 v71, v58, v59
    v_exp_f32 v61, v61
    v_exp_f32 v62, v62
    v_cvt_pk_bf16_f32 v72, v60, v61
    v_exp_f32 v63, v63
    v_mfma_f32_32x32x16_bf16 v[92:107], v[20:23], v[68:71], v[92:107]
    v_exp_f32 v64, v64
    v_cvt_pk_bf16_f32 v73, v62, v63
    v_exp_f32 v65, v65
    v_exp_f32 v66, v66
    v_cvt_pk_bf16_f32 v74, v64, v65
    v_exp_f32 v67, v67
    v_exp_f32 v36, v36
    v_exp_f32 v37, v37
    v_cvt_pk_bf16_f32 v75, v66, v67
    v_exp_f32 v38, v38
    v_cvt_pk_bf16_f32 v68, v36, v37
    v_exp_f32 v39, v39
    v_mfma_f32_32x32x16_bf16 v[92:107], v[24:27], v[72:75], v[92:107]
    buffer_load_dwordx2 v[144:145], v148, s[28:31], s59 offen offset:32
    v_exp_f32 v40, v40
    v_cvt_pk_bf16_f32 v69, v38, v39
    v_exp_f32 v41, v41
    v_exp_f32 v42, v42
    v_cvt_pk_bf16_f32 v70, v40, v41
    v_exp_f32 v43, v43
    v_mfma_f32_32x32x16_bf16 v[52:67], v[16:19], v[12:15], v[124:139]
    ds_read_b128 v[16:19], v2 offset:24960
    ds_read_b128 v[20:23], v3 offset:24960
    ds_read_b128 v[24:27], v156 offset:24960
    v_exp_f32 v44, v44
    v_cvt_pk_bf16_f32 v71, v42, v43
    v_exp_f32 v45, v45
    v_exp_f32 v46, v46
    v_cvt_pk_bf16_f32 v72, v44, v45
    v_exp_f32 v47, v47
    v_mfma_f32_32x32x16_bf16 v[76:91], v[28:31], v[68:71], v[76:91]
    v_exp_f32 v48, v48
    v_cvt_pk_bf16_f32 v73, v46, v47
    v_exp_f32 v49, v49
    v_exp_f32 v50, v50
    v_cvt_pk_bf16_f32 v74, v48, v49
    v_exp_f32 v51, v51
    v_exp_f32 v52, v52
    v_exp_f32 v53, v53
    v_cvt_pk_bf16_f32 v75, v50, v51
    v_exp_f32 v54, v54
    v_cvt_pk_bf16_f32 v68, v52, v53
    v_exp_f32 v55, v55
    v_mfma_f32_32x32x16_bf16 v[76:91], v[32:35], v[72:75], v[76:91]
    s_waitcnt lgkmcnt(0)
    v_exp_f32 v56, v56
    v_cvt_pk_bf16_f32 v69, v54, v55
    v_exp_f32 v57, v57
    v_exp_f32 v58, v58
    v_cvt_pk_bf16_f32 v70, v56, v57
    v_exp_f32 v59, v59
    v_mfma_f32_32x32x16_bf16 v[36:51], v[16:19], v[8:11], v[108:123]
    buffer_load_dwordx2 v[146:147], v148, s[28:31], s59 offen offset:48
    v_exp_f32 v60, v60
    v_cvt_pk_bf16_f32 v71, v58, v59
    v_exp_f32 v61, v61
    v_exp_f32 v62, v62
    v_cvt_pk_bf16_f32 v72, v60, v61
    v_exp_f32 v63, v63
    v_mfma_f32_32x32x16_bf16 v[92:107], v[28:31], v[68:71], v[92:107]
    v_exp_f32 v64, v64
    v_cvt_pk_bf16_f32 v73, v62, v63
    v_exp_f32 v65, v65
    v_exp_f32 v66, v66
    v_cvt_pk_bf16_f32 v74, v64, v65
    v_exp_f32 v67, v67
    v_exp_f32 v36, v36
    v_exp_f32 v37, v37
    v_cvt_pk_bf16_f32 v75, v66, v67
    v_exp_f32 v38, v38
    v_cvt_pk_bf16_f32 v68, v36, v37
    v_exp_f32 v39, v39
    v_mfma_f32_32x32x16_bf16 v[92:107], v[32:35], v[72:75], v[92:107]
    v_exp_f32 v40, v40
    v_cvt_pk_bf16_f32 v69, v38, v39
    v_exp_f32 v41, v41
    v_exp_f32 v42, v42
    v_cvt_pk_bf16_f32 v70, v40, v41
    v_exp_f32 v43, v43
    v_mfma_f32_32x32x16_bf16 v[52:67], v[16:19], v[12:15], v[124:139]
    ds_read_b128 v[16:19], v2 offset:27040
    ds_read_b128 v[28:31], v3 offset:27040
    ds_read_b128 v[32:35], v156 offset:27040
    v_exp_f32 v44, v44
    v_cvt_pk_bf16_f32 v71, v42, v43
    v_exp_f32 v45, v45
    v_exp_f32 v46, v46
    v_cvt_pk_bf16_f32 v72, v44, v45
    v_exp_f32 v47, v47
    v_mfma_f32_32x32x16_bf16 v[76:91], v[20:23], v[68:71], v[76:91]
    v_exp_f32 v48, v48
    v_cvt_pk_bf16_f32 v73, v46, v47
    v_exp_f32 v49, v49
    v_exp_f32 v50, v50
    v_cvt_pk_bf16_f32 v74, v48, v49
    v_exp_f32 v51, v51
    v_exp_f32 v52, v52
    v_exp_f32 v53, v53
    v_cvt_pk_bf16_f32 v75, v50, v51
    v_exp_f32 v54, v54
    v_cvt_pk_bf16_f32 v68, v52, v53
    v_exp_f32 v55, v55
    v_mfma_f32_32x32x16_bf16 v[76:91], v[24:27], v[72:75], v[76:91]
    s_waitcnt lgkmcnt(0)
    v_exp_f32 v56, v56
    v_cvt_pk_bf16_f32 v69, v54, v55
    v_exp_f32 v57, v57
    v_exp_f32 v58, v58
    v_cvt_pk_bf16_f32 v70, v56, v57
    v_exp_f32 v59, v59
    v_mfma_f32_32x32x16_bf16 v[36:51], v[16:19], v[8:11], v[108:123]
    v_exp_f32 v60, v60
    v_cvt_pk_bf16_f32 v71, v58, v59
    v_exp_f32 v61, v61
    v_exp_f32 v62, v62
    v_cvt_pk_bf16_f32 v72, v60, v61
    v_exp_f32 v63, v63
    v_mfma_f32_32x32x16_bf16 v[92:107], v[20:23], v[68:71], v[92:107]
    v_exp_f32 v64, v64
    v_cvt_pk_bf16_f32 v73, v62, v63
    v_exp_f32 v65, v65
    v_exp_f32 v66, v66
    v_cvt_pk_bf16_f32 v74, v64, v65
    v_exp_f32 v67, v67
    v_exp_f32 v36, v36
    v_exp_f32 v37, v37
    v_cvt_pk_bf16_f32 v75, v66, v67
    v_exp_f32 v38, v38
    v_cvt_pk_bf16_f32 v68, v36, v37
    v_exp_f32 v39, v39
    v_mfma_f32_32x32x16_bf16 v[92:107], v[24:27], v[72:75], v[92:107]
    v_exp_f32 v40, v40
    v_cvt_pk_bf16_f32 v69, v38, v39
    v_exp_f32 v41, v41
    v_exp_f32 v42, v42
    v_cvt_pk_bf16_f32 v70, v40, v41
    v_exp_f32 v43, v43
    v_mfma_f32_32x32x16_bf16 v[52:67], v[16:19], v[12:15], v[124:139]
    ds_read_b128 v[16:19], v2 offset:29120
    ds_read_b128 v[20:23], v3 offset:29120
    ds_read_b128 v[24:27], v156 offset:29120
    v_exp_f32 v44, v44
    v_cvt_pk_bf16_f32 v71, v42, v43
    v_exp_f32 v45, v45
    v_exp_f32 v46, v46
    v_cvt_pk_bf16_f32 v72, v44, v45
    v_exp_f32 v47, v47
    v_mfma_f32_32x32x16_bf16 v[76:91], v[28:31], v[68:71], v[76:91]
    v_exp_f32 v48, v48
    v_cvt_pk_bf16_f32 v73, v46, v47
    v_exp_f32 v49, v49
    v_exp_f32 v50, v50
    v_cvt_pk_bf16_f32 v74, v48, v49
    v_exp_f32 v51, v51
    v_exp_f32 v52, v52
    v_exp_f32 v53, v53
    v_cvt_pk_bf16_f32 v75, v50, v51
    v_exp_f32 v54, v54
    v_cvt_pk_bf16_f32 v68, v52, v53
    v_exp_f32 v55, v55
    v_mfma_f32_32x32x16_bf16 v[76:91], v[32:35], v[72:75], v[76:91]
    s_waitcnt lgkmcnt(0)
    v_exp_f32 v56, v56
    v_cvt_pk_bf16_f32 v69, v54, v55
    v_exp_f32 v57, v57
    v_exp_f32 v58, v58
    v_cvt_pk_bf16_f32 v70, v56, v57
    v_exp_f32 v59, v59
    v_mfma_f32_32x32x16_bf16 v[36:51], v[16:19], v[8:11], v[108:123]
    v_exp_f32 v60, v60
    v_cvt_pk_bf16_f32 v71, v58, v59
    v_exp_f32 v61, v61
    v_exp_f32 v62, v62
    v_cvt_pk_bf16_f32 v72, v60, v61
    v_exp_f32 v63, v63
    v_mfma_f32_32x32x16_bf16 v[92:107], v[28:31], v[68:71], v[92:107]
    v_exp_f32 v64, v64
    v_cvt_pk_bf16_f32 v73, v62, v63
    v_exp_f32 v65, v65
    v_exp_f32 v66, v66
    v_cvt_pk_bf16_f32 v74, v64, v65
    v_exp_f32 v67, v67
    v_exp_f32 v36, v36
    v_exp_f32 v37, v37
    v_cvt_pk_bf16_f32 v75, v66, v67
    v_exp_f32 v38, v38
    v_cvt_pk_bf16_f32 v68, v36, v37
    v_exp_f32 v39, v39
    v_mfma_f32_32x32x16_bf16 v[92:107], v[32:35], v[72:75], v[92:107]
    v_exp_f32 v40, v40
    v_cvt_pk_bf16_f32 v69, v38, v39
    v_exp_f32 v41, v41
    v_exp_f32 v42, v42
    v_cvt_pk_bf16_f32 v70, v40, v41
    v_exp_f32 v43, v43
    v_mfma_f32_32x32x16_bf16 v[52:67], v[16:19], v[12:15], v[124:139]
    ds_read_b128 v[16:19], v2 offset:31200
    ds_read_b128 v[28:31], v3 offset:31200
    ds_read_b128 v[32:35], v156 offset:31200
    v_exp_f32 v44, v44
    v_cvt_pk_bf16_f32 v71, v42, v43
    v_exp_f32 v45, v45
    v_exp_f32 v46, v46
    v_cvt_pk_bf16_f32 v72, v44, v45
    v_exp_f32 v47, v47
    v_mfma_f32_32x32x16_bf16 v[76:91], v[20:23], v[68:71], v[76:91]
    v_exp_f32 v48, v48
    v_cvt_pk_bf16_f32 v73, v46, v47
    v_exp_f32 v49, v49
    v_exp_f32 v50, v50
    v_cvt_pk_bf16_f32 v74, v48, v49
    v_exp_f32 v51, v51
    v_exp_f32 v52, v52
    v_exp_f32 v53, v53
    v_cvt_pk_bf16_f32 v75, v50, v51
    v_exp_f32 v54, v54
    v_cvt_pk_bf16_f32 v68, v52, v53
    v_exp_f32 v55, v55
    v_mfma_f32_32x32x16_bf16 v[76:91], v[24:27], v[72:75], v[76:91]
    s_waitcnt lgkmcnt(0)
    v_exp_f32 v56, v56
    v_cvt_pk_bf16_f32 v69, v54, v55
    v_exp_f32 v57, v57
    v_exp_f32 v58, v58
    v_cvt_pk_bf16_f32 v70, v56, v57
    v_exp_f32 v59, v59
    v_mfma_f32_32x32x16_bf16 v[36:51], v[16:19], v[8:11], v[108:123]
    v_exp_f32 v60, v60
    v_cvt_pk_bf16_f32 v71, v58, v59
    v_exp_f32 v61, v61
    v_exp_f32 v62, v62
    v_cvt_pk_bf16_f32 v72, v60, v61
    v_exp_f32 v63, v63
    v_mfma_f32_32x32x16_bf16 v[92:107], v[20:23], v[68:71], v[92:107]
    v_exp_f32 v64, v64
    v_cvt_pk_bf16_f32 v73, v62, v63
    v_exp_f32 v65, v65
    v_exp_f32 v66, v66
    v_cvt_pk_bf16_f32 v74, v64, v65
    v_exp_f32 v67, v67
    v_exp_f32 v36, v36
    v_exp_f32 v37, v37
    v_cvt_pk_bf16_f32 v75, v66, v67
    v_exp_f32 v38, v38
    v_cvt_pk_bf16_f32 v68, v36, v37
    v_exp_f32 v39, v39
    v_mfma_f32_32x32x16_bf16 v[92:107], v[24:27], v[72:75], v[92:107]
    v_exp_f32 v40, v40
    v_cvt_pk_bf16_f32 v69, v38, v39
    v_exp_f32 v41, v41
    v_exp_f32 v42, v42
    v_cvt_pk_bf16_f32 v70, v40, v41
    v_exp_f32 v43, v43
    v_mfma_f32_32x32x16_bf16 v[52:67], v[16:19], v[12:15], v[124:139]
    ds_read_b128 v[16:19], v2 offset:33280
    ds_read_b128 v[20:23], v3 offset:33280
    ds_read_b128 v[24:27], v156 offset:33280
    v_exp_f32 v44, v44
    v_cvt_pk_bf16_f32 v71, v42, v43
    v_exp_f32 v45, v45
    v_exp_f32 v46, v46
    v_cvt_pk_bf16_f32 v72, v44, v45
    v_exp_f32 v47, v47
    v_mfma_f32_32x32x16_bf16 v[76:91], v[28:31], v[68:71], v[76:91]
    v_exp_f32 v48, v48
    v_cvt_pk_bf16_f32 v73, v46, v47
    v_exp_f32 v49, v49
    v_exp_f32 v50, v50
    v_cvt_pk_bf16_f32 v74, v48, v49
    v_exp_f32 v51, v51
    v_exp_f32 v52, v52
    v_exp_f32 v53, v53
    v_cvt_pk_bf16_f32 v75, v50, v51
    v_exp_f32 v54, v54
    v_cvt_pk_bf16_f32 v68, v52, v53
    v_exp_f32 v55, v55
    v_mfma_f32_32x32x16_bf16 v[76:91], v[32:35], v[72:75], v[76:91]
    s_waitcnt lgkmcnt(0)
    v_exp_f32 v56, v56
    v_cvt_pk_bf16_f32 v69, v54, v55
    v_exp_f32 v57, v57
    v_exp_f32 v58, v58
    v_cvt_pk_bf16_f32 v70, v56, v57
    v_exp_f32 v59, v59
    v_mfma_f32_32x32x16_bf16 v[36:51], v[16:19], v[8:11], v[108:123]
    v_exp_f32 v60, v60
    v_cvt_pk_bf16_f32 v71, v58, v59
    v_exp_f32 v61, v61
    v_exp_f32 v62, v62
    v_cvt_pk_bf16_f32 v72, v60, v61
    v_exp_f32 v63, v63
    v_mfma_f32_32x32x16_bf16 v[92:107], v[28:31], v[68:71], v[92:107]
    v_exp_f32 v64, v64
    v_cvt_pk_bf16_f32 v73, v62, v63
    v_exp_f32 v65, v65
    v_exp_f32 v66, v66
    v_cvt_pk_bf16_f32 v74, v64, v65
    v_exp_f32 v67, v67
    v_exp_f32 v36, v36
    v_exp_f32 v37, v37
    v_cvt_pk_bf16_f32 v75, v66, v67
    v_exp_f32 v38, v38
    v_cvt_pk_bf16_f32 v68, v36, v37
    v_exp_f32 v39, v39
    v_mfma_f32_32x32x16_bf16 v[92:107], v[32:35], v[72:75], v[92:107]
    v_exp_f32 v40, v40
    v_cvt_pk_bf16_f32 v69, v38, v39
    v_exp_f32 v41, v41
    v_exp_f32 v42, v42
    v_cvt_pk_bf16_f32 v70, v40, v41
    v_exp_f32 v43, v43
    v_mfma_f32_32x32x16_bf16 v[52:67], v[16:19], v[12:15], v[124:139]
    ds_read_b128 v[16:19], v2 offset:35360
    ds_read_b128 v[28:31], v3 offset:35360
    ds_read_b128 v[32:35], v156 offset:35360
    v_exp_f32 v44, v44
    v_cvt_pk_bf16_f32 v71, v42, v43
    s_waitcnt vmcnt(6)
    v_exp_f32 v45, v45
    ds_write_b128 v220, a[192:195] offset:0
    v_exp_f32 v46, v46
    v_cvt_pk_bf16_f32 v72, v44, v45
    ds_write_b128 v220, a[196:199] offset:1024
    v_exp_f32 v47, v47
    v_mfma_f32_32x32x16_bf16 v[76:91], v[20:23], v[68:71], v[76:91]
    ds_write_b128 v220, a[200:203] offset:2048
    v_exp_f32 v48, v48
    v_cvt_pk_bf16_f32 v73, v46, v47
    ds_write_b128 v220, a[204:207] offset:3072
    v_exp_f32 v49, v49
    v_exp_f32 v50, v50
    v_cvt_pk_bf16_f32 v74, v48, v49
    v_exp_f32 v51, v51
    v_exp_f32 v52, v52
    v_exp_f32 v53, v53
    v_cvt_pk_bf16_f32 v75, v50, v51
    v_exp_f32 v54, v54
    v_cvt_pk_bf16_f32 v68, v52, v53
    v_exp_f32 v55, v55
    v_mfma_f32_32x32x16_bf16 v[76:91], v[24:27], v[72:75], v[76:91]
    s_waitcnt lgkmcnt(0)
    v_exp_f32 v56, v56
    v_cvt_pk_bf16_f32 v69, v54, v55
    v_exp_f32 v57, v57
    v_exp_f32 v58, v58
    v_cvt_pk_bf16_f32 v70, v56, v57
    v_exp_f32 v59, v59
    v_mfma_f32_32x32x16_bf16 v[36:51], v[16:19], v[8:11], v[108:123]
    v_exp_f32 v60, v60
    v_cvt_pk_bf16_f32 v71, v58, v59
    v_exp_f32 v61, v61
    v_exp_f32 v62, v62
    v_cvt_pk_bf16_f32 v72, v60, v61
    v_exp_f32 v63, v63
    v_mfma_f32_32x32x16_bf16 v[92:107], v[20:23], v[68:71], v[92:107]
    v_exp_f32 v64, v64
    v_cvt_pk_bf16_f32 v73, v62, v63
    v_exp_f32 v65, v65
    v_exp_f32 v66, v66
    v_cvt_pk_bf16_f32 v74, v64, v65
    v_exp_f32 v67, v67
    v_exp_f32 v36, v36
    v_exp_f32 v37, v37
    v_cvt_pk_bf16_f32 v75, v66, v67
    v_exp_f32 v38, v38
    v_cvt_pk_bf16_f32 v68, v36, v37
    v_exp_f32 v39, v39
    v_mfma_f32_32x32x16_bf16 v[92:107], v[24:27], v[72:75], v[92:107]
    v_exp_f32 v40, v40
    v_cvt_pk_bf16_f32 v69, v38, v39
    v_exp_f32 v41, v41
    v_exp_f32 v42, v42
    v_cvt_pk_bf16_f32 v70, v40, v41
    v_exp_f32 v43, v43
    v_mfma_f32_32x32x16_bf16 v[52:67], v[16:19], v[12:15], v[124:139]
    ds_read_b128 v[16:19], v2 offset:37440
    ds_read_b128 v[20:23], v3 offset:37440
    ds_read_b128 v[24:27], v156 offset:37440
    v_exp_f32 v44, v44
    v_cvt_pk_bf16_f32 v71, v42, v43
    v_exp_f32 v45, v45
    ds_read_b64_tr_b16 v[168:169], v160
    v_exp_f32 v46, v46
    ds_read_b64_tr_b16 v[170:171], v164
    v_cvt_pk_bf16_f32 v72, v44, v45
    ds_read_b64_tr_b16 v[172:173], v161
    v_exp_f32 v47, v47
    ds_read_b64_tr_b16 v[174:175], v165
    v_mfma_f32_32x32x16_bf16 v[76:91], v[28:31], v[68:71], v[76:91]
    ds_read_b64_tr_b16 v[176:177], v162
    v_exp_f32 v48, v48
    ds_read_b64_tr_b16 v[178:179], v166
    v_cvt_pk_bf16_f32 v73, v46, v47
    ds_read_b64_tr_b16 v[180:181], v163
    v_exp_f32 v49, v49
    ds_read_b64_tr_b16 v[182:183], v167
    v_exp_f32 v50, v50
    v_cvt_pk_bf16_f32 v74, v48, v49
    v_exp_f32 v51, v51
    v_exp_f32 v52, v52
    v_exp_f32 v53, v53
    v_cvt_pk_bf16_f32 v75, v50, v51
    v_exp_f32 v54, v54
    v_cvt_pk_bf16_f32 v68, v52, v53
    v_exp_f32 v55, v55
    v_mfma_f32_32x32x16_bf16 v[76:91], v[32:35], v[72:75], v[76:91]
    s_waitcnt lgkmcnt(0)
    v_exp_f32 v56, v56
    v_cvt_pk_bf16_f32 v69, v54, v55
    v_exp_f32 v57, v57
    v_exp_f32 v58, v58
    v_cvt_pk_bf16_f32 v70, v56, v57
    v_exp_f32 v59, v59
    v_mfma_f32_32x32x16_bf16 v[36:51], v[16:19], v[8:11], v[108:123]
    buffer_store_dwordx4 v[168:171], v2, s[24:27], s16 offen sc1
    v_exp_f32 v60, v60
    v_cvt_pk_bf16_f32 v71, v58, v59
    v_exp_f32 v61, v61
    v_exp_f32 v62, v62
    v_cvt_pk_bf16_f32 v72, v60, v61
    v_exp_f32 v63, v63
    v_mfma_f32_32x32x16_bf16 v[92:107], v[28:31], v[68:71], v[92:107]
    v_exp_f32 v64, v64
    v_cvt_pk_bf16_f32 v73, v62, v63
    v_exp_f32 v65, v65
    v_exp_f32 v66, v66
    v_cvt_pk_bf16_f32 v74, v64, v65
    v_exp_f32 v67, v67
    v_exp_f32 v36, v36
    v_exp_f32 v37, v37
    v_cvt_pk_bf16_f32 v75, v66, v67
    v_exp_f32 v38, v38
    v_cvt_pk_bf16_f32 v68, v36, v37
    v_exp_f32 v39, v39
    v_mfma_f32_32x32x16_bf16 v[92:107], v[32:35], v[72:75], v[92:107]
    v_exp_f32 v40, v40
    v_cvt_pk_bf16_f32 v69, v38, v39
    v_exp_f32 v41, v41
    v_exp_f32 v42, v42
    v_cvt_pk_bf16_f32 v70, v40, v41
    v_exp_f32 v43, v43
    v_mfma_f32_32x32x16_bf16 v[52:67], v[16:19], v[12:15], v[124:139]
    ds_read_b128 v[16:19], v2 offset:39520
    ds_read_b128 v[28:31], v3 offset:39520
    ds_read_b128 v[32:35], v156 offset:39520
    v_exp_f32 v44, v44
    v_cvt_pk_bf16_f32 v71, v42, v43
    v_exp_f32 v45, v45
    v_exp_f32 v46, v46
    v_cvt_pk_bf16_f32 v72, v44, v45
    v_exp_f32 v47, v47
    v_mfma_f32_32x32x16_bf16 v[76:91], v[20:23], v[68:71], v[76:91]
    v_exp_f32 v48, v48
    v_cvt_pk_bf16_f32 v73, v46, v47
    v_exp_f32 v49, v49
    v_exp_f32 v50, v50
    v_cvt_pk_bf16_f32 v74, v48, v49
    v_exp_f32 v51, v51
    v_exp_f32 v52, v52
    v_exp_f32 v53, v53
    v_cvt_pk_bf16_f32 v75, v50, v51
    v_exp_f32 v54, v54
    v_cvt_pk_bf16_f32 v68, v52, v53
    v_exp_f32 v55, v55
    v_mfma_f32_32x32x16_bf16 v[76:91], v[24:27], v[72:75], v[76:91]
    s_waitcnt lgkmcnt(0)
    v_exp_f32 v56, v56
    v_cvt_pk_bf16_f32 v69, v54, v55
    v_exp_f32 v57, v57
    v_exp_f32 v58, v58
    v_cvt_pk_bf16_f32 v70, v56, v57
    v_exp_f32 v59, v59
    v_mfma_f32_32x32x16_bf16 v[36:51], v[16:19], v[8:11], v[108:123]
    buffer_store_dwordx4 v[172:175], v2, s[24:27], s17 offen sc1
    v_exp_f32 v60, v60
    v_cvt_pk_bf16_f32 v71, v58, v59
    v_exp_f32 v61, v61
    v_exp_f32 v62, v62
    v_cvt_pk_bf16_f32 v72, v60, v61
    v_exp_f32 v63, v63
    v_mfma_f32_32x32x16_bf16 v[92:107], v[20:23], v[68:71], v[92:107]
    v_exp_f32 v64, v64
    v_cvt_pk_bf16_f32 v73, v62, v63
    v_exp_f32 v65, v65
    v_exp_f32 v66, v66
    v_cvt_pk_bf16_f32 v74, v64, v65
    v_exp_f32 v67, v67
    v_exp_f32 v36, v36
    v_exp_f32 v37, v37
    v_cvt_pk_bf16_f32 v75, v66, v67
    v_exp_f32 v38, v38
    v_cvt_pk_bf16_f32 v68, v36, v37
    v_exp_f32 v39, v39
    v_mfma_f32_32x32x16_bf16 v[92:107], v[24:27], v[72:75], v[92:107]
    v_exp_f32 v40, v40
    v_cvt_pk_bf16_f32 v69, v38, v39
    v_exp_f32 v41, v41
    v_exp_f32 v42, v42
    v_cvt_pk_bf16_f32 v70, v40, v41
    v_exp_f32 v43, v43
    v_mfma_f32_32x32x16_bf16 v[52:67], v[16:19], v[12:15], v[124:139]
    ds_read_b128 v[16:19], v2 offset:41600
    ds_read_b128 v[20:23], v3 offset:41600
    ds_read_b128 v[24:27], v156 offset:41600
    v_exp_f32 v44, v44
    v_cvt_pk_bf16_f32 v71, v42, v43
    v_exp_f32 v45, v45
    v_exp_f32 v46, v46
    v_cvt_pk_bf16_f32 v72, v44, v45
    v_exp_f32 v47, v47
    v_mfma_f32_32x32x16_bf16 v[76:91], v[28:31], v[68:71], v[76:91]
    v_exp_f32 v48, v48
    v_cvt_pk_bf16_f32 v73, v46, v47
    v_exp_f32 v49, v49
    v_exp_f32 v50, v50
    v_cvt_pk_bf16_f32 v74, v48, v49
    v_exp_f32 v51, v51
    v_exp_f32 v52, v52
    v_exp_f32 v53, v53
    v_cvt_pk_bf16_f32 v75, v50, v51
    v_exp_f32 v54, v54
    v_cvt_pk_bf16_f32 v68, v52, v53
    v_exp_f32 v55, v55
    v_mfma_f32_32x32x16_bf16 v[76:91], v[32:35], v[72:75], v[76:91]
    s_waitcnt lgkmcnt(0)
    v_exp_f32 v56, v56
    v_cvt_pk_bf16_f32 v69, v54, v55
    v_exp_f32 v57, v57
    v_exp_f32 v58, v58
    v_cvt_pk_bf16_f32 v70, v56, v57
    v_exp_f32 v59, v59
    v_mfma_f32_32x32x16_bf16 v[36:51], v[16:19], v[8:11], v[108:123]
    buffer_store_dwordx4 v[176:179], v2, s[24:27], s18 offen sc1
    v_exp_f32 v60, v60
    v_cvt_pk_bf16_f32 v71, v58, v59
    v_exp_f32 v61, v61
    v_exp_f32 v62, v62
    v_cvt_pk_bf16_f32 v72, v60, v61
    v_exp_f32 v63, v63
    v_mfma_f32_32x32x16_bf16 v[92:107], v[28:31], v[68:71], v[92:107]
    v_exp_f32 v64, v64
    v_cvt_pk_bf16_f32 v73, v62, v63
    v_exp_f32 v65, v65
    v_exp_f32 v66, v66
    v_cvt_pk_bf16_f32 v74, v64, v65
    v_exp_f32 v67, v67
    v_exp_f32 v36, v36
    v_exp_f32 v37, v37
    v_cvt_pk_bf16_f32 v75, v66, v67
    v_exp_f32 v38, v38
    v_cvt_pk_bf16_f32 v68, v36, v37
    v_exp_f32 v39, v39
    v_mfma_f32_32x32x16_bf16 v[92:107], v[32:35], v[72:75], v[92:107]
    v_exp_f32 v40, v40
    v_cvt_pk_bf16_f32 v69, v38, v39
    v_exp_f32 v41, v41
    v_exp_f32 v42, v42
    v_cvt_pk_bf16_f32 v70, v40, v41
    v_exp_f32 v43, v43
    v_mfma_f32_32x32x16_bf16 v[52:67], v[16:19], v[12:15], v[124:139]
    ds_read_b128 v[16:19], v2 offset:43680
    ds_read_b128 v[28:31], v3 offset:43680
    ds_read_b128 v[32:35], v156 offset:43680
    v_exp_f32 v44, v44
    v_cvt_pk_bf16_f32 v71, v42, v43
    v_exp_f32 v45, v45
    v_exp_f32 v46, v46
    v_cvt_pk_bf16_f32 v72, v44, v45
    v_exp_f32 v47, v47
    v_mfma_f32_32x32x16_bf16 v[76:91], v[20:23], v[68:71], v[76:91]
    v_exp_f32 v48, v48
    v_cvt_pk_bf16_f32 v73, v46, v47
    v_exp_f32 v49, v49
    v_exp_f32 v50, v50
    v_cvt_pk_bf16_f32 v74, v48, v49
    v_exp_f32 v51, v51
    v_exp_f32 v52, v52
    v_exp_f32 v53, v53
    v_cvt_pk_bf16_f32 v75, v50, v51
    v_exp_f32 v54, v54
    v_cvt_pk_bf16_f32 v68, v52, v53
    v_exp_f32 v55, v55
    v_mfma_f32_32x32x16_bf16 v[76:91], v[24:27], v[72:75], v[76:91]
    s_waitcnt lgkmcnt(0)
    v_exp_f32 v56, v56
    v_cvt_pk_bf16_f32 v69, v54, v55
    v_exp_f32 v57, v57
    v_exp_f32 v58, v58
    v_cvt_pk_bf16_f32 v70, v56, v57
    v_exp_f32 v59, v59
    v_mfma_f32_32x32x16_bf16 v[36:51], v[16:19], v[8:11], v[108:123]
    buffer_store_dwordx4 v[180:183], v2, s[24:27], s19 offen sc1
    v_exp_f32 v60, v60
    v_cvt_pk_bf16_f32 v71, v58, v59
    v_exp_f32 v61, v61
    v_exp_f32 v62, v62
    v_cvt_pk_bf16_f32 v72, v60, v61
    v_exp_f32 v63, v63
    v_mfma_f32_32x32x16_bf16 v[92:107], v[20:23], v[68:71], v[92:107]
    v_exp_f32 v64, v64
    v_cvt_pk_bf16_f32 v73, v62, v63
    v_exp_f32 v65, v65
    v_exp_f32 v66, v66
    v_cvt_pk_bf16_f32 v74, v64, v65
    v_exp_f32 v67, v67
    v_exp_f32 v36, v36
    v_exp_f32 v37, v37
    v_cvt_pk_bf16_f32 v75, v66, v67
    v_exp_f32 v38, v38
    v_cvt_pk_bf16_f32 v68, v36, v37
    v_exp_f32 v39, v39
    v_mfma_f32_32x32x16_bf16 v[92:107], v[24:27], v[72:75], v[92:107]
    v_exp_f32 v40, v40
    v_cvt_pk_bf16_f32 v69, v38, v39
    v_exp_f32 v41, v41
    v_exp_f32 v42, v42
    v_cvt_pk_bf16_f32 v70, v40, v41
    v_exp_f32 v43, v43
    v_mfma_f32_32x32x16_bf16 v[52:67], v[16:19], v[12:15], v[124:139]
    ds_read_b128 v[16:19], v2 offset:45760
    ds_read_b128 v[20:23], v3 offset:45760
    ds_read_b128 v[24:27], v156 offset:45760
    v_exp_f32 v44, v44
    v_cvt_pk_bf16_f32 v71, v42, v43
    v_exp_f32 v45, v45
    v_exp_f32 v46, v46
    v_cvt_pk_bf16_f32 v72, v44, v45
    v_exp_f32 v47, v47
    v_mfma_f32_32x32x16_bf16 v[76:91], v[28:31], v[68:71], v[76:91]
    v_exp_f32 v48, v48
    v_cvt_pk_bf16_f32 v73, v46, v47
    v_exp_f32 v49, v49
    v_exp_f32 v50, v50
    v_cvt_pk_bf16_f32 v74, v48, v49
    v_exp_f32 v51, v51
    v_exp_f32 v52, v52
    v_exp_f32 v53, v53
    v_cvt_pk_bf16_f32 v75, v50, v51
    v_exp_f32 v54, v54
    v_cvt_pk_bf16_f32 v68, v52, v53
    v_exp_f32 v55, v55
    v_mfma_f32_32x32x16_bf16 v[76:91], v[32:35], v[72:75], v[76:91]
    s_waitcnt lgkmcnt(0)
    v_exp_f32 v56, v56
    v_cvt_pk_bf16_f32 v69, v54, v55
    v_exp_f32 v57, v57
    v_exp_f32 v58, v58
    v_cvt_pk_bf16_f32 v70, v56, v57
    v_exp_f32 v59, v59
    v_mfma_f32_32x32x16_bf16 v[36:51], v[16:19], v[8:11], v[108:123]
    v_exp_f32 v60, v60
    v_cvt_pk_bf16_f32 v71, v58, v59
    v_exp_f32 v61, v61
    v_exp_f32 v62, v62
    v_cvt_pk_bf16_f32 v72, v60, v61
    v_exp_f32 v63, v63
    v_mfma_f32_32x32x16_bf16 v[92:107], v[28:31], v[68:71], v[92:107]
    v_exp_f32 v64, v64
    v_cvt_pk_bf16_f32 v73, v62, v63
    v_exp_f32 v65, v65
    v_exp_f32 v66, v66
    v_cvt_pk_bf16_f32 v74, v64, v65
    v_exp_f32 v67, v67
    v_exp_f32 v36, v36
    v_exp_f32 v37, v37
    v_cvt_pk_bf16_f32 v75, v66, v67
    v_exp_f32 v38, v38
    v_cvt_pk_bf16_f32 v68, v36, v37
    v_exp_f32 v39, v39
    v_mfma_f32_32x32x16_bf16 v[92:107], v[32:35], v[72:75], v[92:107]
    v_exp_f32 v40, v40
    v_cvt_pk_bf16_f32 v69, v38, v39
    v_exp_f32 v41, v41
    v_exp_f32 v42, v42
    v_cvt_pk_bf16_f32 v70, v40, v41
    v_exp_f32 v43, v43
    v_mfma_f32_32x32x16_bf16 v[52:67], v[16:19], v[12:15], v[124:139]
    ds_read_b128 v[16:19], v2 offset:47840
    ds_read_b128 v[28:31], v3 offset:47840
    ds_read_b128 v[32:35], v156 offset:47840
    v_exp_f32 v44, v44
    v_cvt_pk_bf16_f32 v71, v42, v43
    v_exp_f32 v45, v45
    v_exp_f32 v46, v46
    v_cvt_pk_bf16_f32 v72, v44, v45
    v_exp_f32 v47, v47
    v_mfma_f32_32x32x16_bf16 v[76:91], v[20:23], v[68:71], v[76:91]
    v_exp_f32 v48, v48
    v_cvt_pk_bf16_f32 v73, v46, v47
    v_exp_f32 v49, v49
    v_exp_f32 v50, v50
    v_cvt_pk_bf16_f32 v74, v48, v49
    v_exp_f32 v51, v51
    v_exp_f32 v52, v52
    v_exp_f32 v53, v53
    v_cvt_pk_bf16_f32 v75, v50, v51
    v_exp_f32 v54, v54
    v_cvt_pk_bf16_f32 v68, v52, v53
    v_exp_f32 v55, v55
    v_mfma_f32_32x32x16_bf16 v[76:91], v[24:27], v[72:75], v[76:91]
    s_waitcnt lgkmcnt(0)
    v_exp_f32 v56, v56
    v_cvt_pk_bf16_f32 v69, v54, v55
    v_exp_f32 v57, v57
    v_exp_f32 v58, v58
    v_cvt_pk_bf16_f32 v70, v56, v57
    v_exp_f32 v59, v59
    v_mfma_f32_32x32x16_bf16 v[36:51], v[16:19], v[8:11], v[108:123]
    v_exp_f32 v60, v60
    v_cvt_pk_bf16_f32 v71, v58, v59
    v_exp_f32 v61, v61
    v_exp_f32 v62, v62
    v_cvt_pk_bf16_f32 v72, v60, v61
    v_exp_f32 v63, v63
    v_mfma_f32_32x32x16_bf16 v[92:107], v[20:23], v[68:71], v[92:107]
    v_exp_f32 v64, v64
    v_cvt_pk_bf16_f32 v73, v62, v63
    v_exp_f32 v65, v65
    v_exp_f32 v66, v66
    v_cvt_pk_bf16_f32 v74, v64, v65
    v_exp_f32 v67, v67
    v_exp_f32 v36, v36
    v_exp_f32 v37, v37
    v_cvt_pk_bf16_f32 v75, v66, v67
    v_exp_f32 v38, v38
    v_cvt_pk_bf16_f32 v68, v36, v37
    v_exp_f32 v39, v39
    v_mfma_f32_32x32x16_bf16 v[92:107], v[24:27], v[72:75], v[92:107]
    v_exp_f32 v40, v40
    v_cvt_pk_bf16_f32 v69, v38, v39
    v_exp_f32 v41, v41
    v_exp_f32 v42, v42
    v_cvt_pk_bf16_f32 v70, v40, v41
    v_exp_f32 v43, v43
    v_mfma_f32_32x32x16_bf16 v[52:67], v[16:19], v[12:15], v[124:139]
    s_waitcnt vmcnt(0)
    s_barrier
    s_cmp_lg_u32 s3, 1
    s_cbranch_scc1 L_noxid
    s_mov_b32 s38, s98
    s_add_u32 s39, s0, 28377088
    s_mov_b64 exec, 1
    v_mov_b32 v6, 0
    v_mov_b32 v7, s38
    buffer_store_dword v7, v6, s[24:27], s39 offen sc1
    s_mov_b64 exec, -1
L_noxid:
    ds_read_b128 v[16:19], v2 offset:49920
    ds_read_b128 v[20:23], v3 offset:49920
    ds_read_b128 v[24:27], v156 offset:49920
    v_exp_f32 v44, v44
    v_cvt_pk_bf16_f32 v71, v42, v43
    v_exp_f32 v45, v45
    v_exp_f32 v46, v46
    v_cvt_pk_bf16_f32 v72, v44, v45
    v_exp_f32 v47, v47
    v_mfma_f32_32x32x16_bf16 v[76:91], v[28:31], v[68:71], v[76:91]
    v_exp_f32 v48, v48
    v_cvt_pk_bf16_f32 v73, v46, v47
    v_exp_f32 v49, v49
    v_exp_f32 v50, v50
    v_cvt_pk_bf16_f32 v74, v48, v49
    v_exp_f32 v51, v51
    v_exp_f32 v52, v52
    v_exp_f32 v53, v53
    v_cvt_pk_bf16_f32 v75, v50, v51
    v_exp_f32 v54, v54
    v_cvt_pk_bf16_f32 v68, v52, v53
    v_exp_f32 v55, v55
    v_mfma_f32_32x32x16_bf16 v[76:91], v[32:35], v[72:75], v[76:91]
    s_waitcnt lgkmcnt(0)
    v_exp_f32 v56, v56
    v_cvt_pk_bf16_f32 v69, v54, v55
    v_exp_f32 v57, v57
    v_exp_f32 v58, v58
    v_cvt_pk_bf16_f32 v70, v56, v57
    v_exp_f32 v59, v59
    v_mfma_f32_32x32x16_bf16 v[36:51], v[16:19], v[8:11], v[108:123]
    buffer_load_dwordx4 v[184:187], v221, s[4:7], s15 offen
    v_exp_f32 v60, v60
    v_cvt_pk_bf16_f32 v71, v58, v59
    v_exp_f32 v61, v61
    v_exp_f32 v62, v62
    v_cvt_pk_bf16_f32 v72, v60, v61
    v_exp_f32 v63, v63
    v_mfma_f32_32x32x16_bf16 v[92:107], v[28:31], v[68:71], v[92:107]
    v_exp_f32 v64, v64
    v_cvt_pk_bf16_f32 v73, v62, v63
    v_exp_f32 v65, v65
    v_exp_f32 v66, v66
    v_cvt_pk_bf16_f32 v74, v64, v65
    v_exp_f32 v67, v67
    v_exp_f32 v36, v36
    v_exp_f32 v37, v37
    v_cvt_pk_bf16_f32 v75, v66, v67
    v_exp_f32 v38, v38
    v_cvt_pk_bf16_f32 v68, v36, v37
    v_exp_f32 v39, v39
    v_mfma_f32_32x32x16_bf16 v[92:107], v[32:35], v[72:75], v[92:107]
    s_add_u32 s15, s15, 6144
    buffer_load_dwordx4 v[188:191], v221, s[4:7], s15 offen
    v_exp_f32 v40, v40
    v_cvt_pk_bf16_f32 v69, v38, v39
    v_exp_f32 v41, v41
    v_exp_f32 v42, v42
    v_cvt_pk_bf16_f32 v70, v40, v41
    v_exp_f32 v43, v43
    v_mfma_f32_32x32x16_bf16 v[52:67], v[16:19], v[12:15], v[124:139]
    ds_read_b128 v[16:19], v2 offset:52000
    ds_read_b128 v[28:31], v3 offset:52000
    ds_read_b128 v[32:35], v156 offset:52000
    v_exp_f32 v44, v44
    v_cvt_pk_bf16_f32 v71, v42, v43
    v_exp_f32 v45, v45
    v_exp_f32 v46, v46
    v_cvt_pk_bf16_f32 v72, v44, v45
    v_exp_f32 v47, v47
    v_mfma_f32_32x32x16_bf16 v[76:91], v[20:23], v[68:71], v[76:91]
    v_exp_f32 v48, v48
    v_cvt_pk_bf16_f32 v73, v46, v47
    v_exp_f32 v49, v49
    v_exp_f32 v50, v50
    v_cvt_pk_bf16_f32 v74, v48, v49
    v_exp_f32 v51, v51
    v_exp_f32 v52, v52
    v_exp_f32 v53, v53
    v_cvt_pk_bf16_f32 v75, v50, v51
    v_exp_f32 v54, v54
    v_cvt_pk_bf16_f32 v68, v52, v53
    v_exp_f32 v55, v55
    v_mfma_f32_32x32x16_bf16 v[76:91], v[24:27], v[72:75], v[76:91]
    s_waitcnt lgkmcnt(0)
    v_exp_f32 v56, v56
    v_cvt_pk_bf16_f32 v69, v54, v55
    v_exp_f32 v57, v57
    v_exp_f32 v58, v58
    v_cvt_pk_bf16_f32 v70, v56, v57
    v_exp_f32 v59, v59
    v_mfma_f32_32x32x16_bf16 v[36:51], v[16:19], v[8:11], v[108:123]
    s_add_u32 s15, s15, 6144
    buffer_load_dwordx4 v[192:195], v221, s[4:7], s15 offen
    v_exp_f32 v60, v60
    v_cvt_pk_bf16_f32 v71, v58, v59
    v_exp_f32 v61, v61
    v_exp_f32 v62, v62
    v_cvt_pk_bf16_f32 v72, v60, v61
    v_exp_f32 v63, v63
    v_mfma_f32_32x32x16_bf16 v[92:107], v[20:23], v[68:71], v[92:107]
    v_exp_f32 v64, v64
    v_cvt_pk_bf16_f32 v73, v62, v63
    v_exp_f32 v65, v65
    v_exp_f32 v66, v66
    v_cvt_pk_bf16_f32 v74, v64, v65
    v_exp_f32 v67, v67
    v_exp_f32 v36, v36
    v_exp_f32 v37, v37
    v_cvt_pk_bf16_f32 v75, v66, v67
    v_exp_f32 v38, v38
    v_cvt_pk_bf16_f32 v68, v36, v37
    v_exp_f32 v39, v39
    v_mfma_f32_32x32x16_bf16 v[92:107], v[24:27], v[72:75], v[92:107]
    s_add_u32 s15, s15, 6144
    buffer_load_dwordx4 v[196:199], v221, s[4:7], s15 offen
    v_exp_f32 v40, v40
    v_cvt_pk_bf16_f32 v69, v38, v39
    v_exp_f32 v41, v41
    v_exp_f32 v42, v42
    v_cvt_pk_bf16_f32 v70, v40, v41
    v_exp_f32 v43, v43
    v_mfma_f32_32x32x16_bf16 v[52:67], v[16:19], v[12:15], v[124:139]
    ds_read_b128 v[16:19], v2 offset:54080
    ds_read_b128 v[20:23], v3 offset:54080
    ds_read_b128 v[24:27], v156 offset:54080
    v_exp_f32 v44, v44
    v_cvt_pk_bf16_f32 v71, v42, v43
    v_exp_f32 v45, v45
    v_exp_f32 v46, v46
    v_cvt_pk_bf16_f32 v72, v44, v45
    v_exp_f32 v47, v47
    v_mfma_f32_32x32x16_bf16 v[76:91], v[28:31], v[68:71], v[76:91]
    v_exp_f32 v48, v48
    v_cvt_pk_bf16_f32 v73, v46, v47
    v_exp_f32 v49, v49
    v_exp_f32 v50, v50
    v_cvt_pk_bf16_f32 v74, v48, v49
    v_exp_f32 v51, v51
    v_exp_f32 v52, v52
    v_exp_f32 v53, v53
    v_cvt_pk_bf16_f32 v75, v50, v51
    v_exp_f32 v54, v54
    v_cvt_pk_bf16_f32 v68, v52, v53
    v_exp_f32 v55, v55
    v_mfma_f32_32x32x16_bf16 v[76:91], v[32:35], v[72:75], v[76:91]
    s_waitcnt lgkmcnt(0)
    v_exp_f32 v56, v56
    v_cvt_pk_bf16_f32 v69, v54, v55
    v_exp_f32 v57, v57
    v_exp_f32 v58, v58
    v_cvt_pk_bf16_f32 v70, v56, v57
    v_exp_f32 v59, v59
    v_mfma_f32_32x32x16_bf16 v[36:51], v[16:19], v[8:11], v[108:123]
    v_exp_f32 v60, v60
    v_cvt_pk_bf16_f32 v71, v58, v59
    v_exp_f32 v61, v61
    v_exp_f32 v62, v62
    v_cvt_pk_bf16_f32 v72, v60, v61
    v_exp_f32 v63, v63
    v_mfma_f32_32x32x16_bf16 v[92:107], v[28:31], v[68:71], v[92:107]
    v_exp_f32 v64, v64
    v_cvt_pk_bf16_f32 v73, v62, v63
    v_exp_f32 v65, v65
    v_exp_f32 v66, v66
    v_cvt_pk_bf16_f32 v74, v64, v65
    v_exp_f32 v67, v67
    v_exp_f32 v36, v36
    v_exp_f32 v37, v37
    v_cvt_pk_bf16_f32 v75, v66, v67
    v_exp_f32 v38, v38
    v_cvt_pk_bf16_f32 v68, v36, v37
    v_exp_f32 v39, v39
    v_mfma_f32_32x32x16_bf16 v[92:107], v[32:35], v[72:75], v[92:107]
    v_exp_f32 v40, v40
    v_cvt_pk_bf16_f32 v69, v38, v39
    v_exp_f32 v41, v41
    v_exp_f32 v42, v42
    v_cvt_pk_bf16_f32 v70, v40, v41
    v_exp_f32 v43, v43
    v_mfma_f32_32x32x16_bf16 v[52:67], v[16:19], v[12:15], v[124:139]
    ds_read_b128 v[16:19], v2 offset:56160
    ds_read_b128 v[28:31], v3 offset:56160
    ds_read_b128 v[32:35], v156 offset:56160
    v_exp_f32 v44, v44
    v_cvt_pk_bf16_f32 v71, v42, v43
    v_exp_f32 v45, v45
    v_exp_f32 v46, v46
    v_cvt_pk_bf16_f32 v72, v44, v45
    v_exp_f32 v47, v47
    v_mfma_f32_32x32x16_bf16 v[76:91], v[20:23], v[68:71], v[76:91]
    v_exp_f32 v48, v48
    v_cvt_pk_bf16_f32 v73, v46, v47
    v_exp_f32 v49, v49
    v_exp_f32 v50, v50
    v_cvt_pk_bf16_f32 v74, v48, v49
    v_exp_f32 v51, v51
    v_exp_f32 v52, v52
    v_exp_f32 v53, v53
    v_cvt_pk_bf16_f32 v75, v50, v51
    v_exp_f32 v54, v54
    v_cvt_pk_bf16_f32 v68, v52, v53
    v_exp_f32 v55, v55
    v_mfma_f32_32x32x16_bf16 v[76:91], v[24:27], v[72:75], v[76:91]
    s_waitcnt lgkmcnt(0)
    v_exp_f32 v56, v56
    v_cvt_pk_bf16_f32 v69, v54, v55
    v_exp_f32 v57, v57
    v_exp_f32 v58, v58
    v_cvt_pk_bf16_f32 v70, v56, v57
    v_exp_f32 v59, v59
    v_mfma_f32_32x32x16_bf16 v[36:51], v[16:19], v[8:11], v[108:123]
    v_exp_f32 v60, v60
    v_cvt_pk_bf16_f32 v71, v58, v59
    v_exp_f32 v61, v61
    v_exp_f32 v62, v62
    v_cvt_pk_bf16_f32 v72, v60, v61
    v_exp_f32 v63, v63
    v_mfma_f32_32x32x16_bf16 v[92:107], v[20:23], v[68:71], v[92:107]
    v_exp_f32 v64, v64
    v_cvt_pk_bf16_f32 v73, v62, v63
    v_exp_f32 v65, v65
    v_exp_f32 v66, v66
    v_cvt_pk_bf16_f32 v74, v64, v65
    v_exp_f32 v67, v67
    v_exp_f32 v36, v36
    v_exp_f32 v37, v37
    v_cvt_pk_bf16_f32 v75, v66, v67
    v_exp_f32 v38, v38
    v_cvt_pk_bf16_f32 v68, v36, v37
    v_exp_f32 v39, v39
    v_mfma_f32_32x32x16_bf16 v[92:107], v[24:27], v[72:75], v[92:107]
    v_exp_f32 v40, v40
    v_cvt_pk_bf16_f32 v69, v38, v39
    v_exp_f32 v41, v41
    v_exp_f32 v42, v42
    v_cvt_pk_bf16_f32 v70, v40, v41
    v_exp_f32 v43, v43
    v_mfma_f32_32x32x16_bf16 v[52:67], v[16:19], v[12:15], v[124:139]
    ds_read_b128 v[16:19], v2 offset:58240
    ds_read_b128 v[20:23], v3 offset:58240
    ds_read_b128 v[24:27], v156 offset:58240
    v_exp_f32 v44, v44
    v_cvt_pk_bf16_f32 v71, v42, v43
    v_exp_f32 v45, v45
    v_exp_f32 v46, v46
    v_cvt_pk_bf16_f32 v72, v44, v45
    v_exp_f32 v47, v47
    v_mfma_f32_32x32x16_bf16 v[76:91], v[28:31], v[68:71], v[76:91]
    v_exp_f32 v48, v48
    v_cvt_pk_bf16_f32 v73, v46, v47
    v_exp_f32 v49, v49
    v_exp_f32 v50, v50
    v_cvt_pk_bf16_f32 v74, v48, v49
    v_exp_f32 v51, v51
    v_exp_f32 v52, v52
    v_exp_f32 v53, v53
    v_cvt_pk_bf16_f32 v75, v50, v51
    v_exp_f32 v54, v54
    v_cvt_pk_bf16_f32 v68, v52, v53
    v_exp_f32 v55, v55
    v_mfma_f32_32x32x16_bf16 v[76:91], v[32:35], v[72:75], v[76:91]
    s_waitcnt lgkmcnt(0)
    v_exp_f32 v56, v56
    v_cvt_pk_bf16_f32 v69, v54, v55
    v_exp_f32 v57, v57
    v_exp_f32 v58, v58
    v_cvt_pk_bf16_f32 v70, v56, v57
    v_exp_f32 v59, v59
    v_mfma_f32_32x32x16_bf16 v[36:51], v[16:19], v[8:11], v[108:123]
    v_exp_f32 v60, v60
    v_cvt_pk_bf16_f32 v71, v58, v59
    v_exp_f32 v61, v61
    v_exp_f32 v62, v62
    v_cvt_pk_bf16_f32 v72, v60, v61
    v_exp_f32 v63, v63
    v_mfma_f32_32x32x16_bf16 v[92:107], v[28:31], v[68:71], v[92:107]
    v_exp_f32 v64, v64
    v_cvt_pk_bf16_f32 v73, v62, v63
    v_exp_f32 v65, v65
    v_exp_f32 v66, v66
    v_cvt_pk_bf16_f32 v74, v64, v65
    v_exp_f32 v67, v67
    v_exp_f32 v36, v36
    v_exp_f32 v37, v37
    v_cvt_pk_bf16_f32 v75, v66, v67
    v_exp_f32 v38, v38
    v_cvt_pk_bf16_f32 v68, v36, v37
    v_exp_f32 v39, v39
    v_mfma_f32_32x32x16_bf16 v[92:107], v[32:35], v[72:75], v[92:107]
    v_exp_f32 v40, v40
    v_cvt_pk_bf16_f32 v69, v38, v39
    v_exp_f32 v41, v41
    v_exp_f32 v42, v42
    v_cvt_pk_bf16_f32 v70, v40, v41
    v_exp_f32 v43, v43
    v_mfma_f32_32x32x16_bf16 v[52:67], v[16:19], v[12:15], v[124:139]
    ds_read_b128 v[16:19], v2 offset:60320
    ds_read_b128 v[28:31], v3 offset:60320
    ds_read_b128 v[32:35], v156 offset:60320
    v_exp_f32 v44, v44
    v_cvt_pk_bf16_f32 v71, v42, v43
    v_exp_f32 v45, v45
    v_exp_f32 v46, v46
    v_cvt_pk_bf16_f32 v72, v44, v45
    v_exp_f32 v47, v47
    v_mfma_f32_32x32x16_bf16 v[76:91], v[20:23], v[68:71], v[76:91]
    v_exp_f32 v48, v48
    v_cvt_pk_bf16_f32 v73, v46, v47
    v_exp_f32 v49, v49
    v_exp_f32 v50, v50
    v_cvt_pk_bf16_f32 v74, v48, v49
    v_exp_f32 v51, v51
    v_exp_f32 v52, v52
    v_exp_f32 v53, v53
    v_cvt_pk_bf16_f32 v75, v50, v51
    v_exp_f32 v54, v54
    v_cvt_pk_bf16_f32 v68, v52, v53
    v_exp_f32 v55, v55
    v_mfma_f32_32x32x16_bf16 v[76:91], v[24:27], v[72:75], v[76:91]
    s_waitcnt lgkmcnt(0)
    v_exp_f32 v56, v56
    v_cvt_pk_bf16_f32 v69, v54, v55
    v_exp_f32 v57, v57
    v_exp_f32 v58, v58
    v_cvt_pk_bf16_f32 v70, v56, v57
    v_exp_f32 v59, v59
    v_mfma_f32_32x32x16_bf16 v[36:51], v[16:19], v[8:11], v[108:123]
    v_exp_f32 v60, v60
    v_cvt_pk_bf16_f32 v71, v58, v59
    v_exp_f32 v61, v61
    v_exp_f32 v62, v62
    v_cvt_pk_bf16_f32 v72, v60, v61
    v_exp_f32 v63, v63
    v_mfma_f32_32x32x16_bf16 v[92:107], v[20:23], v[68:71], v[92:107]
    v_exp_f32 v64, v64
    v_cvt_pk_bf16_f32 v73, v62, v63
    v_exp_f32 v65, v65
    v_exp_f32 v66, v66
    v_cvt_pk_bf16_f32 v74, v64, v65
    v_exp_f32 v67, v67
    v_exp_f32 v36, v36
    v_exp_f32 v37, v37
    v_cvt_pk_bf16_f32 v75, v66, v67
    v_exp_f32 v38, v38
    v_cvt_pk_bf16_f32 v68, v36, v37
    v_exp_f32 v39, v39
    v_mfma_f32_32x32x16_bf16 v[92:107], v[24:27], v[72:75], v[92:107]
    v_exp_f32 v40, v40
    v_cvt_pk_bf16_f32 v69, v38, v39
    v_exp_f32 v41, v41
    v_exp_f32 v42, v42
    v_cvt_pk_bf16_f32 v70, v40, v41
    v_exp_f32 v43, v43
    v_mfma_f32_32x32x16_bf16 v[52:67], v[16:19], v[12:15], v[124:139]
    ds_read_b128 v[16:19], v2 offset:62400
    ds_read_b128 v[20:23], v3 offset:62400
    ds_read_b128 v[24:27], v156 offset:62400
    v_exp_f32 v44, v44
    v_cvt_pk_bf16_f32 v71, v42, v43
    v_exp_f32 v45, v45
    v_exp_f32 v46, v46
    v_cvt_pk_bf16_f32 v72, v44, v45
    v_exp_f32 v47, v47
    v_mfma_f32_32x32x16_bf16 v[76:91], v[28:31], v[68:71], v[76:91]
    v_exp_f32 v48, v48
    v_cvt_pk_bf16_f32 v73, v46, v47
    v_exp_f32 v49, v49
    v_exp_f32 v50, v50
    v_cvt_pk_bf16_f32 v74, v48, v49
    v_exp_f32 v51, v51
    v_exp_f32 v52, v52
    v_exp_f32 v53, v53
    v_cvt_pk_bf16_f32 v75, v50, v51
    v_exp_f32 v54, v54
    v_cvt_pk_bf16_f32 v68, v52, v53
    v_exp_f32 v55, v55
    v_mfma_f32_32x32x16_bf16 v[76:91], v[32:35], v[72:75], v[76:91]
    s_waitcnt lgkmcnt(0)
    v_exp_f32 v56, v56
    v_cvt_pk_bf16_f32 v69, v54, v55
    v_exp_f32 v57, v57
    v_exp_f32 v58, v58
    v_cvt_pk_bf16_f32 v70, v56, v57
    v_exp_f32 v59, v59
    v_mfma_f32_32x32x16_bf16 v[36:51], v[16:19], v[8:11], v[108:123]
    v_exp_f32 v60, v60
    v_cvt_pk_bf16_f32 v71, v58, v59
    v_exp_f32 v61, v61
    v_exp_f32 v62, v62
    v_cvt_pk_bf16_f32 v72, v60, v61
    v_exp_f32 v63, v63
    v_mfma_f32_32x32x16_bf16 v[92:107], v[28:31], v[68:71], v[92:107]
    v_exp_f32 v64, v64
    v_cvt_pk_bf16_f32 v73, v62, v63
    v_exp_f32 v65, v65
    v_exp_f32 v66, v66
    v_cvt_pk_bf16_f32 v74, v64, v65
    v_exp_f32 v67, v67
    v_exp_f32 v36, v36
    v_exp_f32 v37, v37
    v_cvt_pk_bf16_f32 v75, v66, v67
    v_exp_f32 v38, v38
    v_cvt_pk_bf16_f32 v68, v36, v37
    v_exp_f32 v39, v39
    v_mfma_f32_32x32x16_bf16 v[92:107], v[32:35], v[72:75], v[92:107]
    v_exp_f32 v40, v40
    v_cvt_pk_bf16_f32 v69, v38, v39
    v_exp_f32 v41, v41
    v_exp_f32 v42, v42
    v_cvt_pk_bf16_f32 v70, v40, v41
    v_exp_f32 v43, v43
    v_mfma_f32_32x32x16_bf16 v[52:67], v[16:19], v[12:15], v[124:139]
    ds_read_b128 v[16:19], v2 offset:64480
    ds_read_b128 v[28:31], v3 offset:64480
    ds_read_b128 v[32:35], v156 offset:64480
    v_exp_f32 v44, v44
    v_cvt_pk_bf16_f32 v71, v42, v43
    v_exp_f32 v45, v45
    v_exp_f32 v46, v46
    v_cvt_pk_bf16_f32 v72, v44, v45
    v_exp_f32 v47, v47
    v_mfma_f32_32x32x16_bf16 v[76:91], v[20:23], v[68:71], v[76:91]
    s_mov_b32 s53, 28377088
    buffer_load_dwordx4 v[150:153], v155, s[24:27], s53 offen sc1
    v_exp_f32 v48, v48
    v_cvt_pk_bf16_f32 v73, v46, v47
    v_exp_f32 v49, v49
    v_exp_f32 v50, v50
    v_cvt_pk_bf16_f32 v74, v48, v49
    v_exp_f32 v51, v51
    v_exp_f32 v52, v52
    v_exp_f32 v53, v53
    v_cvt_pk_bf16_f32 v75, v50, v51
    v_exp_f32 v54, v54
    v_cvt_pk_bf16_f32 v68, v52, v53
    v_exp_f32 v55, v55
    v_mfma_f32_32x32x16_bf16 v[76:91], v[24:27], v[72:75], v[76:91]
    s_waitcnt lgkmcnt(0)
    v_exp_f32 v56, v56
    v_cvt_pk_bf16_f32 v69, v54, v55
    v_exp_f32 v57, v57
    v_exp_f32 v58, v58
    v_cvt_pk_bf16_f32 v70, v56, v57
    v_exp_f32 v59, v59
    v_mfma_f32_32x32x16_bf16 v[36:51], v[16:19], v[8:11], v[108:123]
    v_exp_f32 v60, v60
    v_cvt_pk_bf16_f32 v71, v58, v59
    v_exp_f32 v61, v61
    v_exp_f32 v62, v62
    v_cvt_pk_bf16_f32 v72, v60, v61
    v_exp_f32 v63, v63
    v_mfma_f32_32x32x16_bf16 v[92:107], v[20:23], v[68:71], v[92:107]
    v_exp_f32 v64, v64
    v_cvt_pk_bf16_f32 v73, v62, v63
    v_exp_f32 v65, v65
    v_exp_f32 v66, v66
    v_cvt_pk_bf16_f32 v74, v64, v65
    v_exp_f32 v67, v67
    v_exp_f32 v36, v36
    v_exp_f32 v37, v37
    v_cvt_pk_bf16_f32 v75, v66, v67
    v_exp_f32 v38, v38
    v_cvt_pk_bf16_f32 v68, v36, v37
    v_exp_f32 v39, v39
    v_mfma_f32_32x32x16_bf16 v[92:107], v[24:27], v[72:75], v[92:107]
    s_waitcnt vmcnt(1)
    v_exp_f32 v40, v40
    v_cvt_pk_bf16_f32 v69, v38, v39
    v_exp_f32 v41, v41
    v_exp_f32 v42, v42
    v_cvt_pk_bf16_f32 v70, v40, v41
    v_exp_f32 v43, v43
    v_mfma_f32_32x32x16_bf16 v[52:67], v[16:19], v[12:15], v[124:139]
    ds_read_b128 v[16:19], v4 offset:1024
    ds_read_b128 v[20:23], v5 offset:1024
    ds_read_b128 v[24:27], v157 offset:1024
    v_exp_f32 v44, v44
    v_cvt_pk_bf16_f32 v71, v42, v43
    v_exp_f32 v45, v45
    v_exp_f32 v46, v46
    v_cvt_pk_bf16_f32 v72, v44, v45
    v_exp_f32 v47, v47
    v_mfma_f32_32x32x16_bf16 v[76:91], v[28:31], v[68:71], v[76:91]
    v_exp_f32 v48, v48
    v_cvt_pk_bf16_f32 v73, v46, v47
    v_exp_f32 v49, v49
    v_exp_f32 v50, v50
    v_cvt_pk_bf16_f32 v74, v48, v49
    v_exp_f32 v51, v51
    v_exp_f32 v52, v52
    v_exp_f32 v53, v53
    v_cvt_pk_bf16_f32 v75, v50, v51
    v_exp_f32 v54, v54
    v_lshlrev_b32 v216, 16, v184
    v_cvt_pk_bf16_f32 v68, v52, v53
    v_exp_f32 v55, v55
    v_and_b32 v217, 0xffff0000, v184
    v_mfma_f32_32x32x16_bf16 v[76:91], v[32:35], v[72:75], v[76:91]
    s_waitcnt lgkmcnt(0)
    v_exp_f32 v56, v56
    v_pk_mul_f32 v[208:209], v[216:217], v[202:203] op_sel_hi:[1,0]
    v_cvt_pk_bf16_f32 v69, v54, v55
    v_exp_f32 v57, v57
    v_exp_f32 v58, v58
    v_lshlrev_b32 v218, 16, v185
    v_cvt_pk_bf16_f32 v70, v56, v57
    v_exp_f32 v59, v59
    v_and_b32 v219, 0xffff0000, v185
    v_mfma_f32_32x32x16_bf16 v[36:51], v[16:19], v[8:11], v[108:123]
    v_exp_f32 v60, v60
    v_cvt_pk_bf16_f32 v71, v58, v59
    v_exp_f32 v61, v61
    v_exp_f32 v62, v62
    v_pk_mul_f32 v[210:211], v[218:219], v[202:203] op_sel_hi:[1,0]
    v_cvt_pk_bf16_f32 v72, v60, v61
    v_exp_f32 v63, v63
    v_lshlrev_b32 v216, 16, v186
    v_mfma_f32_32x32x16_bf16 v[92:107], v[28:31], v[68:71], v[92:107]
    v_exp_f32 v64, v64
    v_cvt_pk_bf16_f32 v73, v62, v63
    v_exp_f32 v65, v65
    v_exp_f32 v66, v66
    v_and_b32 v217, 0xffff0000, v186
    v_cvt_pk_bf16_f32 v74, v64, v65
    v_exp_f32 v67, v67
    v_exp_f32 v36, v36
    v_exp_f32 v37, v37
    v_cvt_pk_bf16_f32 v75, v66, v67
    v_exp_f32 v38, v38
    v_pk_mul_f32 v[212:213], v[216:217], v[202:203] op_sel_hi:[1,0]
    v_cvt_pk_bf16_f32 v68, v36, v37
    v_exp_f32 v39, v39
    v_lshlrev_b32 v218, 16, v187
    v_mfma_f32_32x32x16_bf16 v[92:107], v[32:35], v[72:75], v[92:107]
    v_exp_f32 v40, v40
    v_and_b32 v219, 0xffff0000, v187
    v_cvt_pk_bf16_f32 v69, v38, v39
    v_exp_f32 v41, v41
    v_exp_f32 v42, v42
    v_pk_mul_f32 v[214:215], v[218:219], v[202:203] op_sel_hi:[1,0]
    v_cvt_pk_bf16_f32 v70, v40, v41
    v_exp_f32 v43, v43
    v_lshlrev_b32 v216, 16, v188
    v_mfma_f32_32x32x16_bf16 v[52:67], v[16:19], v[12:15], v[124:139]
    ds_read_b128 v[16:19], v4 offset:3104
    ds_read_b128 v[28:31], v5 offset:3104
    ds_read_b128 v[32:35], v157 offset:3104
    v_exp_f32 v44, v44
    v_cvt_pk_bf16_f32 v71, v42, v43
    v_exp_f32 v45, v45
    v_exp_f32 v46, v46
    v_and_b32 v217, 0xffff0000, v188
    v_cvt_pk_bf16_f32 v72, v44, v45
    v_exp_f32 v47, v47
    v_pk_fma_f32 v[208:209], v[216:217], v[202:203], v[208:209] op_sel:[0,1,0] op_sel_hi:[1,1,1]
    v_mfma_f32_32x32x16_bf16 v[76:91], v[20:23], v[68:71], v[76:91]
    v_exp_f32 v48, v48
    v_cvt_pk_bf16_f32 v73, v46, v47
    v_exp_f32 v49, v49
    v_exp_f32 v50, v50
    v_lshlrev_b32 v218, 16, v189
    v_cvt_pk_bf16_f32 v74, v48, v49
    v_exp_f32 v51, v51
    v_exp_f32 v52, v52
    v_exp_f32 v53, v53
    v_cvt_pk_bf16_f32 v75, v50, v51
    v_exp_f32 v54, v54
    v_and_b32 v219, 0xffff0000, v189
    v_cvt_pk_bf16_f32 v68, v52, v53
    v_exp_f32 v55, v55
    v_pk_fma_f32 v[210:211], v[218:219], v[202:203], v[210:211] op_sel:[0,1,0] op_sel_hi:[1,1,1]
    v_mfma_f32_32x32x16_bf16 v[76:91], v[24:27], v[72:75], v[76:91]
    s_waitcnt lgkmcnt(0)
    v_exp_f32 v56, v56
    v_lshlrev_b32 v216, 16, v190
    v_cvt_pk_bf16_f32 v69, v54, v55
    v_exp_f32 v57, v57
    v_exp_f32 v58, v58
    v_and_b32 v217, 0xffff0000, v190
    v_cvt_pk_bf16_f32 v70, v56, v57
    v_exp_f32 v59, v59
    v_pk_fma_f32 v[212:213], v[216:217], v[202:203], v[212:213] op_sel:[0,1,0] op_sel_hi:[1,1,1]
    v_mfma_f32_32x32x16_bf16 v[36:51], v[16:19], v[8:11], v[108:123]
    v_exp_f32 v60, v60
    v_cvt_pk_bf16_f32 v71, v58, v59
    v_exp_f32 v61, v61
    v_exp_f32 v62, v62
    v_lshlrev_b32 v218, 16, v191
    v_cvt_pk_bf16_f32 v72, v60, v61
    v_exp_f32 v63, v63
    v_and_b32 v219, 0xffff0000, v191
    v_mfma_f32_32x32x16_bf16 v[92:107], v[20:23], v[68:71], v[92:107]
    v_exp_f32 v64, v64
    v_cvt_pk_bf16_f32 v73, v62, v63
    v_exp_f32 v65, v65
    v_exp_f32 v66, v66
    v_pk_fma_f32 v[214:215], v[218:219], v[202:203], v[214:215] op_sel:[0,1,0] op_sel_hi:[1,1,1]
    v_cvt_pk_bf16_f32 v74, v64, v65
    v_exp_f32 v67, v67
    v_exp_f32 v36, v36
    v_exp_f32 v37, v37
    v_cvt_pk_bf16_f32 v75, v66, v67
    v_exp_f32 v38, v38
    v_lshlrev_b32 v216, 16, v192
    v_cvt_pk_bf16_f32 v68, v36, v37
    v_exp_f32 v39, v39
    v_and_b32 v217, 0xffff0000, v192
    v_mfma_f32_32x32x16_bf16 v[92:107], v[24:27], v[72:75], v[92:107]
    v_exp_f32 v40, v40
    v_pk_fma_f32 v[208:209], v[216:217], v[204:205], v[208:209] op_sel_hi:[1,0,1]
    v_cvt_pk_bf16_f32 v69, v38, v39
    v_exp_f32 v41, v41
    v_exp_f32 v42, v42
    v_lshlrev_b32 v218, 16, v193
    v_cvt_pk_bf16_f32 v70, v40, v41
    v_exp_f32 v43, v43
    v_and_b32 v219, 0xffff0000, v193
    v_mfma_f32_32x32x16_bf16 v[52:67], v[16:19], v[12:15], v[124:139]
    ds_read_b128 v[16:19], v4 offset:5184
    ds_read_b128 v[20:23], v5 offset:5184
    ds_read_b128 v[24:27], v157 offset:5184
    v_exp_f32 v44, v44
    v_cvt_pk_bf16_f32 v71, v42, v43
    v_exp_f32 v45, v45
    s_waitcnt vmcnt(0)
    v_xor_b32 v150, s98, v150
    v_xor_b32 v151, s98, v151
    v_xor_b32 v152, s98, v152
    v_xor_b32 v153, s98, v153
    v_or3_b32 v154, v150, v151, v152
    v_or_b32 v154, v154, v153
    v_cmp_lt_u32 vcc, 0, v154
    v_exp_f32 v46, v46
    v_pk_fma_f32 v[210:211], v[218:219], v[204:205], v[210:211] op_sel_hi:[1,0,1]
    v_cvt_pk_bf16_f32 v72, v44, v45
    v_exp_f32 v47, v47
    v_lshlrev_b32 v216, 16, v194
    v_mfma_f32_32x32x16_bf16 v[76:91], v[28:31], v[68:71], v[76:91]
    v_exp_f32 v48, v48
    v_cvt_pk_bf16_f32 v73, v46, v47
    v_exp_f32 v49, v49
    s_cbranch_vccnz L_xid_retry
L_xid_ok:
    v_exp_f32 v50, v50
    v_and_b32 v217, 0xffff0000, v194
    v_cvt_pk_bf16_f32 v74, v48, v49
    v_exp_f32 v51, v51
    v_exp_f32 v52, v52
    v_exp_f32 v53, v53
    v_cvt_pk_bf16_f32 v75, v50, v51
    v_exp_f32 v54, v54
    v_pk_fma_f32 v[212:213], v[216:217], v[204:205], v[212:213] op_sel_hi:[1,0,1]
    v_cvt_pk_bf16_f32 v68, v52, v53
    v_exp_f32 v55, v55
    v_lshlrev_b32 v218, 16, v195
    v_mfma_f32_32x32x16_bf16 v[76:91], v[32:35], v[72:75], v[76:91]
    s_waitcnt lgkmcnt(0)
    v_exp_f32 v56, v56
    v_and_b32 v219, 0xffff0000, v195
    v_cvt_pk_bf16_f32 v69, v54, v55
    v_exp_f32 v57, v57
    v_exp_f32 v58, v58
    v_pk_fma_f32 v[214:215], v[218:219], v[204:205], v[214:215] op_sel_hi:[1,0,1]
    v_cvt_pk_bf16_f32 v70, v56, v57
    v_exp_f32 v59, v59
    v_lshlrev_b32 v216, 16, v196
    v_mfma_f32_32x32x16_bf16 v[36:51], v[16:19], v[8:11], v[108:123]
    s_add_u32 m0, s22, 133120
    s_add_u32 s44, s58, s22
    buffer_load_dwordx4 v2, s[24:27], s44 offen offset:0 sc1 lds
    v_exp_f32 v60, v60
    v_cvt_pk_bf16_f32 v71, v58, v59
    v_exp_f32 v61, v61
    v_exp_f32 v62, v62
    v_and_b32 v217, 0xffff0000, v196
    v_cvt_pk_bf16_f32 v72, v60, v61
    v_exp_f32 v63, v63
    v_pk_fma_f32 v[208:209], v[216:217], v[204:205], v[208:209] op_sel:[0,1,0] op_sel_hi:[1,1,1]
    v_mfma_f32_32x32x16_bf16 v[92:107], v[28:31], v[68:71], v[92:107]
    v_exp_f32 v64, v64
    v_cvt_pk_bf16_f32 v73, v62, v63
    v_exp_f32 v65, v65
    v_exp_f32 v66, v66
    v_lshlrev_b32 v218, 16, v197
    v_cvt_pk_bf16_f32 v74, v64, v65
    v_exp_f32 v67, v67
    v_exp_f32 v36, v36
    v_exp_f32 v37, v37
    v_cvt_pk_bf16_f32 v75, v66, v67
    v_exp_f32 v38, v38
    v_and_b32 v219, 0xffff0000, v197
    v_cvt_pk_bf16_f32 v68, v36, v37
    v_exp_f32 v39, v39
    v_pk_fma_f32 v[210:211], v[218:219], v[204:205], v[210:211] op_sel:[0,1,0] op_sel_hi:[1,1,1]
    v_mfma_f32_32x32x16_bf16 v[92:107], v[32:35], v[72:75], v[92:107]
    buffer_load_dwordx4 v2, s[24:27], s44 offen offset:1024 sc1 lds
    v_exp_f32 v40, v40
    v_lshlrev_b32 v216, 16, v198
    v_cvt_pk_bf16_f32 v69, v38, v39
    v_exp_f32 v41, v41
    v_exp_f32 v42, v42
    v_and_b32 v217, 0xffff0000, v198
    v_cvt_pk_bf16_f32 v70, v40, v41
    v_exp_f32 v43, v43
    v_pk_fma_f32 v[212:213], v[216:217], v[204:205], v[212:213] op_sel:[0,1,0] op_sel_hi:[1,1,1]
    v_mfma_f32_32x32x16_bf16 v[52:67], v[16:19], v[12:15], v[124:139]
    ds_read_b128 v[16:19], v4 offset:7264
    ds_read_b128 v[28:31], v5 offset:7264
    ds_read_b128 v[32:35], v157 offset:7264
    v_exp_f32 v44, v44
    v_cvt_pk_bf16_f32 v71, v42, v43
    v_exp_f32 v45, v45
    v_exp_f32 v46, v46
    v_lshlrev_b32 v218, 16, v199
    v_cvt_pk_bf16_f32 v72, v44, v45
    v_exp_f32 v47, v47
    v_and_b32 v219, 0xffff0000, v199
    v_mfma_f32_32x32x16_bf16 v[76:91], v[20:23], v[68:71], v[76:91]
    v_exp_f32 v48, v48
    v_cvt_pk_bf16_f32 v73, v46, v47
    v_exp_f32 v49, v49
    v_exp_f32 v50, v50
    v_pk_fma_f32 v[214:215], v[218:219], v[204:205], v[214:215] op_sel:[0,1,0] op_sel_hi:[1,1,1]
    v_cvt_pk_bf16_f32 v74, v48, v49
    v_exp_f32 v51, v51
    v_exp_f32 v52, v52
    v_exp_f32 v53, v53
    v_cvt_pk_bf16_f32 v75, v50, v51
    v_exp_f32 v54, v54
    v_permlane32_swap_b32 v208, v212
    v_cvt_pk_bf16_f32 v68, v52, v53
    v_exp_f32 v55, v55
    v_permlane32_swap_b32 v209, v213
    v_mfma_f32_32x32x16_bf16 v[76:91], v[24:27], v[72:75], v[76:91]
    s_waitcnt lgkmcnt(0)
    v_exp_f32 v56, v56
    v_permlane32_swap_b32 v210, v214
    v_cvt_pk_bf16_f32 v69, v54, v55
    v_exp_f32 v57, v57
    v_exp_f32 v58, v58
    v_permlane32_swap_b32 v211, v215
    v_cvt_pk_bf16_f32 v70, v56, v57
    v_exp_f32 v59, v59
    v_pk_add_f32 v[208:209], v[208:209], v[212:213]
    v_mfma_f32_32x32x16_bf16 v[36:51], v[16:19], v[8:11], v[108:123]
    buffer_load_dwordx4 v2, s[24:27], s44 offen offset:2048 sc1 lds
    v_exp_f32 v60, v60
    v_cvt_pk_bf16_f32 v71, v58, v59
    v_exp_f32 v61, v61
    v_exp_f32 v62, v62
    v_pk_add_f32 v[210:211], v[210:211], v[214:215]
    v_cvt_pk_bf16_f32 v72, v60, v61
    v_exp_f32 v63, v63
    v_lshrrev_b32 v200, 4, v1
    v_mfma_f32_32x32x16_bf16 v[92:107], v[20:23], v[68:71], v[92:107]
    v_exp_f32 v64, v64
    v_cvt_pk_bf16_f32 v73, v62, v63
    v_exp_f32 v65, v65
    v_exp_f32 v66, v66
    v_and_b32 v201, 1, v1
    v_cvt_pk_bf16_f32 v74, v64, v65
    v_exp_f32 v67, v67
    v_exp_f32 v36, v36
    v_exp_f32 v37, v37
    v_cvt_pk_bf16_f32 v75, v66, v67
    v_exp_f32 v38, v38
    v_permlane16_swap_b32 v208, v210
    v_cvt_pk_bf16_f32 v68, v36, v37
    v_exp_f32 v39, v39
    v_permlane16_swap_b32 v209, v211
    v_mfma_f32_32x32x16_bf16 v[92:107], v[24:27], v[72:75], v[92:107]
    buffer_load_dwordx4 v2, s[24:27], s44 offen offset:3072 sc1 lds
    v_exp_f32 v40, v40
    v_pk_add_f32 v[208:209], v[208:209], v[210:211]
    v_cvt_pk_bf16_f32 v69, v38, v39
    v_exp_f32 v41, v41
    v_exp_f32 v42, v42
    v_lshlrev_b32 v200, 3, v200
    v_cvt_pk_bf16_f32 v70, v40, v41
    v_exp_f32 v43, v43
    v_lshl_add_u32 v200, v201, 5, v200
    v_mfma_f32_32x32x16_bf16 v[52:67], v[16:19], v[12:15], v[124:139]
    ds_read_b128 v[16:19], v4 offset:9344
    ds_read_b128 v[20:23], v5 offset:9344
    ds_read_b128 v[24:27], v157 offset:9344
    v_exp_f32 v44, v44
    v_cvt_pk_bf16_f32 v71, v42, v43
    v_exp_f32 v45, v45
    v_exp_f32 v46, v46
    v_add_f32_dpp v208, v208, v208 row_ror:8 row_mask:0xf bank_mask:0xf
    v_cvt_pk_bf16_f32 v72, v44, v45
    v_exp_f32 v47, v47
    v_add_f32_dpp v209, v209, v209 row_ror:8 row_mask:0xf bank_mask:0xf
    v_mfma_f32_32x32x16_bf16 v[76:91], v[28:31], v[68:71], v[76:91]
    s_add_u32 m0, s22, 137216
    s_add_u32 s44, s58, s22
    s_add_u32 s44, s44, 4096
    buffer_load_dwordx4 v2, s[24:27], s44 offen offset:0 sc1 lds
    v_exp_f32 v48, v48
    v_cvt_pk_bf16_f32 v73, v46, v47
    v_exp_f32 v49, v49
    v_exp_f32 v50, v50
    s_lshl_b32 s38, s3, 6
    v_cvt_pk_bf16_f32 v74, v48, v49
    v_exp_f32 v51, v51
    v_exp_f32 v52, v52
    v_exp_f32 v53, v53
    v_cvt_pk_bf16_f32 v75, v50, v51
    v_exp_f32 v54, v54
    v_add_f32_dpp v208, v208, v208 row_ror:4 row_mask:0xf bank_mask:0xf
    v_cvt_pk_bf16_f32 v68, v52, v53
    v_exp_f32 v55, v55
    v_add_f32_dpp v209, v209, v209 row_ror:4 row_mask:0xf bank_mask:0xf
    v_mfma_f32_32x32x16_bf16 v[76:91], v[32:35], v[72:75], v[76:91]
    s_waitcnt lgkmcnt(0)
    v_exp_f32 v56, v56
    v_add_u32 v200, s38, v200
    v_cvt_pk_bf16_f32 v69, v54, v55
    v_exp_f32 v57, v57
    v_exp_f32 v58, v58
    v_add_f32_dpp v208, v208, v208 row_ror:2 row_mask:0xf bank_mask:0xf
    v_cvt_pk_bf16_f32 v70, v56, v57
    v_exp_f32 v59, v59
    v_add_f32_dpp v209, v209, v209 row_ror:2 row_mask:0xf bank_mask:0xf
    v_mfma_f32_32x32x16_bf16 v[36:51], v[16:19], v[8:11], v[108:123]
    buffer_load_dwordx4 v2, s[24:27], s44 offen offset:1024 sc1 lds
    v_exp_f32 v60, v60
    v_cvt_pk_bf16_f32 v71, v58, v59
    v_exp_f32 v61, v61
    v_exp_f32 v62, v62
    v_add_u32 v200, 162816, v200
    v_cvt_pk_bf16_f32 v72, v60, v61
    v_exp_f32 v63, v63
    ds_write_b64 v200, v[208:209] offset:0
    v_mfma_f32_32x32x16_bf16 v[92:107], v[28:31], v[68:71], v[92:107]
    buffer_load_dwordx4 v2, s[24:27], s44 offen offset:2048 sc1 lds
    v_exp_f32 v64, v64
    v_cvt_pk_bf16_f32 v73, v62, v63
    v_exp_f32 v65, v65
    v_exp_f32 v66, v66
    v_cvt_pk_bf16_f32 v74, v64, v65
    v_exp_f32 v67, v67
    v_exp_f32 v36, v36
    v_exp_f32 v37, v37
    v_cvt_pk_bf16_f32 v75, v66, v67
    v_exp_f32 v38, v38
    v_cvt_pk_bf16_f32 v68, v36, v37
    v_exp_f32 v39, v39
    v_mfma_f32_32x32x16_bf16 v[92:107], v[32:35], v[72:75], v[92:107]
    buffer_load_dwordx4 a[0:3], v2, s[24:27], s55 offen offset:0 sc1
    v_exp_f32 v40, v40
    v_cvt_pk_bf16_f32 v69, v38, v39
    v_exp_f32 v41, v41
    v_exp_f32 v42, v42
    v_cvt_pk_bf16_f32 v70, v40, v41
    v_exp_f32 v43, v43
    v_mfma_f32_32x32x16_bf16 v[52:67], v[16:19], v[12:15], v[124:139]
    ds_read_b128 v[16:19], v4 offset:11424
    ds_read_b128 v[28:31], v5 offset:11424
    ds_read_b128 v[32:35], v157 offset:11424
    v_exp_f32 v44, v44
    v_cvt_pk_bf16_f32 v71, v42, v43
    v_exp_f32 v45, v45
    v_exp_f32 v46, v46
    v_cvt_pk_bf16_f32 v72, v44, v45
    v_exp_f32 v47, v47
    v_mfma_f32_32x32x16_bf16 v[76:91], v[20:23], v[68:71], v[76:91]
    buffer_load_dwordx4 a[4:7], v2, s[24:27], s56 offen offset:0 sc1
    v_exp_f32 v48, v48
    v_cvt_pk_bf16_f32 v73, v46, v47
    v_exp_f32 v49, v49
    v_exp_f32 v50, v50
    v_cvt_pk_bf16_f32 v74, v48, v49
    v_exp_f32 v51, v51
    v_exp_f32 v52, v52
    v_exp_f32 v53, v53
    v_cvt_pk_bf16_f32 v75, v50, v51
    v_exp_f32 v54, v54
    v_cvt_pk_bf16_f32 v68, v52, v53
    v_exp_f32 v55, v55
    v_mfma_f32_32x32x16_bf16 v[76:91], v[24:27], v[72:75], v[76:91]
    s_waitcnt lgkmcnt(0)
    v_exp_f32 v56, v56
    v_cvt_pk_bf16_f32 v69, v54, v55
    v_exp_f32 v57, v57
    v_exp_f32 v58, v58
    v_cvt_pk_bf16_f32 v70, v56, v57
    v_exp_f32 v59, v59
    v_mfma_f32_32x32x16_bf16 v[36:51], v[16:19], v[8:11], v[108:123]
    buffer_load_dwordx4 a[8:11], v2, s[24:27], s55 offen offset:1024 sc1
    v_exp_f32 v60, v60
    v_cvt_pk_bf16_f32 v71, v58, v59
    v_exp_f32 v61, v61
    v_exp_f32 v62, v62
    v_cvt_pk_bf16_f32 v72, v60, v61
    v_exp_f32 v63, v63
    v_mfma_f32_32x32x16_bf16 v[92:107], v[20:23], v[68:71], v[92:107]
    buffer_load_dwordx4 a[12:15], v2, s[24:27], s56 offen offset:1024 sc1
    v_exp_f32 v64, v64
    v_cvt_pk_bf16_f32 v73, v62, v63
    v_exp_f32 v65, v65
    v_exp_f32 v66, v66
    v_cvt_pk_bf16_f32 v74, v64, v65
    v_exp_f32 v67, v67
    v_exp_f32 v36, v36
    v_exp_f32 v37, v37
    v_cvt_pk_bf16_f32 v75, v66, v67
    v_exp_f32 v38, v38
    v_cvt_pk_bf16_f32 v68, v36, v37
    v_exp_f32 v39, v39
    v_mfma_f32_32x32x16_bf16 v[92:107], v[24:27], v[72:75], v[92:107]
    buffer_load_dwordx4 a[16:19], v2, s[24:27], s55 offen offset:2048 sc1
    v_exp_f32 v40, v40
    v_cvt_pk_bf16_f32 v69, v38, v39
    v_exp_f32 v41, v41
    v_exp_f32 v42, v42
    v_cvt_pk_bf16_f32 v70, v40, v41
    v_exp_f32 v43, v43
    v_mfma_f32_32x32x16_bf16 v[52:67], v[16:19], v[12:15], v[124:139]
    s_barrier
    s_cmp_lg_u32 s3, 1
    s_cbranch_scc1 L_m2_done
    s_cmp_ge_u32 s37, 16
    s_cbranch_scc1 L_m2_done
    v_lshlrev_b32 v216, 2, v1
    v_add_u32 v217, 162816, v216
    ds_read_b32 v208, v217
    s_lshr_b32 s38, s99, 5
    s_cmp_eq_u32 s38, 4
    s_cselect_b32 s39, 1.0, 0
    s_waitcnt lgkmcnt(0)
    v_mov_b32 v209, v208
    s_nop 1
    v_permlane32_swap_b32 v209, v208
    v_add_f32 v208, v209, v208
    v_mov_b32 v209, v208
    s_nop 1
    v_permlane16_swap_b32 v209, v208
    v_add_f32 v208, v209, v208
    v_cvt_pk_bf16_f32 v208, v208, v208
    v_and_b32 v208, 0xffff0000, v208
    v_add_f32 v208, s39, v208
    v_cvt_pk_bf16_f32 v208, v208, v208
    v_and_b32 v208, 0xffff0000, v208
    s_lshl_b32 s39, s99, 6
    s_mov_b64 exec, 0xffff
    buffer_store_dword v208, v216, s[24:27], s39 offen offset:0 sc1
    s_sub_u32 s38, 4, s38
    s_cmp_gt_u32 s38, 1
    s_cbranch_scc1 L_m2_done
    s_lshl_b32 s38, s38, 10
    s_and_b32 s39, s99, 31
    s_lshl_b32 s39, s39, 5
    s_add_u32 s38, s38, s39
    s_add_u32 s38, s38, 12288
    v_bfe_u32 v217, v1, 2, 1
    v_lshlrev_b32 v216, 4, v217
    v_bfe_u32 v217, v1, 3, 1
    v_lshl_add_u32 v216, v217, 3, v216
    v_and_b32 v217, 3, v1
    v_lshl_add_u32 v216, v217, 1, v216
    buffer_store_short_d16_hi v208, v216, s[24:27], s38 offen sc1
L_m2_done:
    s_mov_b64 exec, -1
    ds_read_b128 v[16:19], v4 offset:13504
    ds_read_b128 v[20:23], v5 offset:13504
    ds_read_b128 v[24:27], v157 offset:13504
    v_exp_f32 v44, v44
    v_cvt_pk_bf16_f32 v71, v42, v43
    v_exp_f32 v45, v45
    v_exp_f32 v46, v46
    v_cvt_pk_bf16_f32 v72, v44, v45
    v_exp_f32 v47, v47
    v_mfma_f32_32x32x16_bf16 v[76:91], v[28:31], v[68:71], v[76:91]
    buffer_load_dwordx4 a[20:23], v2, s[24:27], s56 offen offset:2048 sc1
    v_exp_f32 v48, v48
    v_cvt_pk_bf16_f32 v73, v46, v47
    v_exp_f32 v49, v49
    v_exp_f32 v50, v50
    v_cvt_pk_bf16_f32 v74, v48, v49
    v_exp_f32 v51, v51
    v_exp_f32 v52, v52
    v_exp_f32 v53, v53
    v_cvt_pk_bf16_f32 v75, v50, v51
    v_exp_f32 v54, v54
    v_cvt_pk_bf16_f32 v68, v52, v53
    v_exp_f32 v55, v55
    v_mfma_f32_32x32x16_bf16 v[76:91], v[32:35], v[72:75], v[76:91]
    s_waitcnt lgkmcnt(0)
    v_exp_f32 v56, v56
    v_cvt_pk_bf16_f32 v69, v54, v55
    v_exp_f32 v57, v57
    v_exp_f32 v58, v58
    v_cvt_pk_bf16_f32 v70, v56, v57
    v_exp_f32 v59, v59
    v_mfma_f32_32x32x16_bf16 v[36:51], v[16:19], v[8:11], v[108:123]
    buffer_load_dwordx4 a[24:27], v2, s[24:27], s55 offen offset:3072 sc1
    v_exp_f32 v60, v60
    v_cvt_pk_bf16_f32 v71, v58, v59
    v_exp_f32 v61, v61
    v_exp_f32 v62, v62
    v_cvt_pk_bf16_f32 v72, v60, v61
    v_exp_f32 v63, v63
    v_mfma_f32_32x32x16_bf16 v[92:107], v[28:31], v[68:71], v[92:107]
    buffer_load_dwordx4 a[28:31], v2, s[24:27], s56 offen offset:3072 sc1
    v_exp_f32 v64, v64
    v_cvt_pk_bf16_f32 v73, v62, v63
    v_exp_f32 v65, v65
    v_exp_f32 v66, v66
    v_cvt_pk_bf16_f32 v74, v64, v65
    v_exp_f32 v67, v67
    v_exp_f32 v36, v36
    v_exp_f32 v37, v37
    v_cvt_pk_bf16_f32 v75, v66, v67
    v_exp_f32 v38, v38
    v_cvt_pk_bf16_f32 v68, v36, v37
    v_exp_f32 v39, v39
    v_mfma_f32_32x32x16_bf16 v[92:107], v[32:35], v[72:75], v[92:107]
    s_add_u32 s55, s55, 4096
    buffer_load_dwordx4 a[32:35], v2, s[24:27], s55 offen offset:0 sc1
    v_exp_f32 v40, v40
    v_cvt_pk_bf16_f32 v69, v38, v39
    v_exp_f32 v41, v41
    v_exp_f32 v42, v42
    v_cvt_pk_bf16_f32 v70, v40, v41
    v_exp_f32 v43, v43
    v_mfma_f32_32x32x16_bf16 v[52:67], v[16:19], v[12:15], v[124:139]
    ds_read_b128 v[16:19], v4 offset:15584
    ds_read_b128 v[28:31], v5 offset:15584
    ds_read_b128 v[32:35], v157 offset:15584
    v_exp_f32 v44, v44
    v_cvt_pk_bf16_f32 v71, v42, v43
    v_exp_f32 v45, v45
    v_exp_f32 v46, v46
    v_cvt_pk_bf16_f32 v72, v44, v45
    v_exp_f32 v47, v47
    v_mfma_f32_32x32x16_bf16 v[76:91], v[20:23], v[68:71], v[76:91]
    s_add_u32 s56, s56, 4096
    buffer_load_dwordx4 a[36:39], v2, s[24:27], s56 offen offset:0 sc1
    v_exp_f32 v48, v48
    v_cvt_pk_bf16_f32 v73, v46, v47
    v_exp_f32 v49, v49
    v_exp_f32 v50, v50
    v_cvt_pk_bf16_f32 v74, v48, v49
    v_exp_f32 v51, v51
    v_exp_f32 v52, v52
    v_exp_f32 v53, v53
    v_cvt_pk_bf16_f32 v75, v50, v51
    v_exp_f32 v54, v54
    v_cvt_pk_bf16_f32 v68, v52, v53
    v_exp_f32 v55, v55
    v_mfma_f32_32x32x16_bf16 v[76:91], v[24:27], v[72:75], v[76:91]
    s_waitcnt lgkmcnt(0)
    v_exp_f32 v56, v56
    v_cvt_pk_bf16_f32 v69, v54, v55
    v_exp_f32 v57, v57
    v_exp_f32 v58, v58
    v_cvt_pk_bf16_f32 v70, v56, v57
    v_exp_f32 v59, v59
    v_mfma_f32_32x32x16_bf16 v[36:51], v[16:19], v[8:11], v[108:123]
    buffer_load_dwordx4 a[40:43], v2, s[24:27], s55 offen offset:1024 sc1
    v_exp_f32 v60, v60
    v_cvt_pk_bf16_f32 v71, v58, v59
    v_exp_f32 v61, v61
    v_exp_f32 v62, v62
    v_cvt_pk_bf16_f32 v72, v60, v61
    v_exp_f32 v63, v63
    v_mfma_f32_32x32x16_bf16 v[92:107], v[20:23], v[68:71], v[92:107]
    buffer_load_dwordx4 a[44:47], v2, s[24:27], s56 offen offset:1024 sc1
    v_exp_f32 v64, v64
    v_cvt_pk_bf16_f32 v73, v62, v63
    v_exp_f32 v65, v65
    v_exp_f32 v66, v66
    v_cvt_pk_bf16_f32 v74, v64, v65
    v_exp_f32 v67, v67
    v_exp_f32 v36, v36
    v_exp_f32 v37, v37
    v_cvt_pk_bf16_f32 v75, v66, v67
    v_exp_f32 v38, v38
    v_cvt_pk_bf16_f32 v68, v36, v37
    v_exp_f32 v39, v39
    v_mfma_f32_32x32x16_bf16 v[92:107], v[24:27], v[72:75], v[92:107]
    buffer_load_dwordx4 a[48:51], v2, s[24:27], s55 offen offset:2048 sc1
    v_exp_f32 v40, v40
    v_cvt_pk_bf16_f32 v69, v38, v39
    v_exp_f32 v41, v41
    v_exp_f32 v42, v42
    v_cvt_pk_bf16_f32 v70, v40, v41
    v_exp_f32 v43, v43
    v_mfma_f32_32x32x16_bf16 v[52:67], v[16:19], v[12:15], v[124:139]
    ds_read_b128 v[16:19], v4 offset:17664
    ds_read_b128 v[20:23], v5 offset:17664
    ds_read_b128 v[24:27], v157 offset:17664
    v_exp_f32 v44, v44
    v_cvt_pk_bf16_f32 v71, v42, v43
    v_exp_f32 v45, v45
    v_exp_f32 v46, v46
    v_cvt_pk_bf16_f32 v72, v44, v45
    v_exp_f32 v47, v47
    v_mfma_f32_32x32x16_bf16 v[76:91], v[28:31], v[68:71], v[76:91]
    buffer_load_dwordx4 a[52:55], v2, s[24:27], s56 offen offset:2048 sc1
    v_exp_f32 v48, v48
    v_cvt_pk_bf16_f32 v73, v46, v47
    v_exp_f32 v49, v49
    v_exp_f32 v50, v50
    v_cvt_pk_bf16_f32 v74, v48, v49
    v_exp_f32 v51, v51
    v_exp_f32 v52, v52
    v_exp_f32 v53, v53
    v_cvt_pk_bf16_f32 v75, v50, v51
    v_exp_f32 v54, v54
    v_cvt_pk_bf16_f32 v68, v52, v53
    v_exp_f32 v55, v55
    v_mfma_f32_32x32x16_bf16 v[76:91], v[32:35], v[72:75], v[76:91]
    s_waitcnt lgkmcnt(0)
    v_exp_f32 v56, v56
    v_cvt_pk_bf16_f32 v69, v54, v55
    v_exp_f32 v57, v57
    v_exp_f32 v58, v58
    v_cvt_pk_bf16_f32 v70, v56, v57
    v_exp_f32 v59, v59
    v_mfma_f32_32x32x16_bf16 v[36:51], v[16:19], v[8:11], v[108:123]
    buffer_load_dwordx4 a[56:59], v2, s[24:27], s55 offen offset:3072 sc1
    v_exp_f32 v60, v60
    v_cvt_pk_bf16_f32 v71, v58, v59
    v_exp_f32 v61, v61
    v_exp_f32 v62, v62
    v_cvt_pk_bf16_f32 v72, v60, v61
    v_exp_f32 v63, v63
    v_mfma_f32_32x32x16_bf16 v[92:107], v[28:31], v[68:71], v[92:107]
    buffer_load_dwordx4 a[60:63], v2, s[24:27], s56 offen offset:3072 sc1
    v_exp_f32 v64, v64
    v_cvt_pk_bf16_f32 v73, v62, v63
    v_exp_f32 v65, v65
    v_exp_f32 v66, v66
    v_cvt_pk_bf16_f32 v74, v64, v65
    v_exp_f32 v67, v67
    v_exp_f32 v36, v36
    v_exp_f32 v37, v37
    v_cvt_pk_bf16_f32 v75, v66, v67
    v_exp_f32 v38, v38
    v_cvt_pk_bf16_f32 v68, v36, v37
    v_exp_f32 v39, v39
    v_mfma_f32_32x32x16_bf16 v[92:107], v[32:35], v[72:75], v[92:107]
    s_add_u32 s55, s55, 4096
    buffer_load_dwordx4 a[64:67], v2, s[24:27], s55 offen offset:0 sc1
    v_exp_f32 v40, v40
    v_cvt_pk_bf16_f32 v69, v38, v39
    v_exp_f32 v41, v41
    v_exp_f32 v42, v42
    v_cvt_pk_bf16_f32 v70, v40, v41
    v_exp_f32 v43, v43
    v_mfma_f32_32x32x16_bf16 v[52:67], v[16:19], v[12:15], v[124:139]
    s_cmp_lg_u32 s3, 1
    s_cbranch_scc1 L_nomid
    s_waitcnt vmcnt(12)
    s_getreg_b32 s38, hwreg(HW_REG_XCC_ID, 0, 4)
    s_xor_b32 s38, s38, s98
    s_add_u32 s39, s0, 28385280
    s_mov_b64 exec, 1
    v_mov_b32 v6, 0
    v_mov_b32 v7, s38
    buffer_store_dword v7, v6, s[24:27], s39 offen sc1
    s_mov_b64 exec, -1
L_nomid:
    ds_read_b128 v[16:19], v4 offset:19744
    ds_read_b128 v[28:31], v5 offset:19744
    ds_read_b128 v[32:35], v157 offset:19744
    v_exp_f32 v44, v44
    v_cvt_pk_bf16_f32 v71, v42, v43
    v_exp_f32 v45, v45
    v_exp_f32 v46, v46
    v_cvt_pk_bf16_f32 v72, v44, v45
    v_exp_f32 v47, v47
    v_mfma_f32_32x32x16_bf16 v[76:91], v[20:23], v[68:71], v[76:91]
    s_add_u32 s56, s56, 4096
    buffer_load_dwordx4 a[68:71], v2, s[24:27], s56 offen offset:0 sc1
    v_exp_f32 v48, v48
    v_cvt_pk_bf16_f32 v73, v46, v47
    v_exp_f32 v49, v49
    v_exp_f32 v50, v50
    v_cvt_pk_bf16_f32 v74, v48, v49
    v_exp_f32 v51, v51
    v_exp_f32 v52, v52
    v_exp_f32 v53, v53
    v_cvt_pk_bf16_f32 v75, v50, v51
    v_exp_f32 v54, v54
    v_cvt_pk_bf16_f32 v68, v52, v53
    v_exp_f32 v55, v55
    v_mfma_f32_32x32x16_bf16 v[76:91], v[24:27], v[72:75], v[76:91]
    s_waitcnt lgkmcnt(0)
    v_exp_f32 v56, v56
    v_cvt_pk_bf16_f32 v69, v54, v55
    v_exp_f32 v57, v57
    v_exp_f32 v58, v58
    v_cvt_pk_bf16_f32 v70, v56, v57
    v_exp_f32 v59, v59
    v_mfma_f32_32x32x16_bf16 v[36:51], v[16:19], v[8:11], v[108:123]
    buffer_load_dwordx4 a[72:75], v2, s[24:27], s55 offen offset:1024 sc1
    v_exp_f32 v60, v60
    v_cvt_pk_bf16_f32 v71, v58, v59
    v_exp_f32 v61, v61
    v_exp_f32 v62, v62
    v_cvt_pk_bf16_f32 v72, v60, v61
    v_exp_f32 v63, v63
    v_mfma_f32_32x32x16_bf16 v[92:107], v[20:23], v[68:71], v[92:107]
    buffer_load_dwordx4 a[76:79], v2, s[24:27], s56 offen offset:1024 sc1
    v_exp_f32 v64, v64
    v_cvt_pk_bf16_f32 v73, v62, v63
    v_exp_f32 v65, v65
    v_exp_f32 v66, v66
    v_cvt_pk_bf16_f32 v74, v64, v65
    v_exp_f32 v67, v67
    v_exp_f32 v36, v36
    v_exp_f32 v37, v37
    v_cvt_pk_bf16_f32 v75, v66, v67
    v_exp_f32 v38, v38
    v_cvt_pk_bf16_f32 v68, v36, v37
    v_exp_f32 v39, v39
    v_mfma_f32_32x32x16_bf16 v[92:107], v[24:27], v[72:75], v[92:107]
    buffer_load_dwordx4 a[80:83], v2, s[24:27], s55 offen offset:2048 sc1
    v_exp_f32 v40, v40
    v_cvt_pk_bf16_f32 v69, v38, v39
    v_exp_f32 v41, v41
    v_exp_f32 v42, v42
    v_cvt_pk_bf16_f32 v70, v40, v41
    v_exp_f32 v43, v43
    v_mfma_f32_32x32x16_bf16 v[52:67], v[16:19], v[12:15], v[124:139]
    ds_read_b128 v[16:19], v4 offset:21824
    ds_read_b128 v[20:23], v5 offset:21824
    ds_read_b128 v[24:27], v157 offset:21824
    v_exp_f32 v44, v44
    v_cvt_pk_bf16_f32 v71, v42, v43
    v_exp_f32 v45, v45
    v_exp_f32 v46, v46
    v_cvt_pk_bf16_f32 v72, v44, v45
    v_exp_f32 v47, v47
    v_mfma_f32_32x32x16_bf16 v[76:91], v[28:31], v[68:71], v[76:91]
    buffer_load_dwordx4 a[84:87], v2, s[24:27], s56 offen offset:2048 sc1
    v_exp_f32 v48, v48
    v_cvt_pk_bf16_f32 v73, v46, v47
    v_exp_f32 v49, v49
    v_exp_f32 v50, v50
    v_cvt_pk_bf16_f32 v74, v48, v49
    v_exp_f32 v51, v51
    v_exp_f32 v52, v52
    v_exp_f32 v53, v53
    v_cvt_pk_bf16_f32 v75, v50, v51
    v_exp_f32 v54, v54
    v_cvt_pk_bf16_f32 v68, v52, v53
    v_exp_f32 v55, v55
    v_mfma_f32_32x32x16_bf16 v[76:91], v[32:35], v[72:75], v[76:91]
    s_waitcnt lgkmcnt(0)
    v_exp_f32 v56, v56
    v_cvt_pk_bf16_f32 v69, v54, v55
    v_exp_f32 v57, v57
    v_exp_f32 v58, v58
    v_cvt_pk_bf16_f32 v70, v56, v57
    v_exp_f32 v59, v59
    v_mfma_f32_32x32x16_bf16 v[36:51], v[16:19], v[8:11], v[108:123]
    buffer_load_dwordx4 a[88:91], v2, s[24:27], s55 offen offset:3072 sc1
    v_exp_f32 v60, v60
    v_cvt_pk_bf16_f32 v71, v58, v59
    v_exp_f32 v61, v61
    v_exp_f32 v62, v62
    v_cvt_pk_bf16_f32 v72, v60, v61
    v_exp_f32 v63, v63
    v_mfma_f32_32x32x16_bf16 v[92:107], v[28:31], v[68:71], v[92:107]
    buffer_load_dwordx4 a[92:95], v2, s[24:27], s56 offen offset:3072 sc1
    v_exp_f32 v64, v64
    v_cvt_pk_bf16_f32 v73, v62, v63
    v_exp_f32 v65, v65
    v_exp_f32 v66, v66
    v_cvt_pk_bf16_f32 v74, v64, v65
    v_exp_f32 v67, v67
    v_exp_f32 v36, v36
    v_exp_f32 v37, v37
    v_cvt_pk_bf16_f32 v75, v66, v67
    v_exp_f32 v38, v38
    v_cvt_pk_bf16_f32 v68, v36, v37
    v_exp_f32 v39, v39
    v_mfma_f32_32x32x16_bf16 v[92:107], v[32:35], v[72:75], v[92:107]
    s_add_u32 s55, s55, 4096
    buffer_load_dwordx4 a[96:99], v2, s[24:27], s55 offen offset:0 sc1
    v_exp_f32 v40, v40
    v_cvt_pk_bf16_f32 v69, v38, v39
    v_exp_f32 v41, v41
    v_exp_f32 v42, v42
    v_cvt_pk_bf16_f32 v70, v40, v41
    v_exp_f32 v43, v43
    v_mfma_f32_32x32x16_bf16 v[52:67], v[16:19], v[12:15], v[124:139]
    ds_read_b128 v[16:19], v4 offset:23904
    ds_read_b128 v[28:31], v5 offset:23904
    ds_read_b128 v[32:35], v157 offset:23904
    v_exp_f32 v44, v44
    v_cvt_pk_bf16_f32 v71, v42, v43
    v_exp_f32 v45, v45
    v_exp_f32 v46, v46
    v_cvt_pk_bf16_f32 v72, v44, v45
    v_exp_f32 v47, v47
    v_mfma_f32_32x32x16_bf16 v[76:91], v[20:23], v[68:71], v[76:91]
    s_add_u32 s56, s56, 4096
    buffer_load_dwordx4 a[100:103], v2, s[24:27], s56 offen offset:0 sc1
    v_exp_f32 v48, v48
    v_cvt_pk_bf16_f32 v73, v46, v47
    v_exp_f32 v49, v49
    v_exp_f32 v50, v50
    v_cvt_pk_bf16_f32 v74, v48, v49
    v_exp_f32 v51, v51
    v_exp_f32 v52, v52
    v_exp_f32 v53, v53
    v_cvt_pk_bf16_f32 v75, v50, v51
    v_exp_f32 v54, v54
    v_cvt_pk_bf16_f32 v68, v52, v53
    v_exp_f32 v55, v55
    v_mfma_f32_32x32x16_bf16 v[76:91], v[24:27], v[72:75], v[76:91]
    s_waitcnt lgkmcnt(0)
    v_exp_f32 v56, v56
    v_cvt_pk_bf16_f32 v69, v54, v55
    v_exp_f32 v57, v57
    v_exp_f32 v58, v58
    v_cvt_pk_bf16_f32 v70, v56, v57
    v_exp_f32 v59, v59
    v_mfma_f32_32x32x16_bf16 v[36:51], v[16:19], v[8:11], v[108:123]
    buffer_load_dwordx4 a[104:107], v2, s[24:27], s55 offen offset:1024 sc1
    v_exp_f32 v60, v60
    v_cvt_pk_bf16_f32 v71, v58, v59
    v_exp_f32 v61, v61
    v_exp_f32 v62, v62
    v_cvt_pk_bf16_f32 v72, v60, v61
    v_exp_f32 v63, v63
    v_mfma_f32_32x32x16_bf16 v[92:107], v[20:23], v[68:71], v[92:107]
    buffer_load_dwordx4 a[108:111], v2, s[24:27], s56 offen offset:1024 sc1
    v_exp_f32 v64, v64
    v_cvt_pk_bf16_f32 v73, v62, v63
    v_exp_f32 v65, v65
    v_exp_f32 v66, v66
    v_cvt_pk_bf16_f32 v74, v64, v65
    v_exp_f32 v67, v67
    v_exp_f32 v36, v36
    v_exp_f32 v37, v37
    v_cvt_pk_bf16_f32 v75, v66, v67
    v_exp_f32 v38, v38
    v_cvt_pk_bf16_f32 v68, v36, v37
    v_exp_f32 v39, v39
    v_mfma_f32_32x32x16_bf16 v[92:107], v[24:27], v[72:75], v[92:107]
    buffer_load_dwordx4 a[112:115], v2, s[24:27], s55 offen offset:2048 sc1
    v_exp_f32 v40, v40
    v_cvt_pk_bf16_f32 v69, v38, v39
    v_exp_f32 v41, v41
    v_exp_f32 v42, v42
    v_cvt_pk_bf16_f32 v70, v40, v41
    v_exp_f32 v43, v43
    v_mfma_f32_32x32x16_bf16 v[52:67], v[16:19], v[12:15], v[124:139]
    s_barrier
    ds_read_b128 v[16:19], v4 offset:25984
    ds_read_b128 v[20:23], v5 offset:25984
    ds_read_b128 v[24:27], v157 offset:25984
    v_exp_f32 v44, v44
    v_cvt_pk_bf16_f32 v71, v42, v43
    v_exp_f32 v45, v45
    v_exp_f32 v46, v46
    v_cvt_pk_bf16_f32 v72, v44, v45
    v_exp_f32 v47, v47
    v_mfma_f32_32x32x16_bf16 v[76:91], v[28:31], v[68:71], v[76:91]
    buffer_load_dwordx4 a[116:119], v2, s[24:27], s56 offen offset:2048 sc1
    v_exp_f32 v48, v48
    v_cvt_pk_bf16_f32 v73, v46, v47
    v_exp_f32 v49, v49
    v_exp_f32 v50, v50
    v_cvt_pk_bf16_f32 v74, v48, v49
    v_exp_f32 v51, v51
    v_exp_f32 v52, v52
    v_exp_f32 v53, v53
    v_cvt_pk_bf16_f32 v75, v50, v51
    v_exp_f32 v54, v54
    v_cvt_pk_bf16_f32 v68, v52, v53
    v_exp_f32 v55, v55
    v_mfma_f32_32x32x16_bf16 v[76:91], v[32:35], v[72:75], v[76:91]
    s_waitcnt lgkmcnt(0)
    v_exp_f32 v56, v56
    v_cvt_pk_bf16_f32 v69, v54, v55
    v_exp_f32 v57, v57
    v_exp_f32 v58, v58
    v_cvt_pk_bf16_f32 v70, v56, v57
    v_exp_f32 v59, v59
    v_mfma_f32_32x32x16_bf16 v[36:51], v[16:19], v[8:11], v[108:123]
    buffer_load_dwordx4 a[120:123], v2, s[24:27], s55 offen offset:3072 sc1
    v_exp_f32 v60, v60
    v_cvt_pk_bf16_f32 v71, v58, v59
    v_exp_f32 v61, v61
    v_exp_f32 v62, v62
    v_cvt_pk_bf16_f32 v72, v60, v61
    v_exp_f32 v63, v63
    v_mfma_f32_32x32x16_bf16 v[92:107], v[28:31], v[68:71], v[92:107]
    s_add_u32 m0, s23, 0
    s_add_u32 s44, s21, 0
    buffer_load_dwordx4 v2, s[24:27], s44 offen offset:0 sc1 lds
    v_exp_f32 v64, v64
    v_cvt_pk_bf16_f32 v73, v62, v63
    v_exp_f32 v65, v65
    v_exp_f32 v66, v66
    v_cvt_pk_bf16_f32 v74, v64, v65
    v_exp_f32 v67, v67
    v_exp_f32 v36, v36
    v_exp_f32 v37, v37
    v_cvt_pk_bf16_f32 v75, v66, v67
    v_exp_f32 v38, v38
    v_cvt_pk_bf16_f32 v68, v36, v37
    v_exp_f32 v39, v39
    v_mfma_f32_32x32x16_bf16 v[92:107], v[32:35], v[72:75], v[92:107]
    buffer_load_dwordx4 a[124:127], v2, s[24:27], s56 offen offset:3072 sc1
    v_exp_f32 v40, v40
    v_cvt_pk_bf16_f32 v69, v38, v39
    v_exp_f32 v41, v41
    v_exp_f32 v42, v42
    v_cvt_pk_bf16_f32 v70, v40, v41
    v_exp_f32 v43, v43
    v_mfma_f32_32x32x16_bf16 v[52:67], v[16:19], v[12:15], v[124:139]
    ds_read_b128 v[16:19], v4 offset:28064
    ds_read_b128 v[28:31], v5 offset:28064
    ds_read_b128 v[32:35], v157 offset:28064
    v_exp_f32 v44, v44
    v_cvt_pk_bf16_f32 v71, v42, v43
    v_exp_f32 v45, v45
    v_exp_f32 v46, v46
    v_cvt_pk_bf16_f32 v72, v44, v45
    v_exp_f32 v47, v47
    v_mfma_f32_32x32x16_bf16 v[76:91], v[20:23], v[68:71], v[76:91]
    buffer_load_dwordx4 v2, s[24:27], s44 offen offset:1024 sc1 lds
    v_exp_f32 v48, v48
    v_cvt_pk_bf16_f32 v73, v46, v47
    v_exp_f32 v49, v49
    v_exp_f32 v50, v50
    v_cvt_pk_bf16_f32 v74, v48, v49
    v_exp_f32 v51, v51
    v_exp_f32 v52, v52
    v_exp_f32 v53, v53
    v_cvt_pk_bf16_f32 v75, v50, v51
    v_exp_f32 v54, v54
    v_cvt_pk_bf16_f32 v68, v52, v53
    v_exp_f32 v55, v55
    v_mfma_f32_32x32x16_bf16 v[76:91], v[24:27], v[72:75], v[76:91]
    s_waitcnt lgkmcnt(0)
    v_exp_f32 v56, v56
    v_cvt_pk_bf16_f32 v69, v54, v55
    v_exp_f32 v57, v57
    v_exp_f32 v58, v58
    v_cvt_pk_bf16_f32 v70, v56, v57
    v_exp_f32 v59, v59
    v_mfma_f32_32x32x16_bf16 v[36:51], v[16:19], v[8:11], v[108:123]
    s_add_u32 s55, s55, 4096
    buffer_load_dwordx4 a[128:131], v2, s[24:27], s55 offen offset:0 sc1
    v_exp_f32 v60, v60
    v_cvt_pk_bf16_f32 v71, v58, v59
    v_exp_f32 v61, v61
    v_exp_f32 v62, v62
    v_cvt_pk_bf16_f32 v72, v60, v61
    v_exp_f32 v63, v63
    v_mfma_f32_32x32x16_bf16 v[92:107], v[20:23], v[68:71], v[92:107]
    buffer_load_dwordx4 v2, s[24:27], s44 offen offset:2048 sc1 lds
    v_exp_f32 v64, v64
    v_cvt_pk_bf16_f32 v73, v62, v63
    v_exp_f32 v65, v65
    v_exp_f32 v66, v66
    v_cvt_pk_bf16_f32 v74, v64, v65
    v_exp_f32 v67, v67
    v_exp_f32 v36, v36
    v_exp_f32 v37, v37
    v_cvt_pk_bf16_f32 v75, v66, v67
    v_exp_f32 v38, v38
    v_cvt_pk_bf16_f32 v68, v36, v37
    v_exp_f32 v39, v39
    v_mfma_f32_32x32x16_bf16 v[92:107], v[24:27], v[72:75], v[92:107]
    s_add_u32 s56, s56, 4096
    buffer_load_dwordx4 a[132:135], v2, s[24:27], s56 offen offset:0 sc1
    v_exp_f32 v40, v40
    v_cvt_pk_bf16_f32 v69, v38, v39
    v_exp_f32 v41, v41
    v_exp_f32 v42, v42
    v_cvt_pk_bf16_f32 v70, v40, v41
    v_exp_f32 v43, v43
    v_mfma_f32_32x32x16_bf16 v[52:67], v[16:19], v[12:15], v[124:139]
    ds_read_b128 v[16:19], v4 offset:30144
    ds_read_b128 v[20:23], v5 offset:30144
    ds_read_b128 v[24:27], v157 offset:30144
    v_exp_f32 v44, v44
    v_cvt_pk_bf16_f32 v71, v42, v43
    v_exp_f32 v45, v45
    v_exp_f32 v46, v46
    v_cvt_pk_bf16_f32 v72, v44, v45
    v_exp_f32 v47, v47
    v_mfma_f32_32x32x16_bf16 v[76:91], v[28:31], v[68:71], v[76:91]
    buffer_load_dwordx4 v2, s[24:27], s44 offen offset:3072 sc1 lds
    v_exp_f32 v48, v48
    v_cvt_pk_bf16_f32 v73, v46, v47
    v_exp_f32 v49, v49
    v_exp_f32 v50, v50
    v_cvt_pk_bf16_f32 v74, v48, v49
    v_exp_f32 v51, v51
    v_exp_f32 v52, v52
    v_exp_f32 v53, v53
    v_cvt_pk_bf16_f32 v75, v50, v51
    v_exp_f32 v54, v54
    v_cvt_pk_bf16_f32 v68, v52, v53
    v_exp_f32 v55, v55
    v_mfma_f32_32x32x16_bf16 v[76:91], v[32:35], v[72:75], v[76:91]
    s_waitcnt lgkmcnt(0)
    v_exp_f32 v56, v56
    v_cvt_pk_bf16_f32 v69, v54, v55
    v_exp_f32 v57, v57
    v_exp_f32 v58, v58
    v_cvt_pk_bf16_f32 v70, v56, v57
    v_exp_f32 v59, v59
    v_mfma_f32_32x32x16_bf16 v[36:51], v[16:19], v[8:11], v[108:123]
    buffer_load_dwordx4 a[136:139], v2, s[24:27], s55 offen offset:1024 sc1
    v_exp_f32 v60, v60
    v_cvt_pk_bf16_f32 v71, v58, v59
    v_exp_f32 v61, v61
    v_exp_f32 v62, v62
    v_cvt_pk_bf16_f32 v72, v60, v61
    v_exp_f32 v63, v63
    v_mfma_f32_32x32x16_bf16 v[92:107], v[28:31], v[68:71], v[92:107]
    s_add_u32 m0, s23, 4096
    s_add_u32 s44, s21, 4096
    buffer_load_dwordx4 v2, s[24:27], s44 offen offset:0 sc1 lds
    v_exp_f32 v64, v64
    v_cvt_pk_bf16_f32 v73, v62, v63
    v_exp_f32 v65, v65
    v_exp_f32 v66, v66
    v_cvt_pk_bf16_f32 v74, v64, v65
    v_exp_f32 v67, v67
    v_exp_f32 v36, v36
    v_exp_f32 v37, v37
    v_cvt_pk_bf16_f32 v75, v66, v67
    v_exp_f32 v38, v38
    v_cvt_pk_bf16_f32 v68, v36, v37
    v_exp_f32 v39, v39
    v_mfma_f32_32x32x16_bf16 v[92:107], v[32:35], v[72:75], v[92:107]
    buffer_load_dwordx4 a[140:143], v2, s[24:27], s56 offen offset:1024 sc1
    v_exp_f32 v40, v40
    v_cvt_pk_bf16_f32 v69, v38, v39
    v_exp_f32 v41, v41
    v_exp_f32 v42, v42
    v_cvt_pk_bf16_f32 v70, v40, v41
    v_exp_f32 v43, v43
    v_mfma_f32_32x32x16_bf16 v[52:67], v[16:19], v[12:15], v[124:139]
    ds_read_b128 v[16:19], v4 offset:32224
    ds_read_b128 v[28:31], v5 offset:32224
    ds_read_b128 v[32:35], v157 offset:32224
    v_exp_f32 v44, v44
    v_cvt_pk_bf16_f32 v71, v42, v43
    v_exp_f32 v45, v45
    v_exp_f32 v46, v46
    v_cvt_pk_bf16_f32 v72, v44, v45
    v_exp_f32 v47, v47
    v_mfma_f32_32x32x16_bf16 v[76:91], v[20:23], v[68:71], v[76:91]
    buffer_load_dwordx4 v2, s[24:27], s44 offen offset:1024 sc1 lds
    v_exp_f32 v48, v48
    v_cvt_pk_bf16_f32 v73, v46, v47
    v_exp_f32 v49, v49
    v_exp_f32 v50, v50
    v_cvt_pk_bf16_f32 v74, v48, v49
    v_exp_f32 v51, v51
    v_exp_f32 v52, v52
    v_exp_f32 v53, v53
    v_cvt_pk_bf16_f32 v75, v50, v51
    v_exp_f32 v54, v54
    v_cvt_pk_bf16_f32 v68, v52, v53
    v_exp_f32 v55, v55
    v_mfma_f32_32x32x16_bf16 v[76:91], v[24:27], v[72:75], v[76:91]
    s_waitcnt lgkmcnt(0)
    v_exp_f32 v56, v56
    v_cvt_pk_bf16_f32 v69, v54, v55
    v_exp_f32 v57, v57
    v_exp_f32 v58, v58
    v_cvt_pk_bf16_f32 v70, v56, v57
    v_exp_f32 v59, v59
    v_mfma_f32_32x32x16_bf16 v[36:51], v[16:19], v[8:11], v[108:123]
    buffer_load_dwordx4 a[144:147], v2, s[24:27], s55 offen offset:2048 sc1
    v_exp_f32 v60, v60
    v_cvt_pk_bf16_f32 v71, v58, v59
    v_exp_f32 v61, v61
    v_exp_f32 v62, v62
    v_cvt_pk_bf16_f32 v72, v60, v61
    v_exp_f32 v63, v63
    v_mfma_f32_32x32x16_bf16 v[92:107], v[20:23], v[68:71], v[92:107]
    buffer_load_dwordx4 v2, s[24:27], s44 offen offset:2048 sc1 lds
    v_exp_f32 v64, v64
    v_cvt_pk_bf16_f32 v73, v62, v63
    v_exp_f32 v65, v65
    v_exp_f32 v66, v66
    v_cvt_pk_bf16_f32 v74, v64, v65
    v_exp_f32 v67, v67
    v_exp_f32 v36, v36
    v_exp_f32 v37, v37
    v_cvt_pk_bf16_f32 v75, v66, v67
    v_exp_f32 v38, v38
    v_cvt_pk_bf16_f32 v68, v36, v37
    v_exp_f32 v39, v39
    v_mfma_f32_32x32x16_bf16 v[92:107], v[24:27], v[72:75], v[92:107]
    buffer_load_dwordx4 a[148:151], v2, s[24:27], s56 offen offset:2048 sc1
    v_exp_f32 v40, v40
    v_cvt_pk_bf16_f32 v69, v38, v39
    v_exp_f32 v41, v41
    v_exp_f32 v42, v42
    v_cvt_pk_bf16_f32 v70, v40, v41
    v_exp_f32 v43, v43
    v_mfma_f32_32x32x16_bf16 v[52:67], v[16:19], v[12:15], v[124:139]
    ds_read_b128 v[16:19], v4 offset:34304
    ds_read_b128 v[20:23], v5 offset:34304
    ds_read_b128 v[24:27], v157 offset:34304
    v_exp_f32 v44, v44
    v_cvt_pk_bf16_f32 v71, v42, v43
    v_exp_f32 v45, v45
    v_exp_f32 v46, v46
    v_cvt_pk_bf16_f32 v72, v44, v45
    v_exp_f32 v47, v47
    v_mfma_f32_32x32x16_bf16 v[76:91], v[28:31], v[68:71], v[76:91]
    buffer_load_dwordx4 v2, s[24:27], s44 offen offset:3072 sc1 lds
    v_exp_f32 v48, v48
    v_cvt_pk_bf16_f32 v73, v46, v47
    v_exp_f32 v49, v49
    v_exp_f32 v50, v50
    v_cvt_pk_bf16_f32 v74, v48, v49
    v_exp_f32 v51, v51
    v_exp_f32 v52, v52
    v_exp_f32 v53, v53
    v_cvt_pk_bf16_f32 v75, v50, v51
    v_exp_f32 v54, v54
    v_cvt_pk_bf16_f32 v68, v52, v53
    v_exp_f32 v55, v55
    v_mfma_f32_32x32x16_bf16 v[76:91], v[32:35], v[72:75], v[76:91]
    s_waitcnt lgkmcnt(0)
    v_exp_f32 v56, v56
    v_cvt_pk_bf16_f32 v69, v54, v55
    v_exp_f32 v57, v57
    v_exp_f32 v58, v58
    v_cvt_pk_bf16_f32 v70, v56, v57
    v_exp_f32 v59, v59
    v_mfma_f32_32x32x16_bf16 v[36:51], v[16:19], v[8:11], v[108:123]
    buffer_load_dwordx4 a[152:155], v2, s[24:27], s55 offen offset:3072 sc1
    v_exp_f32 v60, v60
    v_cvt_pk_bf16_f32 v71, v58, v59
    v_exp_f32 v61, v61
    v_exp_f32 v62, v62
    v_cvt_pk_bf16_f32 v72, v60, v61
    v_exp_f32 v63, v63
    v_mfma_f32_32x32x16_bf16 v[92:107], v[28:31], v[68:71], v[92:107]
    s_add_u32 m0, s23, 8192
    s_add_u32 s44, s21, 8192
    buffer_load_dwordx4 v2, s[24:27], s44 offen offset:0 sc1 lds
    v_exp_f32 v64, v64
    v_cvt_pk_bf16_f32 v73, v62, v63
    v_exp_f32 v65, v65
    v_exp_f32 v66, v66
    v_cvt_pk_bf16_f32 v74, v64, v65
    v_exp_f32 v67, v67
    v_exp_f32 v36, v36
    v_exp_f32 v37, v37
    v_cvt_pk_bf16_f32 v75, v66, v67
    v_exp_f32 v38, v38
    v_cvt_pk_bf16_f32 v68, v36, v37
    v_exp_f32 v39, v39
    v_mfma_f32_32x32x16_bf16 v[92:107], v[32:35], v[72:75], v[92:107]
    buffer_load_dwordx4 a[156:159], v2, s[24:27], s56 offen offset:3072 sc1
    v_exp_f32 v40, v40
    v_cvt_pk_bf16_f32 v69, v38, v39
    v_exp_f32 v41, v41
    v_exp_f32 v42, v42
    v_cvt_pk_bf16_f32 v70, v40, v41
    v_exp_f32 v43, v43
    v_mfma_f32_32x32x16_bf16 v[52:67], v[16:19], v[12:15], v[124:139]
    ds_read_b128 v[16:19], v4 offset:36384
    ds_read_b128 v[28:31], v5 offset:36384
    ds_read_b128 v[32:35], v157 offset:36384
    v_exp_f32 v44, v44
    v_cvt_pk_bf16_f32 v71, v42, v43
    v_exp_f32 v45, v45
    v_exp_f32 v46, v46
    v_cvt_pk_bf16_f32 v72, v44, v45
    v_exp_f32 v47, v47
    v_mfma_f32_32x32x16_bf16 v[76:91], v[20:23], v[68:71], v[76:91]
    buffer_load_dwordx4 v2, s[24:27], s44 offen offset:1024 sc1 lds
    v_exp_f32 v48, v48
    v_cvt_pk_bf16_f32 v73, v46, v47
    v_exp_f32 v49, v49
    v_exp_f32 v50, v50
    v_cvt_pk_bf16_f32 v74, v48, v49
    v_exp_f32 v51, v51
    v_exp_f32 v52, v52
    v_exp_f32 v53, v53
    v_cvt_pk_bf16_f32 v75, v50, v51
    v_exp_f32 v54, v54
    v_cvt_pk_bf16_f32 v68, v52, v53
    v_exp_f32 v55, v55
    v_mfma_f32_32x32x16_bf16 v[76:91], v[24:27], v[72:75], v[76:91]
    s_waitcnt lgkmcnt(0)
    v_exp_f32 v56, v56
    v_cvt_pk_bf16_f32 v69, v54, v55
    v_exp_f32 v57, v57
    v_exp_f32 v58, v58
    v_cvt_pk_bf16_f32 v70, v56, v57
    v_exp_f32 v59, v59
    v_mfma_f32_32x32x16_bf16 v[36:51], v[16:19], v[8:11], v[108:123]
    s_add_u32 s55, s55, 4096
    buffer_load_dwordx4 a[160:163], v2, s[24:27], s55 offen offset:0 sc1
    v_exp_f32 v60, v60
    v_cvt_pk_bf16_f32 v71, v58, v59
    v_exp_f32 v61, v61
    v_exp_f32 v62, v62
    v_cvt_pk_bf16_f32 v72, v60, v61
    v_exp_f32 v63, v63
    v_mfma_f32_32x32x16_bf16 v[92:107], v[20:23], v[68:71], v[92:107]
    buffer_load_dwordx4 v2, s[24:27], s44 offen offset:2048 sc1 lds
    v_exp_f32 v64, v64
    v_cvt_pk_bf16_f32 v73, v62, v63
    v_exp_f32 v65, v65
    v_exp_f32 v66, v66
    v_cvt_pk_bf16_f32 v74, v64, v65
    v_exp_f32 v67, v67
    v_exp_f32 v36, v36
    v_exp_f32 v37, v37
    v_cvt_pk_bf16_f32 v75, v66, v67
    v_exp_f32 v38, v38
    v_cvt_pk_bf16_f32 v68, v36, v37
    v_exp_f32 v39, v39
    v_mfma_f32_32x32x16_bf16 v[92:107], v[24:27], v[72:75], v[92:107]
    s_add_u32 s56, s56, 4096
    buffer_load_dwordx4 a[164:167], v2, s[24:27], s56 offen offset:0 sc1
    v_exp_f32 v40, v40
    v_cvt_pk_bf16_f32 v69, v38, v39
    v_exp_f32 v41, v41
    v_exp_f32 v42, v42
    v_cvt_pk_bf16_f32 v70, v40, v41
    v_exp_f32 v43, v43
    v_mfma_f32_32x32x16_bf16 v[52:67], v[16:19], v[12:15], v[124:139]
    ds_read_b128 v[16:19], v4 offset:38464
    ds_read_b128 v[20:23], v5 offset:38464
    ds_read_b128 v[24:27], v157 offset:38464
    v_exp_f32 v44, v44
    v_cvt_pk_bf16_f32 v71, v42, v43
    v_exp_f32 v45, v45
    v_exp_f32 v46, v46
    v_cvt_pk_bf16_f32 v72, v44, v45
    v_exp_f32 v47, v47
    v_mfma_f32_32x32x16_bf16 v[76:91], v[28:31], v[68:71], v[76:91]
    buffer_load_dwordx4 v2, s[24:27], s44 offen offset:3072 sc1 lds
    v_exp_f32 v48, v48
    v_cvt_pk_bf16_f32 v73, v46, v47
    v_exp_f32 v49, v49
    v_exp_f32 v50, v50
    v_cvt_pk_bf16_f32 v74, v48, v49
    v_exp_f32 v51, v51
    v_exp_f32 v52, v52
    v_exp_f32 v53, v53
    v_cvt_pk_bf16_f32 v75, v50, v51
    v_exp_f32 v54, v54
    v_cvt_pk_bf16_f32 v68, v52, v53
    v_exp_f32 v55, v55
    v_mfma_f32_32x32x16_bf16 v[76:91], v[32:35], v[72:75], v[76:91]
    s_waitcnt lgkmcnt(0)
    v_exp_f32 v56, v56
    v_cvt_pk_bf16_f32 v69, v54, v55
    v_exp_f32 v57, v57
    v_exp_f32 v58, v58
    v_cvt_pk_bf16_f32 v70, v56, v57
    v_exp_f32 v59, v59
    v_mfma_f32_32x32x16_bf16 v[36:51], v[16:19], v[8:11], v[108:123]
    buffer_load_dwordx4 a[168:171], v2, s[24:27], s55 offen offset:1024 sc1
    v_exp_f32 v60, v60
    v_cvt_pk_bf16_f32 v71, v58, v59
    v_exp_f32 v61, v61
    v_exp_f32 v62, v62
    v_cvt_pk_bf16_f32 v72, v60, v61
    v_exp_f32 v63, v63
    v_mfma_f32_32x32x16_bf16 v[92:107], v[28:31], v[68:71], v[92:107]
    s_add_u32 m0, s23, 12288
    s_add_u32 s44, s21, 12288
    buffer_load_dwordx4 v2, s[24:27], s44 offen offset:0 sc1 lds
    v_exp_f32 v64, v64
    v_cvt_pk_bf16_f32 v73, v62, v63
    v_exp_f32 v65, v65
    v_exp_f32 v66, v66
    v_cvt_pk_bf16_f32 v74, v64, v65
    v_exp_f32 v67, v67
    v_exp_f32 v36, v36
    v_exp_f32 v37, v37
    v_cvt_pk_bf16_f32 v75, v66, v67
    v_exp_f32 v38, v38
    v_cvt_pk_bf16_f32 v68, v36, v37
    v_exp_f32 v39, v39
    v_mfma_f32_32x32x16_bf16 v[92:107], v[32:35], v[72:75], v[92:107]
    buffer_load_dwordx4 a[172:175], v2, s[24:27], s56 offen offset:1024 sc1
    v_exp_f32 v40, v40
    v_cvt_pk_bf16_f32 v69, v38, v39
    v_exp_f32 v41, v41
    v_exp_f32 v42, v42
    v_cvt_pk_bf16_f32 v70, v40, v41
    v_exp_f32 v43, v43
    v_mfma_f32_32x32x16_bf16 v[52:67], v[16:19], v[12:15], v[124:139]
    ds_read_b128 v[16:19], v4 offset:40544
    ds_read_b128 v[28:31], v5 offset:40544
    ds_read_b128 v[32:35], v157 offset:40544
    v_exp_f32 v44, v44
    v_cvt_pk_bf16_f32 v71, v42, v43
    v_exp_f32 v45, v45
    v_exp_f32 v46, v46
    v_cvt_pk_bf16_f32 v72, v44, v45
    v_exp_f32 v47, v47
    v_mfma_f32_32x32x16_bf16 v[76:91], v[20:23], v[68:71], v[76:91]
    buffer_load_dwordx4 v2, s[24:27], s44 offen offset:1024 sc1 lds
    v_exp_f32 v48, v48
    v_cvt_pk_bf16_f32 v73, v46, v47
    v_exp_f32 v49, v49
    v_exp_f32 v50, v50
    v_cvt_pk_bf16_f32 v74, v48, v49
    v_exp_f32 v51, v51
    v_exp_f32 v52, v52
    v_exp_f32 v53, v53
    v_cvt_pk_bf16_f32 v75, v50, v51
    v_exp_f32 v54, v54
    v_cvt_pk_bf16_f32 v68, v52, v53
    v_exp_f32 v55, v55
    v_mfma_f32_32x32x16_bf16 v[76:91], v[24:27], v[72:75], v[76:91]
    s_waitcnt lgkmcnt(0)
    v_exp_f32 v56, v56
    v_cvt_pk_bf16_f32 v69, v54, v55
    v_exp_f32 v57, v57
    v_exp_f32 v58, v58
    v_cvt_pk_bf16_f32 v70, v56, v57
    v_exp_f32 v59, v59
    v_mfma_f32_32x32x16_bf16 v[36:51], v[16:19], v[8:11], v[108:123]
    buffer_load_dwordx4 a[224:227], v2, s[24:27], s51 offen offset:0 sc1
    v_exp_f32 v60, v60
    v_cvt_pk_bf16_f32 v71, v58, v59
    v_exp_f32 v61, v61
    v_exp_f32 v62, v62
    v_cvt_pk_bf16_f32 v72, v60, v61
    v_exp_f32 v63, v63
    v_mfma_f32_32x32x16_bf16 v[92:107], v[20:23], v[68:71], v[92:107]
    buffer_load_dwordx4 v2, s[24:27], s44 offen offset:2048 sc1 lds
    v_exp_f32 v64, v64
    v_cvt_pk_bf16_f32 v73, v62, v63
    v_exp_f32 v65, v65
    v_exp_f32 v66, v66
    v_cvt_pk_bf16_f32 v74, v64, v65
    v_exp_f32 v67, v67
    v_exp_f32 v36, v36
    v_exp_f32 v37, v37
    v_cvt_pk_bf16_f32 v75, v66, v67
    v_exp_f32 v38, v38
    v_cvt_pk_bf16_f32 v68, v36, v37
    v_exp_f32 v39, v39
    v_mfma_f32_32x32x16_bf16 v[92:107], v[24:27], v[72:75], v[92:107]
    buffer_load_dwordx4 a[228:231], v2, s[24:27], s51 offen offset:1024 sc1
    v_exp_f32 v40, v40
    v_cvt_pk_bf16_f32 v69, v38, v39
    v_exp_f32 v41, v41
    v_exp_f32 v42, v42
    v_cvt_pk_bf16_f32 v70, v40, v41
    v_exp_f32 v43, v43
    v_mfma_f32_32x32x16_bf16 v[52:67], v[16:19], v[12:15], v[124:139]
    ds_read_b128 v[16:19], v4 offset:42624
    ds_read_b128 v[20:23], v5 offset:42624
    ds_read_b128 v[24:27], v157 offset:42624
    v_exp_f32 v44, v44
    v_cvt_pk_bf16_f32 v71, v42, v43
    v_exp_f32 v45, v45
    v_exp_f32 v46, v46
    v_cvt_pk_bf16_f32 v72, v44, v45
    v_exp_f32 v47, v47
    v_mfma_f32_32x32x16_bf16 v[76:91], v[28:31], v[68:71], v[76:91]
    buffer_load_dwordx4 v2, s[24:27], s44 offen offset:3072 sc1 lds
    v_exp_f32 v48, v48
    v_cvt_pk_bf16_f32 v73, v46, v47
    v_exp_f32 v49, v49
    v_exp_f32 v50, v50
    v_cvt_pk_bf16_f32 v74, v48, v49
    v_exp_f32 v51, v51
    v_exp_f32 v52, v52
    v_exp_f32 v53, v53
    v_cvt_pk_bf16_f32 v75, v50, v51
    v_exp_f32 v54, v54
    v_cvt_pk_bf16_f32 v68, v52, v53
    v_exp_f32 v55, v55
    v_mfma_f32_32x32x16_bf16 v[76:91], v[32:35], v[72:75], v[76:91]
    s_waitcnt lgkmcnt(0)
    v_exp_f32 v56, v56
    v_cvt_pk_bf16_f32 v69, v54, v55
    v_exp_f32 v57, v57
    v_exp_f32 v58, v58
    v_cvt_pk_bf16_f32 v70, v56, v57
    v_exp_f32 v59, v59
    v_mfma_f32_32x32x16_bf16 v[36:51], v[16:19], v[8:11], v[108:123]
    buffer_load_dwordx4 a[232:235], v2, s[24:27], s51 offen offset:2048 sc1
    v_exp_f32 v60, v60
    v_cvt_pk_bf16_f32 v71, v58, v59
    v_exp_f32 v61, v61
    v_exp_f32 v62, v62
    v_cvt_pk_bf16_f32 v72, v60, v61
    v_exp_f32 v63, v63
    v_mfma_f32_32x32x16_bf16 v[92:107], v[28:31], v[68:71], v[92:107]
    s_add_u32 m0, s23, 16384
    s_add_u32 s44, s21, 16384
    buffer_load_dwordx4 v2, s[24:27], s44 offen offset:0 sc1 lds
    v_exp_f32 v64, v64
    v_cvt_pk_bf16_f32 v73, v62, v63
    v_exp_f32 v65, v65
    v_exp_f32 v66, v66
    v_cvt_pk_bf16_f32 v74, v64, v65
    v_exp_f32 v67, v67
    v_exp_f32 v36, v36
    v_exp_f32 v37, v37
    v_cvt_pk_bf16_f32 v75, v66, v67
    v_exp_f32 v38, v38
    v_cvt_pk_bf16_f32 v68, v36, v37
    v_exp_f32 v39, v39
    v_mfma_f32_32x32x16_bf16 v[92:107], v[32:35], v[72:75], v[92:107]
    buffer_load_dwordx4 a[236:239], v2, s[24:27], s51 offen offset:3072 sc1
    v_exp_f32 v40, v40
    v_cvt_pk_bf16_f32 v69, v38, v39
    v_exp_f32 v41, v41
    v_exp_f32 v42, v42
    v_cvt_pk_bf16_f32 v70, v40, v41
    v_exp_f32 v43, v43
    v_mfma_f32_32x32x16_bf16 v[52:67], v[16:19], v[12:15], v[124:139]
    ds_read_b128 v[16:19], v4 offset:44704
    ds_read_b128 v[28:31], v5 offset:44704
    ds_read_b128 v[32:35], v157 offset:44704
    v_exp_f32 v44, v44
    v_cvt_pk_bf16_f32 v71, v42, v43
    v_exp_f32 v45, v45
    v_exp_f32 v46, v46
    v_cvt_pk_bf16_f32 v72, v44, v45
    v_exp_f32 v47, v47
    v_mfma_f32_32x32x16_bf16 v[76:91], v[20:23], v[68:71], v[76:91]
    buffer_load_dwordx4 v2, s[24:27], s44 offen offset:1024 sc1 lds
    v_exp_f32 v48, v48
    v_cvt_pk_bf16_f32 v73, v46, v47
    v_exp_f32 v49, v49
    v_exp_f32 v50, v50
    v_cvt_pk_bf16_f32 v74, v48, v49
    v_exp_f32 v51, v51
    v_exp_f32 v52, v52
    v_exp_f32 v53, v53
    v_cvt_pk_bf16_f32 v75, v50, v51
    v_exp_f32 v54, v54
    v_cvt_pk_bf16_f32 v68, v52, v53
    v_exp_f32 v55, v55
    v_mfma_f32_32x32x16_bf16 v[76:91], v[24:27], v[72:75], v[76:91]
    s_waitcnt lgkmcnt(0)
    v_exp_f32 v56, v56
    v_cvt_pk_bf16_f32 v69, v54, v55
    v_exp_f32 v57, v57
    v_exp_f32 v58, v58
    v_cvt_pk_bf16_f32 v70, v56, v57
    v_exp_f32 v59, v59
    v_mfma_f32_32x32x16_bf16 v[36:51], v[16:19], v[8:11], v[108:123]
    s_add_u32 s51, s51, 4096
    buffer_load_dwordx4 a[240:243], v2, s[24:27], s51 offen offset:0 sc1
    v_exp_f32 v60, v60
    v_cvt_pk_bf16_f32 v71, v58, v59
    v_exp_f32 v61, v61
    v_exp_f32 v62, v62
    v_cvt_pk_bf16_f32 v72, v60, v61
    v_exp_f32 v63, v63
    v_mfma_f32_32x32x16_bf16 v[92:107], v[20:23], v[68:71], v[92:107]
    buffer_load_dwordx4 v2, s[24:27], s44 offen offset:2048 sc1 lds
    v_exp_f32 v64, v64
    v_cvt_pk_bf16_f32 v73, v62, v63
    v_exp_f32 v65, v65
    v_exp_f32 v66, v66
    v_cvt_pk_bf16_f32 v74, v64, v65
    v_exp_f32 v67, v67
    v_exp_f32 v36, v36
    v_exp_f32 v37, v37
    v_cvt_pk_bf16_f32 v75, v66, v67
    v_exp_f32 v38, v38
    v_cvt_pk_bf16_f32 v68, v36, v37
    v_exp_f32 v39, v39
    v_mfma_f32_32x32x16_bf16 v[92:107], v[24:27], v[72:75], v[92:107]
    buffer_load_dwordx4 a[244:247], v2, s[24:27], s51 offen offset:1024 sc1
    v_exp_f32 v40, v40
    v_cvt_pk_bf16_f32 v69, v38, v39
    v_exp_f32 v41, v41
    v_exp_f32 v42, v42
    v_cvt_pk_bf16_f32 v70, v40, v41
    v_exp_f32 v43, v43
    v_mfma_f32_32x32x16_bf16 v[52:67], v[16:19], v[12:15], v[124:139]
    ds_read_b128 v[16:19], v4 offset:46784
    ds_read_b128 v[20:23], v5 offset:46784
    ds_read_b128 v[24:27], v157 offset:46784
    v_exp_f32 v44, v44
    v_cvt_pk_bf16_f32 v71, v42, v43
    v_exp_f32 v45, v45
    v_exp_f32 v46, v46
    v_cvt_pk_bf16_f32 v72, v44, v45
    v_exp_f32 v47, v47
    v_mfma_f32_32x32x16_bf16 v[76:91], v[28:31], v[68:71], v[76:91]
    buffer_load_dwordx4 v2, s[24:27], s44 offen offset:3072 sc1 lds
    v_exp_f32 v48, v48
    v_cvt_pk_bf16_f32 v73, v46, v47
    v_exp_f32 v49, v49
    v_exp_f32 v50, v50
    v_cvt_pk_bf16_f32 v74, v48, v49
    v_exp_f32 v51, v51
    v_exp_f32 v52, v52
    v_exp_f32 v53, v53
    v_cvt_pk_bf16_f32 v75, v50, v51
    v_exp_f32 v54, v54
    v_cvt_pk_bf16_f32 v68, v52, v53
    v_exp_f32 v55, v55
    v_mfma_f32_32x32x16_bf16 v[76:91], v[32:35], v[72:75], v[76:91]
    s_waitcnt lgkmcnt(0)
    v_exp_f32 v56, v56
    v_cvt_pk_bf16_f32 v69, v54, v55
    v_exp_f32 v57, v57
    v_exp_f32 v58, v58
    v_cvt_pk_bf16_f32 v70, v56, v57
    v_exp_f32 v59, v59
    v_mfma_f32_32x32x16_bf16 v[36:51], v[16:19], v[8:11], v[108:123]
    buffer_load_dwordx4 a[248:251], v2, s[24:27], s51 offen offset:2048 sc1
    v_exp_f32 v60, v60
    v_cvt_pk_bf16_f32 v71, v58, v59
    v_exp_f32 v61, v61
    v_exp_f32 v62, v62
    v_cvt_pk_bf16_f32 v72, v60, v61
    v_exp_f32 v63, v63
    v_mfma_f32_32x32x16_bf16 v[92:107], v[28:31], v[68:71], v[92:107]
    s_add_u32 m0, s23, 20480
    s_add_u32 s44, s21, 20480
    buffer_load_dwordx4 v2, s[24:27], s44 offen offset:0 sc1 lds
    v_exp_f32 v64, v64
    v_cvt_pk_bf16_f32 v73, v62, v63
    v_exp_f32 v65, v65
    v_exp_f32 v66, v66
    v_cvt_pk_bf16_f32 v74, v64, v65
    v_exp_f32 v67, v67
    v_exp_f32 v36, v36
    v_exp_f32 v37, v37
    v_cvt_pk_bf16_f32 v75, v66, v67
    v_exp_f32 v38, v38
    v_cvt_pk_bf16_f32 v68, v36, v37
    v_exp_f32 v39, v39
    v_mfma_f32_32x32x16_bf16 v[92:107], v[32:35], v[72:75], v[92:107]
    buffer_load_dwordx4 a[252:255], v2, s[24:27], s51 offen offset:3072 sc1
    v_exp_f32 v40, v40
    v_cvt_pk_bf16_f32 v69, v38, v39
    v_exp_f32 v41, v41
    v_exp_f32 v42, v42
    v_cvt_pk_bf16_f32 v70, v40, v41
    v_exp_f32 v43, v43
    v_mfma_f32_32x32x16_bf16 v[52:67], v[16:19], v[12:15], v[124:139]
    ds_read_b128 v[16:19], v4 offset:48864
    ds_read_b128 v[28:31], v5 offset:48864
    ds_read_b128 v[32:35], v157 offset:48864
    v_exp_f32 v44, v44
    v_cvt_pk_bf16_f32 v71, v42, v43
    v_exp_f32 v45, v45
    v_exp_f32 v46, v46
    v_cvt_pk_bf16_f32 v72, v44, v45
    v_exp_f32 v47, v47
    v_mfma_f32_32x32x16_bf16 v[76:91], v[20:23], v[68:71], v[76:91]
    s_add_u32 s51, s51, 4096
    buffer_load_dwordx4 v[160:163], v2, s[24:27], s51 offen offset:0 sc1
    v_exp_f32 v48, v48
    v_cvt_pk_bf16_f32 v73, v46, v47
    v_exp_f32 v49, v49
    v_exp_f32 v50, v50
    v_cvt_pk_bf16_f32 v74, v48, v49
    v_exp_f32 v51, v51
    v_exp_f32 v52, v52
    v_exp_f32 v53, v53
    v_cvt_pk_bf16_f32 v75, v50, v51
    v_exp_f32 v54, v54
    v_cvt_pk_bf16_f32 v68, v52, v53
    v_exp_f32 v55, v55
    v_mfma_f32_32x32x16_bf16 v[76:91], v[24:27], v[72:75], v[76:91]
    s_waitcnt lgkmcnt(0)
    v_exp_f32 v56, v56
    v_cvt_pk_bf16_f32 v69, v54, v55
    v_exp_f32 v57, v57
    v_exp_f32 v58, v58
    v_cvt_pk_bf16_f32 v70, v56, v57
    v_exp_f32 v59, v59
    v_mfma_f32_32x32x16_bf16 v[36:51], v[16:19], v[8:11], v[108:123]
    buffer_load_dwordx4 v[164:167], v2, s[24:27], s51 offen offset:1024 sc1
    v_exp_f32 v60, v60
    v_cvt_pk_bf16_f32 v71, v58, v59
    v_exp_f32 v61, v61
    v_exp_f32 v62, v62
    v_cvt_pk_bf16_f32 v72, v60, v61
    v_exp_f32 v63, v63
    v_mfma_f32_32x32x16_bf16 v[92:107], v[20:23], v[68:71], v[92:107]
    buffer_load_dwordx4 v[168:171], v2, s[24:27], s51 offen offset:2048 sc1
    v_exp_f32 v64, v64
    v_cvt_pk_bf16_f32 v73, v62, v63
    v_exp_f32 v65, v65
    v_exp_f32 v66, v66
    v_cvt_pk_bf16_f32 v74, v64, v65
    v_exp_f32 v67, v67
    v_exp_f32 v36, v36
    v_exp_f32 v37, v37
    v_cvt_pk_bf16_f32 v75, v66, v67
    v_exp_f32 v38, v38
    v_cvt_pk_bf16_f32 v68, v36, v37
    v_exp_f32 v39, v39
    v_mfma_f32_32x32x16_bf16 v[92:107], v[24:27], v[72:75], v[92:107]
    buffer_load_dwordx4 v[172:175], v2, s[24:27], s51 offen offset:3072 sc1
    v_exp_f32 v40, v40
    v_cvt_pk_bf16_f32 v69, v38, v39
    v_exp_f32 v41, v41
    v_exp_f32 v42, v42
    v_cvt_pk_bf16_f32 v70, v40, v41
    v_exp_f32 v43, v43
    v_mfma_f32_32x32x16_bf16 v[52:67], v[16:19], v[12:15], v[124:139]
    ds_read_b128 v[16:19], v4 offset:50944
    ds_read_b128 v[20:23], v5 offset:50944
    ds_read_b128 v[24:27], v157 offset:50944
    v_exp_f32 v44, v44
    v_cvt_pk_bf16_f32 v71, v42, v43
    v_exp_f32 v45, v45
    v_exp_f32 v46, v46
    v_cvt_pk_bf16_f32 v72, v44, v45
    v_exp_f32 v47, v47
    v_mfma_f32_32x32x16_bf16 v[76:91], v[28:31], v[68:71], v[76:91]
    s_add_u32 s51, s51, 4096
    buffer_load_dwordx4 v[176:179], v2, s[24:27], s51 offen offset:0 sc1
    v_exp_f32 v48, v48
    v_cvt_pk_bf16_f32 v73, v46, v47
    v_exp_f32 v49, v49
    v_exp_f32 v50, v50
    v_cvt_pk_bf16_f32 v74, v48, v49
    v_exp_f32 v51, v51
    v_exp_f32 v52, v52
    v_exp_f32 v53, v53
    v_cvt_pk_bf16_f32 v75, v50, v51
    v_exp_f32 v54, v54
    v_cvt_pk_bf16_f32 v68, v52, v53
    v_exp_f32 v55, v55
    v_mfma_f32_32x32x16_bf16 v[76:91], v[32:35], v[72:75], v[76:91]
    s_waitcnt lgkmcnt(0)
    v_exp_f32 v56, v56
    v_cvt_pk_bf16_f32 v69, v54, v55
    v_exp_f32 v57, v57
    v_exp_f32 v58, v58
    v_cvt_pk_bf16_f32 v70, v56, v57
    v_exp_f32 v59, v59
    v_mfma_f32_32x32x16_bf16 v[36:51], v[16:19], v[8:11], v[108:123]
    buffer_load_dwordx4 v[180:183], v2, s[24:27], s51 offen offset:1024 sc1
    v_exp_f32 v60, v60
    v_cvt_pk_bf16_f32 v71, v58, v59
    v_exp_f32 v61, v61
    v_exp_f32 v62, v62
    v_cvt_pk_bf16_f32 v72, v60, v61
    v_exp_f32 v63, v63
    v_mfma_f32_32x32x16_bf16 v[92:107], v[28:31], v[68:71], v[92:107]
    buffer_load_dwordx4 v[184:187], v2, s[24:27], s51 offen offset:2048 sc1
    v_exp_f32 v64, v64
    v_cvt_pk_bf16_f32 v73, v62, v63
    v_exp_f32 v65, v65
    v_exp_f32 v66, v66
    v_cvt_pk_bf16_f32 v74, v64, v65
    v_exp_f32 v67, v67
    v_exp_f32 v36, v36
    v_exp_f32 v37, v37
    v_cvt_pk_bf16_f32 v75, v66, v67
    v_exp_f32 v38, v38
    v_cvt_pk_bf16_f32 v68, v36, v37
    v_exp_f32 v39, v39
    v_mfma_f32_32x32x16_bf16 v[92:107], v[32:35], v[72:75], v[92:107]
    buffer_load_dwordx4 v[188:191], v2, s[24:27], s51 offen offset:3072 sc1
    v_exp_f32 v40, v40
    v_cvt_pk_bf16_f32 v69, v38, v39
    v_exp_f32 v41, v41
    v_exp_f32 v42, v42
    v_cvt_pk_bf16_f32 v70, v40, v41
    v_exp_f32 v43, v43
    v_mfma_f32_32x32x16_bf16 v[52:67], v[16:19], v[12:15], v[124:139]
    ds_read_b128 v[16:19], v4 offset:53024
    ds_read_b128 v[28:31], v5 offset:53024
    ds_read_b128 v[32:35], v157 offset:53024
    v_exp_f32 v44, v44
    v_cvt_pk_bf16_f32 v71, v42, v43
    v_exp_f32 v45, v45
    v_exp_f32 v46, v46
    v_cvt_pk_bf16_f32 v72, v44, v45
    v_exp_f32 v47, v47
    v_mfma_f32_32x32x16_bf16 v[76:91], v[20:23], v[68:71], v[76:91]
    s_mov_b32 s53, 28385280
    buffer_load_dwordx4 v[150:153], v155, s[24:27], s53 offen sc1
    v_exp_f32 v48, v48
    v_cvt_pk_bf16_f32 v73, v46, v47
    v_exp_f32 v49, v49
    v_exp_f32 v50, v50
    v_cvt_pk_bf16_f32 v74, v48, v49
    v_exp_f32 v51, v51
    v_exp_f32 v52, v52
    v_exp_f32 v53, v53
    v_cvt_pk_bf16_f32 v75, v50, v51
    v_exp_f32 v54, v54
    v_cvt_pk_bf16_f32 v68, v52, v53
    v_exp_f32 v55, v55
    v_mfma_f32_32x32x16_bf16 v[76:91], v[24:27], v[72:75], v[76:91]
    s_waitcnt lgkmcnt(0)
    v_exp_f32 v56, v56
    v_cvt_pk_bf16_f32 v69, v54, v55
    v_exp_f32 v57, v57
    v_exp_f32 v58, v58
    v_cvt_pk_bf16_f32 v70, v56, v57
    v_exp_f32 v59, v59
    v_mfma_f32_32x32x16_bf16 v[36:51], v[16:19], v[8:11], v[108:123]
    s_add_u32 s51, s51, 4096
    buffer_load_dwordx4 v[192:195], v2, s[24:27], s51 offen offset:0 sc1
    v_exp_f32 v60, v60
    v_cvt_pk_bf16_f32 v71, v58, v59
    v_exp_f32 v61, v61
    v_exp_f32 v62, v62
    v_cvt_pk_bf16_f32 v72, v60, v61
    v_exp_f32 v63, v63
    v_mfma_f32_32x32x16_bf16 v[92:107], v[20:23], v[68:71], v[92:107]
    buffer_load_dwordx4 v[196:199], v2, s[24:27], s51 offen offset:1024 sc1
    v_exp_f32 v64, v64
    v_cvt_pk_bf16_f32 v73, v62, v63
    v_exp_f32 v65, v65
    v_exp_f32 v66, v66
    v_cvt_pk_bf16_f32 v74, v64, v65
    v_exp_f32 v67, v67
    v_exp_f32 v36, v36
    v_exp_f32 v37, v37
    v_cvt_pk_bf16_f32 v75, v66, v67
    v_exp_f32 v38, v38
    v_cvt_pk_bf16_f32 v68, v36, v37
    v_exp_f32 v39, v39
    v_mfma_f32_32x32x16_bf16 v[92:107], v[24:27], v[72:75], v[92:107]
    buffer_load_dwordx4 v[200:203], v2, s[24:27], s51 offen offset:2048 sc1
    v_exp_f32 v40, v40
    v_cvt_pk_bf16_f32 v69, v38, v39
    v_exp_f32 v41, v41
    v_exp_f32 v42, v42
    v_cvt_pk_bf16_f32 v70, v40, v41
    v_exp_f32 v43, v43
    v_mfma_f32_32x32x16_bf16 v[52:67], v[16:19], v[12:15], v[124:139]
    ds_read_b128 v[16:19], v4 offset:55104
    ds_read_b128 v[20:23], v5 offset:55104
    ds_read_b128 v[24:27], v157 offset:55104
    v_exp_f32 v44, v44
    v_cvt_pk_bf16_f32 v71, v42, v43
    v_exp_f32 v45, v45
    v_exp_f32 v46, v46
    v_cvt_pk_bf16_f32 v72, v44, v45
    v_exp_f32 v47, v47
    v_mfma_f32_32x32x16_bf16 v[76:91], v[28:31], v[68:71], v[76:91]
    buffer_load_dwordx4 v[204:207], v2, s[24:27], s51 offen offset:3072 sc1
    v_exp_f32 v48, v48
    v_cvt_pk_bf16_f32 v73, v46, v47
    v_exp_f32 v49, v49
    v_exp_f32 v50, v50
    v_cvt_pk_bf16_f32 v74, v48, v49
    v_exp_f32 v51, v51
    v_exp_f32 v52, v52
    v_exp_f32 v53, v53
    v_cvt_pk_bf16_f32 v75, v50, v51
    v_exp_f32 v54, v54
    v_cvt_pk_bf16_f32 v68, v52, v53
    v_exp_f32 v55, v55
    v_mfma_f32_32x32x16_bf16 v[76:91], v[32:35], v[72:75], v[76:91]
    s_waitcnt lgkmcnt(0)
    v_exp_f32 v56, v56
    v_cvt_pk_bf16_f32 v69, v54, v55
    v_exp_f32 v57, v57
    v_exp_f32 v58, v58
    v_cvt_pk_bf16_f32 v70, v56, v57
    v_exp_f32 v59, v59
    v_mfma_f32_32x32x16_bf16 v[36:51], v[16:19], v[8:11], v[108:123]
    s_add_u32 s51, s51, 4096
    buffer_load_dwordx4 v[208:211], v2, s[24:27], s51 offen offset:0 sc1
    v_exp_f32 v60, v60
    v_cvt_pk_bf16_f32 v71, v58, v59
    v_exp_f32 v61, v61
    v_exp_f32 v62, v62
    v_cvt_pk_bf16_f32 v72, v60, v61
    v_exp_f32 v63, v63
    v_mfma_f32_32x32x16_bf16 v[92:107], v[28:31], v[68:71], v[92:107]
    buffer_load_dwordx4 v[212:215], v2, s[24:27], s51 offen offset:1024 sc1
    v_exp_f32 v64, v64
    v_cvt_pk_bf16_f32 v73, v62, v63
    v_exp_f32 v65, v65
    v_exp_f32 v66, v66
    v_cvt_pk_bf16_f32 v74, v64, v65
    v_exp_f32 v67, v67
    v_exp_f32 v36, v36
    v_exp_f32 v37, v37
    v_cvt_pk_bf16_f32 v75, v66, v67
    v_exp_f32 v38, v38
    v_cvt_pk_bf16_f32 v68, v36, v37
    v_exp_f32 v39, v39
    v_mfma_f32_32x32x16_bf16 v[92:107], v[32:35], v[72:75], v[92:107]
    buffer_load_dwordx4 v[216:219], v2, s[24:27], s51 offen offset:2048 sc1
    v_exp_f32 v40, v40
    v_cvt_pk_bf16_f32 v69, v38, v39
    v_exp_f32 v41, v41
    v_exp_f32 v42, v42
    v_cvt_pk_bf16_f32 v70, v40, v41
    v_exp_f32 v43, v43
    v_mfma_f32_32x32x16_bf16 v[52:67], v[16:19], v[12:15], v[124:139]
    ds_read_b128 v[16:19], v4 offset:57184
    ds_read_b128 v[28:31], v5 offset:57184
    ds_read_b128 v[32:35], v157 offset:57184
    v_exp_f32 v44, v44
    v_cvt_pk_bf16_f32 v71, v42, v43
    v_exp_f32 v45, v45
    v_exp_f32 v46, v46
    v_cvt_pk_bf16_f32 v72, v44, v45
    v_exp_f32 v47, v47
    v_mfma_f32_32x32x16_bf16 v[76:91], v[20:23], v[68:71], v[76:91]
    buffer_load_dwordx4 v[220:223], v2, s[24:27], s51 offen offset:3072 sc1
    v_exp_f32 v48, v48
    v_cvt_pk_bf16_f32 v73, v46, v47
    v_exp_f32 v49, v49
    v_exp_f32 v50, v50
    v_cvt_pk_bf16_f32 v74, v48, v49
    v_exp_f32 v51, v51
    v_exp_f32 v52, v52
    v_exp_f32 v53, v53
    v_cvt_pk_bf16_f32 v75, v50, v51
    v_exp_f32 v54, v54
    v_cvt_pk_bf16_f32 v68, v52, v53
    v_exp_f32 v55, v55
    v_mfma_f32_32x32x16_bf16 v[76:91], v[24:27], v[72:75], v[76:91]
    s_waitcnt lgkmcnt(0)
    v_exp_f32 v56, v56
    v_cvt_pk_bf16_f32 v69, v54, v55
    v_exp_f32 v57, v57
    v_exp_f32 v58, v58
    v_cvt_pk_bf16_f32 v70, v56, v57
    v_exp_f32 v59, v59
    v_mfma_f32_32x32x16_bf16 v[36:51], v[16:19], v[8:11], v[108:123]
    s_add_u32 s51, s51, 4096
    buffer_load_dwordx4 v[224:227], v2, s[24:27], s51 offen offset:0 sc1
    v_exp_f32 v60, v60
    v_cvt_pk_bf16_f32 v71, v58, v59
    v_exp_f32 v61, v61
    v_exp_f32 v62, v62
    v_cvt_pk_bf16_f32 v72, v60, v61
    v_exp_f32 v63, v63
    v_mfma_f32_32x32x16_bf16 v[92:107], v[20:23], v[68:71], v[92:107]
    buffer_load_dwordx4 v[228:231], v2, s[24:27], s51 offen offset:1024 sc1
    v_exp_f32 v64, v64
    v_cvt_pk_bf16_f32 v73, v62, v63
    v_exp_f32 v65, v65
    v_exp_f32 v66, v66
    v_cvt_pk_bf16_f32 v74, v64, v65
    v_exp_f32 v67, v67
    v_exp_f32 v36, v36
    v_exp_f32 v37, v37
    v_cvt_pk_bf16_f32 v75, v66, v67
    v_exp_f32 v38, v38
    v_cvt_pk_bf16_f32 v68, v36, v37
    v_exp_f32 v39, v39
    v_mfma_f32_32x32x16_bf16 v[92:107], v[24:27], v[72:75], v[92:107]
    buffer_load_dwordx4 v[232:235], v2, s[24:27], s51 offen offset:2048 sc1
    v_exp_f32 v40, v40
    v_cvt_pk_bf16_f32 v69, v38, v39
    v_exp_f32 v41, v41
    v_exp_f32 v42, v42
    v_cvt_pk_bf16_f32 v70, v40, v41
    v_exp_f32 v43, v43
    v_mfma_f32_32x32x16_bf16 v[52:67], v[16:19], v[12:15], v[124:139]
    ds_read_b128 v[16:19], v4 offset:59264
    ds_read_b128 v[20:23], v5 offset:59264
    ds_read_b128 v[24:27], v157 offset:59264
    v_exp_f32 v44, v44
    v_cvt_pk_bf16_f32 v71, v42, v43
    v_exp_f32 v45, v45
    s_waitcnt vmcnt(11)
    v_xor_b32 v150, s98, v150
    v_xor_b32 v151, s98, v151
    v_xor_b32 v152, s98, v152
    v_xor_b32 v153, s98, v153
    v_or3_b32 v154, v150, v151, v152
    v_or_b32 v154, v154, v153
    v_cmp_lt_u32 vcc, 15, v154
    v_exp_f32 v46, v46
    v_cvt_pk_bf16_f32 v72, v44, v45
    v_exp_f32 v47, v47
    v_mfma_f32_32x32x16_bf16 v[76:91], v[28:31], v[68:71], v[76:91]
    v_exp_f32 v48, v48
    v_cvt_pk_bf16_f32 v73, v46, v47
    v_exp_f32 v49, v49
    s_cbranch_vccnz L_mid_retry
L_mid_ok:
    v_exp_f32 v50, v50
    v_cvt_pk_bf16_f32 v74, v48, v49
    v_exp_f32 v51, v51
    v_exp_f32 v52, v52
    v_exp_f32 v53, v53
    v_cvt_pk_bf16_f32 v75, v50, v51
    v_exp_f32 v54, v54
    v_cvt_pk_bf16_f32 v68, v52, v53
    v_exp_f32 v55, v55
    v_mfma_f32_32x32x16_bf16 v[76:91], v[32:35], v[72:75], v[76:91]
    s_waitcnt lgkmcnt(0)
    v_exp_f32 v56, v56
    v_cvt_pk_bf16_f32 v69, v54, v55
    v_exp_f32 v57, v57
    v_exp_f32 v58, v58
    v_cvt_pk_bf16_f32 v70, v56, v57
    v_exp_f32 v59, v59
    v_mfma_f32_32x32x16_bf16 v[36:51], v[16:19], v[8:11], v[108:123]
    s_and_b32 s53, s45, 1024
    s_add_u32 m0, s53, 86016
    s_add_u32 s53, s53, 12288
    buffer_load_dwordx4 v2, s[24:27], s53 offen sc1 lds
    v_exp_f32 v60, v60
    v_cvt_pk_bf16_f32 v71, v58, v59
    v_exp_f32 v61, v61
    v_exp_f32 v62, v62
    v_cvt_pk_bf16_f32 v72, v60, v61
    v_exp_f32 v63, v63
    v_mfma_f32_32x32x16_bf16 v[92:107], v[28:31], v[68:71], v[92:107]
    buffer_load_dwordx4 v[236:239], v2, s[24:27], s51 offen offset:3072 sc1
    v_exp_f32 v64, v64
    v_cvt_pk_bf16_f32 v73, v62, v63
    v_exp_f32 v65, v65
    v_exp_f32 v66, v66
    v_cvt_pk_bf16_f32 v74, v64, v65
    v_exp_f32 v67, v67
    v_exp_f32 v36, v36
    v_exp_f32 v37, v37
    v_cvt_pk_bf16_f32 v75, v66, v67
    v_exp_f32 v38, v38
    v_cvt_pk_bf16_f32 v68, v36, v37
    v_exp_f32 v39, v39
    v_mfma_f32_32x32x16_bf16 v[92:107], v[32:35], v[72:75], v[92:107]
    s_mov_b32 m0, 88064
    s_lshr_b32 s53, s37, 3
    s_lshl_b32 s53, s53, 9
    s_add_u32 s53, s53, 4096
    buffer_load_dwordx4 v149, s[24:27], s53 offen sc1 lds
    v_exp_f32 v40, v40
    v_cvt_pk_bf16_f32 v69, v38, v39
    v_exp_f32 v41, v41
    v_exp_f32 v42, v42
    v_cvt_pk_bf16_f32 v70, v40, v41
    v_exp_f32 v43, v43
    v_mfma_f32_32x32x16_bf16 v[52:67], v[16:19], v[12:15], v[124:139]
    ds_read_b128 v[16:19], v4 offset:61344
    ds_read_b128 v[28:31], v5 offset:61344
    ds_read_b128 v[32:35], v157 offset:61344
    v_exp_f32 v44, v44
    v_cvt_pk_bf16_f32 v71, v42, v43
    v_exp_f32 v45, v45
    v_exp_f32 v46, v46
    v_cvt_pk_bf16_f32 v72, v44, v45
    v_exp_f32 v47, v47
    v_mfma_f32_32x32x16_bf16 v[76:91], v[20:23], v[68:71], v[76:91]
    s_add_u32 s51, s51, 4096
    buffer_load_dwordx4 v[240:243], v2, s[24:27], s51 offen offset:0 sc1
    v_exp_f32 v48, v48
    v_cvt_pk_bf16_f32 v73, v46, v47
    v_exp_f32 v49, v49
    v_exp_f32 v50, v50
    v_cvt_pk_bf16_f32 v74, v48, v49
    v_exp_f32 v51, v51
    v_exp_f32 v52, v52
    v_exp_f32 v53, v53
    v_cvt_pk_bf16_f32 v75, v50, v51
    v_exp_f32 v54, v54
    v_cvt_pk_bf16_f32 v68, v52, v53
    v_exp_f32 v55, v55
    v_mfma_f32_32x32x16_bf16 v[76:91], v[24:27], v[72:75], v[76:91]
    s_waitcnt lgkmcnt(0)
    v_exp_f32 v56, v56
    v_cvt_pk_bf16_f32 v69, v54, v55
    v_exp_f32 v57, v57
    v_exp_f32 v58, v58
    v_cvt_pk_bf16_f32 v70, v56, v57
    v_exp_f32 v59, v59
    v_mfma_f32_32x32x16_bf16 v[36:51], v[16:19], v[8:11], v[108:123]
    s_mov_b32 m0, 89088
    s_lshr_b32 s53, s37, 4
    s_lshl_b32 s53, s53, 10
    s_add_u32 s53, s53, 10240
    buffer_load_dwordx4 v2, s[24:27], s53 offen sc1 lds
    v_exp_f32 v60, v60
    v_cvt_pk_bf16_f32 v71, v58, v59
    v_exp_f32 v61, v61
    v_exp_f32 v62, v62
    v_cvt_pk_bf16_f32 v72, v60, v61
    v_exp_f32 v63, v63
    v_mfma_f32_32x32x16_bf16 v[92:107], v[20:23], v[68:71], v[92:107]
    buffer_load_dwordx4 v[244:247], v2, s[24:27], s51 offen offset:1024 sc1
    v_exp_f32 v64, v64
    v_cvt_pk_bf16_f32 v73, v62, v63
    v_exp_f32 v65, v65
    v_exp_f32 v66, v66
    v_cvt_pk_bf16_f32 v74, v64, v65
    v_exp_f32 v67, v67
    v_exp_f32 v36, v36
    v_exp_f32 v37, v37
    v_cvt_pk_bf16_f32 v75, v66, v67
    v_exp_f32 v38, v38
    v_cvt_pk_bf16_f32 v68, v36, v37
    v_exp_f32 v39, v39
    v_mfma_f32_32x32x16_bf16 v[92:107], v[24:27], v[72:75], v[92:107]
    buffer_load_dwordx4 v[248:251], v2, s[24:27], s51 offen offset:2048 sc1
    v_exp_f32 v40, v40
    v_cvt_pk_bf16_f32 v69, v38, v39
    v_exp_f32 v41, v41
    v_exp_f32 v42, v42
    v_cvt_pk_bf16_f32 v70, v40, v41
    v_exp_f32 v43, v43
    v_mfma_f32_32x32x16_bf16 v[52:67], v[16:19], v[12:15], v[124:139]
    ds_read_b128 v[16:19], v4 offset:63424
    ds_read_b128 v[20:23], v5 offset:63424
    ds_read_b128 v[24:27], v157 offset:63424
    v_exp_f32 v44, v44
    v_cvt_pk_bf16_f32 v71, v42, v43
    v_exp_f32 v45, v45
    v_exp_f32 v46, v46
    v_cvt_pk_bf16_f32 v72, v44, v45
    v_exp_f32 v47, v47
    v_mfma_f32_32x32x16_bf16 v[76:91], v[28:31], v[68:71], v[76:91]
    buffer_load_dwordx4 v[252:255], v2, s[24:27], s51 offen offset:3072 sc1
    v_exp_f32 v48, v48
    v_cvt_pk_bf16_f32 v73, v46, v47
    v_exp_f32 v49, v49
    v_exp_f32 v50, v50
    v_cvt_pk_bf16_f32 v74, v48, v49
    v_exp_f32 v51, v51
    v_exp_f32 v52, v52
    v_exp_f32 v53, v53
    v_cvt_pk_bf16_f32 v75, v50, v51
    v_exp_f32 v54, v54
    v_cvt_pk_bf16_f32 v68, v52, v53
    v_exp_f32 v55, v55
    v_mfma_f32_32x32x16_bf16 v[76:91], v[32:35], v[72:75], v[76:91]
    s_waitcnt lgkmcnt(0)
    v_exp_f32 v56, v56
    v_cvt_pk_bf16_f32 v69, v54, v55
    v_exp_f32 v57, v57
    v_exp_f32 v58, v58
    v_cvt_pk_bf16_f32 v70, v56, v57
    v_exp_f32 v59, v59
    v_mfma_f32_32x32x16_bf16 v[36:51], v[16:19], v[8:11], v[108:123]
    v_exp_f32 v60, v60
    v_cvt_pk_bf16_f32 v71, v58, v59
    v_exp_f32 v61, v61
    v_exp_f32 v62, v62
    v_cvt_pk_bf16_f32 v72, v60, v61
    v_exp_f32 v63, v63
    v_mfma_f32_32x32x16_bf16 v[92:107], v[28:31], v[68:71], v[92:107]
    v_exp_f32 v64, v64
    v_cvt_pk_bf16_f32 v73, v62, v63
    v_exp_f32 v65, v65
    v_exp_f32 v66, v66
    v_cvt_pk_bf16_f32 v74, v64, v65
    v_exp_f32 v67, v67
    v_exp_f32 v36, v36
    v_exp_f32 v37, v37
    v_cvt_pk_bf16_f32 v75, v66, v67
    v_exp_f32 v38, v38
    v_cvt_pk_bf16_f32 v68, v36, v37
    v_exp_f32 v39, v39
    v_mfma_f32_32x32x16_bf16 v[92:107], v[32:35], v[72:75], v[92:107]
    v_exp_f32 v40, v40
    v_cvt_pk_bf16_f32 v69, v38, v39
    v_exp_f32 v41, v41
    v_exp_f32 v42, v42
    v_cvt_pk_bf16_f32 v70, v40, v41
    v_exp_f32 v43, v43
    v_mfma_f32_32x32x16_bf16 v[52:67], v[16:19], v[12:15], v[124:139]
    ds_read_b128 v[16:19], v4 offset:65504
    ds_read_b128 v[28:31], v5 offset:65504
    ds_read_b128 v[32:35], v157 offset:65504
    v_exp_f32 v44, v44
    v_cvt_pk_bf16_f32 v71, v42, v43
    v_exp_f32 v45, v45
    v_exp_f32 v46, v46
    v_cvt_pk_bf16_f32 v72, v44, v45
    v_exp_f32 v47, v47
    v_mfma_f32_32x32x16_bf16 v[76:91], v[20:23], v[68:71], v[76:91]
    v_exp_f32 v48, v48
    v_cvt_pk_bf16_f32 v73, v46, v47
    v_exp_f32 v49, v49
    v_exp_f32 v50, v50
    v_cvt_pk_bf16_f32 v74, v48, v49
    v_exp_f32 v51, v51
    v_exp_f32 v52, v52
    v_exp_f32 v53, v53
    v_cvt_pk_bf16_f32 v75, v50, v51
    v_exp_f32 v54, v54
    v_cvt_pk_bf16_f32 v68, v52, v53
    v_exp_f32 v55, v55
    v_mfma_f32_32x32x16_bf16 v[76:91], v[24:27], v[72:75], v[76:91]
    s_waitcnt lgkmcnt(0)
    v_exp_f32 v56, v56
    v_cvt_pk_bf16_f32 v69, v54, v55
    v_exp_f32 v57, v57
    v_exp_f32 v58, v58
    v_cvt_pk_bf16_f32 v70, v56, v57
    v_exp_f32 v59, v59
    v_mfma_f32_32x32x16_bf16 v[36:51], v[16:19], v[8:11], v[108:123]
    v_exp_f32 v60, v60
    v_cvt_pk_bf16_f32 v71, v58, v59
    v_exp_f32 v61, v61
    v_exp_f32 v62, v62
    v_cvt_pk_bf16_f32 v72, v60, v61
    v_exp_f32 v63, v63
    v_mfma_f32_32x32x16_bf16 v[92:107], v[20:23], v[68:71], v[92:107]
    v_exp_f32 v64, v64
    v_cvt_pk_bf16_f32 v73, v62, v63
    v_exp_f32 v65, v65
    v_exp_f32 v66, v66
    v_cvt_pk_bf16_f32 v74, v64, v65
    v_exp_f32 v67, v67
    v_exp_f32 v36, v36
    v_exp_f32 v37, v37
    v_cvt_pk_bf16_f32 v75, v66, v67
    v_exp_f32 v38, v38
    v_cvt_pk_bf16_f32 v68, v36, v37
    v_exp_f32 v39, v39
    v_mfma_f32_32x32x16_bf16 v[92:107], v[24:27], v[72:75], v[92:107]
    v_exp_f32 v40, v40
    v_cvt_pk_bf16_f32 v69, v38, v39
    v_exp_f32 v41, v41
    v_exp_f32 v42, v42
    v_cvt_pk_bf16_f32 v70, v40, v41
    v_exp_f32 v43, v43
    v_mfma_f32_32x32x16_bf16 v[52:67], v[16:19], v[12:15], v[124:139]
    v_exp_f32 v44, v44
    v_cvt_pk_bf16_f32 v71, v42, v43
    v_exp_f32 v45, v45
    v_exp_f32 v46, v46
    v_cvt_pk_bf16_f32 v72, v44, v45
    v_exp_f32 v47, v47
    v_mfma_f32_32x32x16_bf16 v[76:91], v[28:31], v[68:71], v[76:91]
    v_exp_f32 v48, v48
    v_cvt_pk_bf16_f32 v73, v46, v47
    v_exp_f32 v49, v49
    v_exp_f32 v50, v50
    v_cvt_pk_bf16_f32 v74, v48, v49
    v_exp_f32 v51, v51
    v_exp_f32 v52, v52
    v_exp_f32 v53, v53
    v_cvt_pk_bf16_f32 v75, v50, v51
    v_exp_f32 v54, v54
    v_cvt_pk_bf16_f32 v68, v52, v53
    v_exp_f32 v55, v55
    v_mfma_f32_32x32x16_bf16 v[76:91], v[32:35], v[72:75], v[76:91]
    s_waitcnt lgkmcnt(0)
    v_exp_f32 v56, v56
    v_cvt_pk_bf16_f32 v69, v54, v55
    v_exp_f32 v57, v57
    v_exp_f32 v58, v58
    v_cvt_pk_bf16_f32 v70, v56, v57
    v_exp_f32 v59, v59
    v_exp_f32 v60, v60
    v_cvt_pk_bf16_f32 v71, v58, v59
    v_exp_f32 v61, v61
    v_exp_f32 v62, v62
    v_cvt_pk_bf16_f32 v72, v60, v61
    v_exp_f32 v63, v63
    v_mfma_f32_32x32x16_bf16 v[92:107], v[28:31], v[68:71], v[92:107]
    v_exp_f32 v64, v64
    v_cvt_pk_bf16_f32 v73, v62, v63
    v_exp_f32 v65, v65
    v_exp_f32 v66, v66
    v_cvt_pk_bf16_f32 v74, v64, v65
    v_exp_f32 v67, v67
    s_nop 0
    v_cvt_pk_bf16_f32 v75, v66, v67
    s_nop 1
    v_mfma_f32_32x32x16_bf16 v[92:107], v[32:35], v[72:75], v[92:107]
    s_mov_b32 s53, 0x53800000
    v_cmp_nge_f32 vcc, s53, v84
    s_nop 9
    v_cmp_nge_f32 s[42:43], s53, v100
    s_nop 3
    s_or_b64 vcc, vcc, s[42:43]
    s_cbranch_scc0 L_att_fin
    s_branch L_att_fallback
L_att_fin:
    v_rcp_f32 v6, v84
    v_rcp_f32 v7, v100
    s_lshl_b32 s42, s36, 3
    s_and_b32 s43, s37, 7
    s_add_u32 s42, s42, s43
    v_lshrrev_b32 v8, 5, v1
    v_and_b32 v9, 31, v1
    v_mul_f32 v76, v6, v76
    v_mul_f32 v77, v6, v77
    v_mul_f32 v78, v6, v78
    v_mul_f32 v79, v6, v79
    v_mul_f32 v80, v6, v80
    v_mul_f32 v81, v6, v81
    v_mul_f32 v82, v6, v82
    v_mul_f32 v83, v6, v83
    v_cvt_pk_bf16_f32 v68, v76, v77
    v_cvt_pk_bf16_f32 v69, v78, v79
    v_cvt_pk_bf16_f32 v70, v80, v81
    v_cvt_pk_bf16_f32 v71, v82, v83
    buffer_store_dwordx4 v[68:71], v2, s[24:27], s46 offen sc1
    v_mul_f32 v92, v7, v92
    v_mul_f32 v93, v7, v93
    v_mul_f32 v94, v7, v94
    v_mul_f32 v95, v7, v95
    v_mul_f32 v96, v7, v96
    v_mul_f32 v97, v7, v97
    v_mul_f32 v98, v7, v98
    v_mul_f32 v99, v7, v99
    v_cvt_pk_bf16_f32 v72, v92, v93
    v_cvt_pk_bf16_f32 v73, v94, v95
    v_cvt_pk_bf16_f32 v74, v96, v97
    v_cvt_pk_bf16_f32 v75, v98, v99
    s_add_u32 s46, s46, 32768
    buffer_store_dwordx4 v[72:75], v2, s[24:27], s46 offen sc1
    v_add_u32 v5, 0x20000, v2
    v_lshrrev_b32 v12, 4, v9
    v_lshlrev_b32 v12, 14, v12
    v_and_b32 v13, 15, v9
    v_lshl_add_u32 v12, v13, 4, v12
    v_lshl_add_u32 v12, v8, 8, v12
    v_lshlrev_b32 v13, 3, v9
    s_lshl_b32 s43, s3, 10
    s_lshl_b32 s44, s42, 15
    s_lshl_b32 s45, s50, 10
    s_add_u32 s44, s44, s45
    s_add_u32 s45, s44, 14745600
    s_add_u32 s44, s44, 12648448
    s_lshl_b32 s46, s42, 12
    s_lshl_b32 s47, s50, 8
    s_add_u32 s46, s46, s47
    s_add_u32 s46, s46, 16842752
    s_lshl_b32 s47, s42, 15
    s_add_u32 s47, s47, s43
    s_add_u32 s47, s47, 10027008
    s_add_u32 m0, s43, 90112
    v_lshl_or_b32 v150, v151, 4, v150
    v_lshl_or_b32 v152, v153, 4, v152
    v_lshl_or_b32 v150, v152, 8, v150
    v_and_b32 v151, 1, v1
    v_readlane_b32 s38, v150, 0
    v_readlane_b32 s39, v150, 1
    v_cmp_eq_u32 vcc, 1, v151
    v_mov_b32 v152, s38
    v_mov_b32 v153, s39
    v_cndmask_b32 v152, v152, v153, vcc
    v_cmp_ne_u32 vcc, v152, v150
    s_nop 3
    s_cmp_eq_u64 vcc, 0
    s_cselect_b32 s93, 1, 0
    s_mul_i32 s38, s54, 32
    s_add_u32 s38, s38, s40
    s_lshl_b32 s38, s38, 8
    s_add_u32 s38, s38, 28180480
    v_mov_b32 v6, 0
    v_mov_b32 v7, s98
    s_cmp_lg_u32 s3, 0
    s_waitcnt vmcnt(0) lgkmcnt(0)
    s_barrier
    s_cbranch_scc1 L_sig1_s
    s_mov_b64 exec, 1
    buffer_store_dword v7, v6, s[24:27], s38 offen sc1
    s_mov_b64 exec, -1
L_sig1_s:
    s_lshl_b32 s38, s3, 7
    s_add_u32 s38, s38, 88064
    v_lshlrev_b32 v10, 4, v8
    v_add_u32 v10, s38, v10
    ds_read_b128 v[108:111], v10 offset:0
    ds_read_b128 v[124:127], v10 offset:512
    ds_read_b128 v[112:115], v10 offset:32
    ds_read_b128 v[128:131], v10 offset:544
    ds_read_b128 v[116:119], v10 offset:64
    ds_read_b128 v[132:135], v10 offset:576
    ds_read_b128 v[120:123], v10 offset:96
    ds_read_b128 v[136:139], v10 offset:608
    v_lshlrev_b32 v44, 16, v140
    v_and_b32 v45, 0xffff0000, v140
    v_lshlrev_b32 v46, 16, v141
    v_and_b32 v47, 0xffff0000, v141
    v_lshlrev_b32 v48, 16, v142
    v_and_b32 v49, 0xffff0000, v142
    v_lshlrev_b32 v50, 16, v143
    v_and_b32 v51, 0xffff0000, v143
    v_lshlrev_b32 v52, 16, v144
    v_and_b32 v53, 0xffff0000, v144
    v_lshlrev_b32 v54, 16, v145
    v_and_b32 v55, 0xffff0000, v145
    v_lshlrev_b32 v56, 16, v146
    v_and_b32 v57, 0xffff0000, v146
    v_lshlrev_b32 v58, 16, v147
    v_and_b32 v59, 0xffff0000, v147
    v_add_u32 v14, s43, v2
    v_add_u32 v15, s43, v4
    v_add_u32 v16, s43, v5
    v_and_b32 v17, 15, v1
    v_lshrrev_b32 v18, 4, v1
    v_lshlrev_b32 v17, 10, v17
    v_lshl_add_u32 v17, v18, 4, v17
    v_add_u32 v17, 86016, v17
    s_mov_b32 s48, 0x00030003
    s_mov_b32 s49, 0x00030003
    v_mov_b32 v60, 0
    v_mov_b32 v61, 0
    v_mov_b32 v62, 0
    v_mov_b32 v63, 0
    v_mov_b32 v64, 0
    v_mov_b32 v65, 0
    v_mov_b32 v66, 0
    v_mov_b32 v67, 0
    v_mov_b32 v68, 0
    v_mov_b32 v69, 0
    v_mov_b32 v70, 0
    v_mov_b32 v71, 0
    v_mov_b32 v72, 0
    v_mov_b32 v73, 0
    v_mov_b32 v74, 0
    v_mov_b32 v75, 0
    v_mov_b32 v76, 0
    v_mov_b32 v77, 0
    v_mov_b32 v78, 0
    v_mov_b32 v79, 0
    v_mov_b32 v80, 0
    v_mov_b32 v81, 0
    v_mov_b32 v82, 0
    v_mov_b32 v83, 0
    v_mov_b32 v84, 0
    v_mov_b32 v85, 0
    v_mov_b32 v86, 0
    v_mov_b32 v87, 0
    v_mov_b32 v88, 0
    v_mov_b32 v89, 0
    v_mov_b32 v90, 0
    v_mov_b32 v91, 0
    s_mov_b64 exec, s[48:49]
    ds_read_b128 v[60:63], v17 offset:0
    ds_read_b128 v[64:67], v17 offset:64
    ds_read_b128 v[68:71], v17 offset:128
    ds_read_b128 v[72:75], v17 offset:192
    ds_read_b128 v[76:79], v17 offset:256
    ds_read_b128 v[80:83], v17 offset:320
    ds_read_b128 v[84:87], v17 offset:384
    ds_read_b128 v[88:91], v17 offset:448
    s_mov_b64 exec, -1
    ds_read_b128 v[92:95], v16 offset:2048
    ds_read_b128 v[96:99], v16 offset:6144
    ds_read_b128 v[100:103], v16 offset:9216
    ds_read_b128 v[104:107], v16 offset:13312
    s_waitcnt lgkmcnt(2)
    v_mfma_f32_16x16x32_bf16 v[36:39], v[60:63], v[92:95], 0
    v_mfma_f32_16x16x32_bf16 v[40:43], v[60:63], v[96:99], 0
    ds_read_b128 v[92:95], v16 offset:16384
    ds_read_b128 v[96:99], v16 offset:20480
    s_waitcnt lgkmcnt(2)
    v_mfma_f32_16x16x32_bf16 v[36:39], v[64:67], v[100:103], v[36:39]
    v_mfma_f32_16x16x32_bf16 v[40:43], v[64:67], v[104:107], v[40:43]
    ds_read_b128 v[100:103], v16 offset:23552
    ds_read_b128 v[104:107], v16 offset:27648
    s_waitcnt lgkmcnt(2)
    v_mfma_f32_16x16x32_bf16 v[36:39], v[68:71], v[92:95], v[36:39]
    v_mfma_f32_16x16x32_bf16 v[40:43], v[68:71], v[96:99], v[40:43]
    ds_read_b128 v[92:95], v14 offset:0
    ds_read_b128 v[96:99], v14 offset:4096
    s_waitcnt lgkmcnt(2)
    v_mfma_f32_16x16x32_bf16 v[36:39], v[72:75], v[100:103], v[36:39]
    v_mfma_f32_16x16x32_bf16 v[40:43], v[72:75], v[104:107], v[40:43]
    ds_read_b128 v[100:103], v14 offset:7168
    ds_read_b128 v[104:107], v14 offset:11264
    s_waitcnt lgkmcnt(2)
    v_mfma_f32_16x16x32_bf16 v[36:39], v[76:79], v[92:95], v[36:39]
    v_mfma_f32_16x16x32_bf16 v[40:43], v[76:79], v[96:99], v[40:43]
    ds_read_b128 v[92:95], v14 offset:14336
    ds_read_b128 v[96:99], v14 offset:18432
    s_waitcnt lgkmcnt(2)
    v_mfma_f32_16x16x32_bf16 v[36:39], v[80:83], v[100:103], v[36:39]
    v_mfma_f32_16x16x32_bf16 v[40:43], v[80:83], v[104:107], v[40:43]
    ds_read_b128 v[100:103], v14 offset:21504
    ds_read_b128 v[104:107], v14 offset:25600
    s_waitcnt lgkmcnt(2)
    v_mfma_f32_16x16x32_bf16 v[36:39], v[84:87], v[92:95], v[36:39]
    v_mfma_f32_16x16x32_bf16 v[40:43], v[84:87], v[96:99], v[40:43]
    ds_read_b128 v[92:95], v14 offset:28672
    ds_read_b128 v[96:99], v14 offset:32768
    s_waitcnt lgkmcnt(2)
    v_mfma_f32_16x16x32_bf16 v[36:39], v[88:91], v[100:103], v[36:39]
    v_mfma_f32_16x16x32_bf16 v[40:43], v[88:91], v[104:107], v[40:43]
    s_mov_b64 exec, s[48:49]
    ds_read_b128 v[60:63], v17 offset:512
    ds_read_b128 v[64:67], v17 offset:576
    ds_read_b128 v[68:71], v17 offset:640
    ds_read_b128 v[72:75], v17 offset:704
    ds_read_b128 v[76:79], v17 offset:768
    ds_read_b128 v[80:83], v17 offset:832
    ds_read_b128 v[84:87], v17 offset:896
    ds_read_b128 v[88:91], v17 offset:960
    s_mov_b64 exec, -1
    s_cmp_lg_u32 s3, 0
    s_cbranch_scc1 L_wait1
    s_mul_i32 s38, s36, 8192
    s_add_u32 s38, s38, 28180480
    v_lshlrev_b32 v6, 8, v1
    s_mov_b32 exec_lo, 0xffffffff
    s_mov_b32 exec_hi, 0
    s_mov_b32 s39, 0x40000
L_poll1:
    buffer_load_dword v7, v6, s[24:27], s38 offen sc1
    s_sub_u32 s39, s39, 1
    s_cbranch_scc1 L_bail1
    s_waitcnt vmcnt(0)
    v_cmp_ne_u32 vcc, s98, v7
    s_cbranch_vccnz L_poll1
L_bail1:
    s_waitcnt vmcnt(0)
    s_mov_b64 exec, -1
L_wait1:
    s_barrier
    buffer_load_dwordx4 v2, s[24:27], s47 offen sc1 lds
    s_add_u32 m0, m0, 4096
    s_add_u32 s47, s47, 4096
    buffer_load_dwordx4 v2, s[24:27], s47 offen sc1 lds
    s_add_u32 m0, m0, 4096
    s_add_u32 s47, s47, 4096
    buffer_load_dwordx4 v2, s[24:27], s47 offen sc1 lds
    s_add_u32 m0, m0, 4096
    s_add_u32 s47, s47, 4096
    buffer_load_dwordx4 v2, s[24:27], s47 offen sc1 lds
    s_add_u32 m0, m0, 4096
    s_add_u32 s47, s47, 4096
    buffer_load_dwordx4 v2, s[24:27], s47 offen sc1 lds
    s_add_u32 m0, m0, 4096
    s_add_u32 s47, s47, 4096
    buffer_load_dwordx4 v2, s[24:27], s47 offen sc1 lds
    s_add_u32 m0, m0, 4096
    s_add_u32 s47, s47, 4096
    buffer_load_dwordx4 v2, s[24:27], s47 offen sc1 lds
    s_add_u32 m0, m0, 4096
    s_add_u32 s47, s47, 4096
    buffer_load_dwordx4 v2, s[24:27], s47 offen sc1 lds
    ds_read_b128 v[100:103], v14 offset:35840
    ds_read_b128 v[104:107], v14 offset:39936
    s_waitcnt lgkmcnt(2)
    v_mfma_f32_16x16x32_bf16 v[36:39], v[60:63], v[92:95], v[36:39]
    v_mfma_f32_16x16x32_bf16 v[40:43], v[60:63], v[96:99], v[40:43]
    ds_read_b128 v[92:95], v14 offset:43008
    ds_read_b128 v[96:99], v14 offset:47104
    s_waitcnt lgkmcnt(2)
    v_mfma_f32_16x16x32_bf16 v[36:39], v[64:67], v[100:103], v[36:39]
    v_mfma_f32_16x16x32_bf16 v[40:43], v[64:67], v[104:107], v[40:43]
    ds_read_b128 v[100:103], v14 offset:50176
    ds_read_b128 v[104:107], v14 offset:54272
    s_waitcnt lgkmcnt(2)
    v_mfma_f32_16x16x32_bf16 v[36:39], v[68:71], v[92:95], v[36:39]
    v_mfma_f32_16x16x32_bf16 v[40:43], v[68:71], v[96:99], v[40:43]
    ds_read_b128 v[92:95], v14 offset:57344
    ds_read_b128 v[96:99], v14 offset:61440
    s_waitcnt lgkmcnt(2)
    v_mfma_f32_16x16x32_bf16 v[36:39], v[72:75], v[100:103], v[36:39]
    v_mfma_f32_16x16x32_bf16 v[40:43], v[72:75], v[104:107], v[40:43]
    ds_read_b128 v[100:103], v14 offset:64512
    ds_read_b128 v[104:107], v15 offset:3072
    s_waitcnt lgkmcnt(2)
    v_mfma_f32_16x16x32_bf16 v[36:39], v[76:79], v[92:95], v[36:39]
    v_mfma_f32_16x16x32_bf16 v[40:43], v[76:79], v[96:99], v[40:43]
    ds_read_b128 v[92:95], v15 offset:6144
    ds_read_b128 v[96:99], v15 offset:10240
    s_waitcnt lgkmcnt(2)
    v_mfma_f32_16x16x32_bf16 v[36:39], v[80:83], v[100:103], v[36:39]
    v_mfma_f32_16x16x32_bf16 v[40:43], v[80:83], v[104:107], v[40:43]
    ds_read_b128 v[100:103], v15 offset:13312
    ds_read_b128 v[104:107], v15 offset:17408
    s_waitcnt lgkmcnt(2)
    v_mfma_f32_16x16x32_bf16 v[36:39], v[84:87], v[92:95], v[36:39]
    v_mfma_f32_16x16x32_bf16 v[40:43], v[84:87], v[96:99], v[40:43]
    s_waitcnt lgkmcnt(0)
    v_mfma_f32_16x16x32_bf16 v[36:39], v[88:91], v[100:103], v[36:39]
    v_mfma_f32_16x16x32_bf16 v[40:43], v[88:91], v[104:107], v[40:43]
    s_nop 6
    v_cvt_pk_bf16_f32 v18, v36, v36
    v_and_b32 v18, 0xffff0000, v18
    v_cvt_pk_bf16_f32 v19, v37, v37
    v_and_b32 v19, 0xffff0000, v19
    v_sub_f32 v36, v36, v18
    v_sub_f32 v37, v37, v19
    v_cvt_pk_bf16_f32 v92, v18, v36
    v_cvt_pk_bf16_f32 v93, v19, v37
    v_mov_b32 v94, 0
    v_mov_b32 v95, 0
    ds_write_b128 v15, v[92:95] offset:57344
    v_cvt_pk_bf16_f32 v18, v40, v40
    v_and_b32 v18, 0xffff0000, v18
    v_cvt_pk_bf16_f32 v19, v41, v41
    v_and_b32 v19, 0xffff0000, v19
    v_sub_f32 v40, v40, v18
    v_sub_f32 v41, v41, v19
    v_cvt_pk_bf16_f32 v96, v18, v40
    v_cvt_pk_bf16_f32 v97, v19, v41
    v_mov_b32 v98, 0
    v_mov_b32 v99, 0
    ds_write_b128 v15, v[96:99] offset:61440
    s_waitcnt vmcnt(6)
    s_barrier
    ds_read_b128 v[60:63], v4 offset:24576
    ds_read_b128 v[64:67], v4 offset:25600
    ds_read_b128 v[68:71], v4 offset:26624
    ds_read_b128 v[72:75], v4 offset:27648
    ds_read_b128 v[76:79], v4 offset:28672
    ds_read_b128 v[80:83], v4 offset:29696
    s_waitcnt lgkmcnt(5)
    v_mfma_f32_32x32x16_bf16 v[20:35], a[224:227], v[60:63], 0
    ds_read_b128 v[84:87], v4 offset:30720
    s_waitcnt lgkmcnt(5)
    v_mfma_f32_32x32x16_bf16 v[20:35], a[228:231], v[64:67], v[20:35]
    ds_read_b128 v[88:91], v4 offset:31744
    s_waitcnt lgkmcnt(5)
    v_mfma_f32_32x32x16_bf16 v[20:35], a[232:235], v[68:71], v[20:35]
    s_waitcnt vmcnt(3)
    s_barrier
    ds_read_b128 v[60:63], v4 offset:32768
    s_waitcnt lgkmcnt(5)
    v_mfma_f32_32x32x16_bf16 v[20:35], a[236:239], v[72:75], v[20:35]
    ds_read_b128 v[64:67], v4 offset:33792
    s_waitcnt lgkmcnt(5)
    v_mfma_f32_32x32x16_bf16 v[20:35], a[240:243], v[76:79], v[20:35]
    ds_read_b128 v[68:71], v4 offset:34816
    s_waitcnt lgkmcnt(5)
    v_mfma_f32_32x32x16_bf16 v[20:35], a[244:247], v[80:83], v[20:35]
    ds_read_b128 v[72:75], v4 offset:35840
    s_waitcnt lgkmcnt(5)
    v_mfma_f32_32x32x16_bf16 v[20:35], a[248:251], v[84:87], v[20:35]
    ds_read_b128 v[76:79], v4 offset:36864
    s_waitcnt lgkmcnt(5)
    v_mfma_f32_32x32x16_bf16 v[20:35], a[252:255], v[88:91], v[20:35]
    ds_read_b128 v[80:83], v4 offset:37888
    s_waitcnt lgkmcnt(5)
    v_mfma_f32_32x32x16_bf16 v[20:35], v[160:163], v[60:63], v[20:35]
    ds_read_b128 v[84:87], v4 offset:38912
    s_waitcnt lgkmcnt(5)
    v_mfma_f32_32x32x16_bf16 v[20:35], v[164:167], v[64:67], v[20:35]
    ds_read_b128 v[88:91], v4 offset:39936
    s_waitcnt lgkmcnt(5)
    v_mfma_f32_32x32x16_bf16 v[20:35], v[168:171], v[68:71], v[20:35]
    ds_read_b128 v[60:63], v4 offset:40960
    s_waitcnt lgkmcnt(5)
    v_mfma_f32_32x32x16_bf16 v[20:35], v[172:175], v[72:75], v[20:35]
    ds_read_b128 v[64:67], v4 offset:41984
    s_waitcnt lgkmcnt(5)
    v_mfma_f32_32x32x16_bf16 v[20:35], v[176:179], v[76:79], v[20:35]
    ds_read_b128 v[68:71], v4 offset:43008
    s_waitcnt lgkmcnt(5)
    v_mfma_f32_32x32x16_bf16 v[20:35], v[180:183], v[80:83], v[20:35]
    ds_read_b128 v[72:75], v4 offset:44032
    s_waitcnt lgkmcnt(5)
    v_mfma_f32_32x32x16_bf16 v[20:35], v[184:187], v[84:87], v[20:35]
    s_waitcnt vmcnt(0)
    s_barrier
    ds_read_b128 v[76:79], v4 offset:45056
    s_waitcnt lgkmcnt(5)
    v_mfma_f32_32x32x16_bf16 v[20:35], v[188:191], v[88:91], v[20:35]
    ds_read_b128 v[80:83], v4 offset:46080
    s_waitcnt lgkmcnt(5)
    v_mfma_f32_32x32x16_bf16 v[20:35], v[192:195], v[60:63], v[20:35]
    ds_read_b128 v[84:87], v4 offset:47104
    s_waitcnt lgkmcnt(5)
    v_mfma_f32_32x32x16_bf16 v[20:35], v[196:199], v[64:67], v[20:35]
    ds_read_b128 v[88:91], v4 offset:48128
    s_waitcnt lgkmcnt(5)
    v_mfma_f32_32x32x16_bf16 v[20:35], v[200:203], v[68:71], v[20:35]
    ds_read_b128 v[60:63], v4 offset:49152
    s_waitcnt lgkmcnt(5)
    v_mfma_f32_32x32x16_bf16 v[20:35], v[204:207], v[72:75], v[20:35]
    ds_read_b128 v[64:67], v4 offset:50176
    s_waitcnt lgkmcnt(5)
    v_mfma_f32_32x32x16_bf16 v[20:35], v[208:211], v[76:79], v[20:35]
    ds_read_b128 v[68:71], v4 offset:51200
    s_waitcnt lgkmcnt(5)
    v_mfma_f32_32x32x16_bf16 v[20:35], v[212:215], v[80:83], v[20:35]
    ds_read_b128 v[72:75], v4 offset:52224
    s_waitcnt lgkmcnt(5)
    v_mfma_f32_32x32x16_bf16 v[20:35], v[216:219], v[84:87], v[20:35]
    ds_read_b128 v[76:79], v4 offset:53248
    s_waitcnt lgkmcnt(5)
    v_mfma_f32_32x32x16_bf16 v[20:35], v[220:223], v[88:91], v[20:35]
    ds_read_b128 v[80:83], v4 offset:54272
    s_waitcnt lgkmcnt(5)
    v_mfma_f32_32x32x16_bf16 v[20:35], v[224:227], v[60:63], v[20:35]
    ds_read_b128 v[84:87], v4 offset:55296
    s_waitcnt lgkmcnt(5)
    v_mfma_f32_32x32x16_bf16 v[20:35], v[228:231], v[64:67], v[20:35]
    ds_read_b128 v[88:91], v4 offset:56320
    s_waitcnt lgkmcnt(5)
    v_mfma_f32_32x32x16_bf16 v[20:35], v[232:235], v[68:71], v[20:35]
    s_waitcnt lgkmcnt(4)
    v_mfma_f32_32x32x16_bf16 v[20:35], v[236:239], v[72:75], v[20:35]
    s_waitcnt lgkmcnt(3)
    v_mfma_f32_32x32x16_bf16 v[20:35], v[240:243], v[76:79], v[20:35]
    s_waitcnt lgkmcnt(2)
    v_mfma_f32_32x32x16_bf16 v[20:35], v[244:247], v[80:83], v[20:35]
    s_waitcnt lgkmcnt(1)
    v_mfma_f32_32x32x16_bf16 v[20:35], v[248:251], v[84:87], v[20:35]
    s_waitcnt lgkmcnt(0)
    v_mfma_f32_32x32x16_bf16 v[20:35], v[252:255], v[88:91], v[20:35]
    s_nop 11
    v_pk_fma_f32 v[20:21], v[108:109], v[20:21], v[44:45]
    v_pk_fma_f32 v[22:23], v[110:111], v[22:23], v[46:47]
    v_pk_fma_f32 v[24:25], v[112:113], v[24:25], v[48:49]
    v_pk_fma_f32 v[26:27], v[114:115], v[26:27], v[50:51]
    v_pk_fma_f32 v[28:29], v[116:117], v[28:29], v[52:53]
    v_pk_fma_f32 v[30:31], v[118:119], v[30:31], v[54:55]
    v_pk_fma_f32 v[32:33], v[120:121], v[32:33], v[56:57]
    v_pk_fma_f32 v[34:35], v[122:123], v[34:35], v[58:59]
    v_pk_mul_f32 v[124:125], v[124:125], v[20:21]
    v_pk_mul_f32 v[126:127], v[126:127], v[22:23]
    v_pk_mul_f32 v[128:129], v[128:129], v[24:25]
    v_pk_mul_f32 v[130:131], v[130:131], v[26:27]
    v_pk_mul_f32 v[132:133], v[132:133], v[28:29]
    v_pk_mul_f32 v[134:135], v[134:135], v[30:31]
    v_pk_mul_f32 v[136:137], v[136:137], v[32:33]
    v_pk_mul_f32 v[138:139], v[138:139], v[34:35]
    v_cvt_pk_bf16_f32 v60, v124, v125
    v_cvt_pk_bf16_f32 v61, v126, v127
    v_cvt_pk_bf16_f32 v62, v128, v129
    v_cvt_pk_bf16_f32 v63, v130, v131
    v_cvt_pk_bf16_f32 v64, v132, v133
    v_cvt_pk_bf16_f32 v65, v134, v135
    v_cvt_pk_bf16_f32 v66, v136, v137
    v_cvt_pk_bf16_f32 v67, v138, v139
    buffer_store_dwordx4 v[60:63], v12, s[24:27], s45 offen sc1
    buffer_store_dwordx4 v[64:67], v12, s[24:27], s45 offen offset:512 sc1
    v_pk_add_f32 v[14:15], v[20:21], v[22:23]
    v_pk_mul_f32 v[16:17], v[20:21], v[20:21]
    v_pk_fma_f32 v[16:17], v[22:23], v[22:23], v[16:17]
    v_pk_add_f32 v[14:15], v[14:15], v[24:25]
    v_pk_fma_f32 v[16:17], v[24:25], v[24:25], v[16:17]
    v_pk_add_f32 v[14:15], v[14:15], v[26:27]
    v_pk_fma_f32 v[16:17], v[26:27], v[26:27], v[16:17]
    v_pk_add_f32 v[14:15], v[14:15], v[28:29]
    v_pk_fma_f32 v[16:17], v[28:29], v[28:29], v[16:17]
    v_pk_add_f32 v[14:15], v[14:15], v[30:31]
    v_pk_fma_f32 v[16:17], v[30:31], v[30:31], v[16:17]
    v_pk_add_f32 v[14:15], v[14:15], v[32:33]
    v_pk_fma_f32 v[16:17], v[32:33], v[32:33], v[16:17]
    v_pk_add_f32 v[14:15], v[14:15], v[34:35]
    v_pk_fma_f32 v[16:17], v[34:35], v[34:35], v[16:17]
    v_add_f32 v14, v14, v15
    v_add_f32 v15, v16, v17
    v_mov_b32 v16, v14
    v_mov_b32 v17, v15
    v_cvt_pk_bf16_f32 v144, v20, v21
    v_cvt_pk_bf16_f32 v145, v22, v23
    v_permlane32_swap_b32 v16, v14
    v_permlane32_swap_b32 v17, v15
    v_pk_add_f32 v[14:15], v[14:15], v[16:17]
    s_mov_b32 exec_hi, 0
    buffer_store_dwordx2 v[14:15], v13, s[24:27], s46 offen sc1
    s_mov_b32 exec_hi, -1
    v_cvt_pk_bf16_f32 v146, v24, v25
    v_cvt_pk_bf16_f32 v147, v26, v27
    v_cvt_pk_bf16_f32 v148, v28, v29
    v_cvt_pk_bf16_f32 v149, v30, v31
    v_cvt_pk_bf16_f32 v150, v32, v33
    v_cvt_pk_bf16_f32 v151, v34, v35
    v_mov_b32 v156, v12
    s_mov_b32 s59, s44
    s_lshr_b32 s40, s42, 2
    s_and_b32 s41, s42, 3
    s_lshl_b32 s41, s41, 2
    s_lshr_b32 s43, s37, 3
    s_add_u32 s41, s41, s43
    s_mul_i32 s38, s40, 16
    s_add_u32 s38, s38, s41
    s_lshl_b32 s38, s38, 8
    s_add_u32 s38, s38, 28246016
    v_mov_b32 v6, 0
    v_mov_b32 v7, s98
    s_cmp_lg_u32 s3, 0
    s_waitcnt vmcnt(0) lgkmcnt(0)
    s_barrier
    s_cbranch_scc1 L_sig2_s
    s_mov_b64 exec, 1
    s_cmp_eq_u32 s93, 0
    s_cbranch_scc1 L_sig2_slow_s
    buffer_store_dword v7, v6, s[24:27], s38 offen
    s_branch L_sig2_done_s
L_sig2_slow_s:
    buffer_store_dword v7, v6, s[24:27], s38 offen sc1
L_sig2_done_s:
    s_mov_b64 exec, -1
L_sig2_s:
    s_lshl_b32 s40, s36, 1
    s_bfe_u32 s41, s37, 0x10002
    s_add_u32 s40, s40, s41
    s_lshl_b32 s44, s40, 2
    s_add_u32 s44, s44, s3
    s_lshl_b32 s45, s44, 15
    s_add_u32 s45, s45, 14745600
    s_add_u32 s46, s45, 16384
    v_and_b32 v3, 15, v1
    v_lshrrev_b32 v152, 4, v1
    v_lshlrev_b32 v153, 3, v3
    v_lshl_add_u32 v153, v152, 10, v153
    s_lshl_b32 s47, s44, 12
    s_add_u32 s47, s47, 16842752
    s_mul_i32 s42, s44, 114688
    s_mul_i32 s43, s57, 7168
    s_add_u32 s42, s42, s43
    s_add_u32 s42, s42, 18939904
    s_add_u32 s43, s42, 4096
    ds_read_b128 v[64:67], v5 offset:2048
    ds_read_b128 v[68:71], v5 offset:3072
    ds_read_b128 v[72:75], v5 offset:4096
    ds_read_b128 v[76:79], v5 offset:5120
    ds_read_b128 v[80:83], v5 offset:9216
    ds_read_b128 v[84:87], v5 offset:10240
    ds_read_b128 v[88:91], v5 offset:11264
    ds_read_b128 v[92:95], v5 offset:12288
    ds_read_b128 v[96:99], v5 offset:16384
    ds_read_b128 v[100:103], v5 offset:17408
    s_cmp_lg_u32 s3, 0
    s_cbranch_scc1 L_wait2
    s_mul_i32 s38, s40, 4096
    s_add_u32 s38, s38, 28246016
    v_lshlrev_b32 v6, 8, v1
    s_mov_b32 exec_lo, 0xffff
    s_mov_b32 exec_hi, 0
    s_mov_b32 s39, 0x40000
L_poll2:
    buffer_load_dword v7, v6, s[24:27], s38 offen sc1
    s_sub_u32 s39, s39, 1
    s_cbranch_scc1 L_bail2
    s_waitcnt vmcnt(0)
    v_cmp_ne_u32 vcc, s98, v7
    s_cbranch_vccnz L_poll2
L_bail2:
    s_waitcnt vmcnt(0)
    s_mov_b64 exec, -1
L_wait2:
    s_barrier
    buffer_load_dwordx4 a[224:227], v2, s[24:27], s45 offen offset:0 sc1
    buffer_load_dwordx4 a[228:231], v2, s[24:27], s46 offen offset:0 sc1
    buffer_load_dwordx4 a[232:235], v2, s[24:27], s45 offen offset:1024 sc1
    buffer_load_dwordx4 a[236:239], v2, s[24:27], s46 offen offset:1024 sc1
    buffer_load_dwordx4 a[240:243], v2, s[24:27], s45 offen offset:2048 sc1
    buffer_load_dwordx4 a[244:247], v2, s[24:27], s46 offen offset:2048 sc1
    buffer_load_dwordx4 a[248:251], v2, s[24:27], s45 offen offset:3072 sc1
    buffer_load_dwordx4 a[252:255], v2, s[24:27], s46 offen offset:3072 sc1
    s_add_u32 s45, s45, 4096
    s_add_u32 s46, s46, 4096
    buffer_load_dwordx4 v[160:163], v2, s[24:27], s45 offen offset:0 sc1
    buffer_load_dwordx4 v[164:167], v2, s[24:27], s46 offen offset:0 sc1
    buffer_load_dwordx4 v[168:171], v2, s[24:27], s45 offen offset:1024 sc1
    buffer_load_dwordx4 v[172:175], v2, s[24:27], s46 offen offset:1024 sc1
    buffer_load_dwordx4 v[176:179], v2, s[24:27], s45 offen offset:2048 sc1
    buffer_load_dwordx4 v[180:183], v2, s[24:27], s46 offen offset:2048 sc1
    s_waitcnt vmcnt(12) lgkmcnt(6)
    v_mfma_f32_16x16x32_bf16 v[8:11], v[64:67], a[224:227], 0
    buffer_load_dwordx4 v[184:187], v2, s[24:27], s45 offen offset:3072 sc1
    buffer_load_dwordx4 v[188:191], v2, s[24:27], s46 offen offset:3072 sc1
    v_mfma_f32_16x16x32_bf16 v[12:15], v[64:67], a[228:231], 0
    ds_read_b128 v[104:107], v5 offset:18432
    v_mfma_f32_16x16x32_bf16 v[16:19], v[68:71], a[224:227], 0
    v_mfma_f32_16x16x32_bf16 v[20:23], v[68:71], a[228:231], 0
    ds_read_b128 v[108:111], v5 offset:19456
    v_mfma_f32_16x16x32_bf16 v[24:27], v[72:75], a[224:227], 0
    v_mfma_f32_16x16x32_bf16 v[28:31], v[72:75], a[228:231], 0
    ds_read_b128 v[112:115], v5 offset:23552
    v_mfma_f32_16x16x32_bf16 v[32:35], v[76:79], a[224:227], 0
    v_mfma_f32_16x16x32_bf16 v[36:39], v[76:79], a[228:231], 0
    ds_read_b128 v[116:119], v5 offset:24576
    s_waitcnt vmcnt(12) lgkmcnt(6)
    v_mfma_f32_16x16x32_bf16 v[8:11], v[80:83], a[232:235], v[8:11]
    s_add_u32 s45, s45, 4096
    s_add_u32 s46, s46, 4096
    buffer_load_dwordx4 v[192:195], v2, s[24:27], s45 offen offset:0 sc1
    buffer_load_dwordx4 v[196:199], v2, s[24:27], s46 offen offset:0 sc1
    v_mfma_f32_16x16x32_bf16 v[12:15], v[80:83], a[236:239], v[12:15]
    ds_read_b128 v[64:67], v5 offset:25600
    v_mfma_f32_16x16x32_bf16 v[16:19], v[84:87], a[232:235], v[16:19]
    buffer_load_dwordx2 v[120:121], v153, s[24:27], s47 offen offset:0 sc1
    v_mfma_f32_16x16x32_bf16 v[20:23], v[84:87], a[236:239], v[20:23]
    ds_read_b128 v[68:71], v5 offset:26624
    v_mfma_f32_16x16x32_bf16 v[24:27], v[88:91], a[232:235], v[24:27]
    buffer_load_dwordx2 v[122:123], v153, s[24:27], s47 offen offset:256 sc1
    v_mfma_f32_16x16x32_bf16 v[28:31], v[88:91], a[236:239], v[28:31]
    ds_read_b128 v[72:75], v2 offset:0
    v_mfma_f32_16x16x32_bf16 v[32:35], v[92:95], a[232:235], v[32:35]
    buffer_load_dwordx2 v[124:125], v153, s[24:27], s47 offen offset:512 sc1
    v_mfma_f32_16x16x32_bf16 v[36:39], v[92:95], a[236:239], v[36:39]
    ds_read_b128 v[76:79], v2 offset:1024
    s_waitcnt vmcnt(15) lgkmcnt(6)
    v_mfma_f32_16x16x32_bf16 v[8:11], v[96:99], a[240:243], v[8:11]
    buffer_load_dwordx4 v[200:203], v2, s[24:27], s45 offen offset:1024 sc1
    buffer_load_dwordx4 v[204:207], v2, s[24:27], s46 offen offset:1024 sc1
    v_mfma_f32_16x16x32_bf16 v[12:15], v[96:99], a[244:247], v[12:15]
    ds_read_b128 v[80:83], v2 offset:2048
    v_mfma_f32_16x16x32_bf16 v[16:19], v[100:103], a[240:243], v[16:19]
    buffer_load_dwordx2 v[126:127], v153, s[24:27], s47 offen offset:768 sc1
    v_mfma_f32_16x16x32_bf16 v[20:23], v[100:103], a[244:247], v[20:23]
    ds_read_b128 v[84:87], v2 offset:3072
    v_mfma_f32_16x16x32_bf16 v[24:27], v[104:107], a[240:243], v[24:27]
    buffer_load_dwordx2 v[128:129], v153, s[24:27], s47 offen offset:128 sc1
    v_mfma_f32_16x16x32_bf16 v[28:31], v[104:107], a[244:247], v[28:31]
    ds_read_b128 v[88:91], v2 offset:7168
    v_mfma_f32_16x16x32_bf16 v[32:35], v[108:111], a[240:243], v[32:35]
    buffer_load_dwordx2 v[130:131], v153, s[24:27], s47 offen offset:384 sc1
    v_mfma_f32_16x16x32_bf16 v[36:39], v[108:111], a[244:247], v[36:39]
    ds_read_b128 v[92:95], v2 offset:8192
    s_waitcnt vmcnt(18) lgkmcnt(6)
    v_mfma_f32_16x16x32_bf16 v[8:11], v[112:115], a[248:251], v[8:11]
    buffer_load_dwordx4 v[208:211], v2, s[24:27], s45 offen offset:2048 sc1
    buffer_load_dwordx4 v[212:215], v2, s[24:27], s46 offen offset:2048 sc1
    v_mfma_f32_16x16x32_bf16 v[12:15], v[112:115], a[252:255], v[12:15]
    ds_read_b128 v[96:99], v2 offset:9216
    v_mfma_f32_16x16x32_bf16 v[16:19], v[116:119], a[248:251], v[16:19]
    buffer_load_dwordx2 v[132:133], v153, s[24:27], s47 offen offset:640 sc1
    v_mfma_f32_16x16x32_bf16 v[20:23], v[116:119], a[252:255], v[20:23]
    ds_read_b128 v[100:103], v2 offset:10240
    v_mfma_f32_16x16x32_bf16 v[24:27], v[64:67], a[248:251], v[24:27]
    buffer_load_dwordx2 v[134:135], v153, s[24:27], s47 offen offset:896 sc1
    v_mfma_f32_16x16x32_bf16 v[28:31], v[64:67], a[252:255], v[28:31]
    ds_read_b128 v[104:107], v2 offset:14336
    v_mfma_f32_16x16x32_bf16 v[32:35], v[68:71], a[248:251], v[32:35]
    v_mfma_f32_16x16x32_bf16 v[36:39], v[68:71], a[252:255], v[36:39]
    ds_read_b128 v[108:111], v2 offset:15360
    s_waitcnt vmcnt(20) lgkmcnt(6)
    v_mfma_f32_16x16x32_bf16 v[8:11], v[72:75], v[160:163], v[8:11]
    buffer_load_dwordx4 v[216:219], v2, s[24:27], s45 offen offset:3072 sc1
    buffer_load_dwordx4 v[220:223], v2, s[24:27], s46 offen offset:3072 sc1
    v_mfma_f32_16x16x32_bf16 v[12:15], v[72:75], v[164:167], v[12:15]
    ds_read_b128 v[112:115], v2 offset:16384
    v_mfma_f32_16x16x32_bf16 v[16:19], v[76:79], v[160:163], v[16:19]
    v_mfma_f32_16x16x32_bf16 v[20:23], v[76:79], v[164:167], v[20:23]
    ds_read_b128 v[116:119], v2 offset:17408
    v_mfma_f32_16x16x32_bf16 v[24:27], v[80:83], v[160:163], v[24:27]
    v_mfma_f32_16x16x32_bf16 v[28:31], v[80:83], v[164:167], v[28:31]
    ds_read_b128 v[64:67], v2 offset:21504
    v_mfma_f32_16x16x32_bf16 v[32:35], v[84:87], v[160:163], v[32:35]
    v_mfma_f32_16x16x32_bf16 v[36:39], v[84:87], v[164:167], v[36:39]
    ds_read_b128 v[68:71], v2 offset:22528
    s_waitcnt vmcnt(20) lgkmcnt(6)
    v_mfma_f32_16x16x32_bf16 v[8:11], v[88:91], v[168:171], v[8:11]
    s_add_u32 s45, s45, 4096
    s_add_u32 s46, s46, 4096
    buffer_load_dwordx4 v[224:227], v2, s[24:27], s45 offen offset:0 sc1
    buffer_load_dwordx4 v[228:231], v2, s[24:27], s46 offen offset:0 sc1
    v_mfma_f32_16x16x32_bf16 v[12:15], v[88:91], v[172:175], v[12:15]
    ds_read_b128 v[72:75], v2 offset:23552
    v_mfma_f32_16x16x32_bf16 v[16:19], v[92:95], v[168:171], v[16:19]
    v_mfma_f32_16x16x32_bf16 v[20:23], v[92:95], v[172:175], v[20:23]
    ds_read_b128 v[76:79], v2 offset:24576
    v_mfma_f32_16x16x32_bf16 v[24:27], v[96:99], v[168:171], v[24:27]
    v_mfma_f32_16x16x32_bf16 v[28:31], v[96:99], v[172:175], v[28:31]
    ds_read_b128 v[80:83], v2 offset:28672
    v_mfma_f32_16x16x32_bf16 v[32:35], v[100:103], v[168:171], v[32:35]
    v_mfma_f32_16x16x32_bf16 v[36:39], v[100:103], v[172:175], v[36:39]
    ds_read_b128 v[84:87], v2 offset:29696
    s_waitcnt vmcnt(20) lgkmcnt(6)
    v_mfma_f32_16x16x32_bf16 v[8:11], v[104:107], v[176:179], v[8:11]
    buffer_load_dwordx4 v[232:235], v2, s[24:27], s45 offen offset:1024 sc1
    buffer_load_dwordx4 v[236:239], v2, s[24:27], s46 offen offset:1024 sc1
    v_mfma_f32_16x16x32_bf16 v[12:15], v[104:107], v[180:183], v[12:15]
    ds_read_b128 v[88:91], v2 offset:30720
    v_mfma_f32_16x16x32_bf16 v[16:19], v[108:111], v[176:179], v[16:19]
    v_mfma_f32_16x16x32_bf16 v[20:23], v[108:111], v[180:183], v[20:23]
    ds_read_b128 v[92:95], v2 offset:31744
    v_mfma_f32_16x16x32_bf16 v[24:27], v[112:115], v[176:179], v[24:27]
    v_mfma_f32_16x16x32_bf16 v[28:31], v[112:115], v[180:183], v[28:31]
    ds_read_b128 v[96:99], v2 offset:35840
    v_mfma_f32_16x16x32_bf16 v[32:35], v[116:119], v[176:179], v[32:35]
    v_mfma_f32_16x16x32_bf16 v[36:39], v[116:119], v[180:183], v[36:39]
    ds_read_b128 v[100:103], v2 offset:36864
    s_waitcnt vmcnt(20) lgkmcnt(6)
    s_waitcnt vmcnt(6)
    v_mfma_f32_16x16x32_bf16 v[8:11], v[64:67], v[184:187], v[8:11]
    buffer_load_dwordx4 v[240:243], v2, s[24:27], s45 offen offset:2048 sc1
    buffer_load_dwordx4 v[244:247], v2, s[24:27], s46 offen offset:2048 sc1
    v_pk_add_f32 v[120:121], v[120:121], v[122:123]
    v_pk_add_f32 v[124:125], v[124:125], v[126:127]
    v_mfma_f32_16x16x32_bf16 v[12:15], v[64:67], v[188:191], v[12:15]
    ds_read_b128 v[104:107], v2 offset:37888
    v_pk_add_f32 v[120:121], v[120:121], v[124:125]
    v_mfma_f32_16x16x32_bf16 v[16:19], v[68:71], v[184:187], v[16:19]
    v_pk_add_f32 v[128:129], v[128:129], v[130:131]
    v_pk_add_f32 v[132:133], v[132:133], v[134:135]
    v_mfma_f32_16x16x32_bf16 v[20:23], v[68:71], v[188:191], v[20:23]
    ds_read_b128 v[108:111], v2 offset:38912
    v_pk_add_f32 v[128:129], v[128:129], v[132:133]
    v_mfma_f32_16x16x32_bf16 v[24:27], v[72:75], v[184:187], v[24:27]
    v_mov_b32 v122, v120
    v_mov_b32 v123, v121
    v_mfma_f32_16x16x32_bf16 v[28:31], v[72:75], v[188:191], v[28:31]
    ds_read_b128 v[112:115], v2 offset:43008
    v_mov_b32 v130, v128
    v_mfma_f32_16x16x32_bf16 v[32:35], v[76:79], v[184:187], v[32:35]
    v_mov_b32 v131, v129
    s_nop 1
    v_mfma_f32_16x16x32_bf16 v[36:39], v[76:79], v[188:191], v[36:39]
    ds_read_b128 v[116:119], v2 offset:44032
    v_permlane16_swap_b32 v122, v120
    s_waitcnt vmcnt(20) lgkmcnt(6)
    v_mfma_f32_16x16x32_bf16 v[8:11], v[80:83], v[192:195], v[8:11]
    buffer_load_dwordx4 v[248:251], v2, s[24:27], s45 offen offset:3072 sc1
    buffer_load_dwordx4 v[252:255], v2, s[24:27], s46 offen offset:3072 sc1
    v_permlane16_swap_b32 v123, v121
    v_permlane16_swap_b32 v130, v128
    v_mfma_f32_16x16x32_bf16 v[12:15], v[80:83], v[196:199], v[12:15]
    ds_read_b128 v[64:67], v2 offset:45056
    v_permlane16_swap_b32 v131, v129
    v_mfma_f32_16x16x32_bf16 v[16:19], v[84:87], v[192:195], v[16:19]
    v_add_f32 v120, v122, v120
    v_add_f32 v121, v123, v121
    v_mfma_f32_16x16x32_bf16 v[20:23], v[84:87], v[196:199], v[20:23]
    ds_read_b128 v[68:71], v2 offset:46080
    v_add_f32 v128, v130, v128
    v_mfma_f32_16x16x32_bf16 v[24:27], v[88:91], v[192:195], v[24:27]
    v_add_f32 v129, v131, v129
    v_mov_b32 v122, v120
    v_mfma_f32_16x16x32_bf16 v[28:31], v[88:91], v[196:199], v[28:31]
    ds_read_b128 v[72:75], v2 offset:50176
    v_mov_b32 v123, v121
    v_mfma_f32_16x16x32_bf16 v[32:35], v[92:95], v[192:195], v[32:35]
    v_mov_b32 v130, v128
    v_mov_b32 v131, v129
    v_mfma_f32_16x16x32_bf16 v[36:39], v[92:95], v[196:199], v[36:39]
    ds_read_b128 v[76:79], v2 offset:51200
    s_nop 1
    s_waitcnt vmcnt(17) lgkmcnt(6)
    v_mfma_f32_16x16x32_bf16 v[8:11], v[96:99], v[200:203], v[8:11]
    v_permlane32_swap_b32 v122, v120
    v_permlane32_swap_b32 v123, v121
    v_mfma_f32_16x16x32_bf16 v[12:15], v[96:99], v[204:207], v[12:15]
    ds_read_b128 v[80:83], v2 offset:52224
    v_permlane32_swap_b32 v130, v128
    v_mfma_f32_16x16x32_bf16 v[16:19], v[100:103], v[200:203], v[16:19]
    v_permlane32_swap_b32 v131, v129
    v_add_f32 v120, v122, v120
    v_mfma_f32_16x16x32_bf16 v[20:23], v[100:103], v[204:207], v[20:23]
    ds_read_b128 v[84:87], v2 offset:53248
    v_add_f32 v121, v123, v121
    v_mfma_f32_16x16x32_bf16 v[24:27], v[104:107], v[200:203], v[24:27]
    v_add_f32 v128, v130, v128
    v_add_f32 v129, v131, v129
    v_mfma_f32_16x16x32_bf16 v[28:31], v[104:107], v[204:207], v[28:31]
    ds_read_b128 v[88:91], v2 offset:57344
    v_mul_f32 v120, 0x3b000000, v120
    v_mfma_f32_16x16x32_bf16 v[32:35], v[108:111], v[200:203], v[32:35]
    v_mul_f32 v121, 0x3b000000, v121
    v_fma_f32 v121, -v120, v120, v121
    v_mfma_f32_16x16x32_bf16 v[36:39], v[108:111], v[204:207], v[36:39]
    ds_read_b128 v[92:95], v2 offset:58368
    v_max_f32 v121, 0, v121
    s_waitcnt vmcnt(12) lgkmcnt(6)
    v_mfma_f32_16x16x32_bf16 v[8:11], v[112:115], v[208:211], v[8:11]
    v_cvt_pk_bf16_f32 v124, v120, v120
    v_and_b32 v124, 0xffff0000, v124
    v_mfma_f32_16x16x32_bf16 v[12:15], v[112:115], v[212:215], v[12:15]
    ds_read_b128 v[96:99], v2 offset:59392
    v_cvt_pk_bf16_f32 v121, v121, v121
    v_mfma_f32_16x16x32_bf16 v[16:19], v[116:119], v[208:211], v[16:19]
    buffer_load_dwordx4 a[176:179], v2, s[24:27], s55 offen offset:2048 sc1
    v_and_b32 v121, 0xffff0000, v121
    v_add_f32 v121, 0x3727c5ac, v121
    v_mfma_f32_16x16x32_bf16 v[20:23], v[116:119], v[212:215], v[20:23]
    ds_read_b128 v[100:103], v2 offset:60416
    v_cvt_pk_bf16_f32 v121, v121, v121
    v_mfma_f32_16x16x32_bf16 v[24:27], v[64:67], v[208:211], v[24:27]
    buffer_load_dwordx4 a[180:183], v2, s[24:27], s56 offen offset:2048 sc1
    v_and_b32 v121, 0xffff0000, v121
    v_sqrt_f32 v121, v121
    v_mfma_f32_16x16x32_bf16 v[28:31], v[64:67], v[212:215], v[28:31]
    ds_read_b128 v[104:107], v2 offset:64512
    s_nop 0
    v_mfma_f32_16x16x32_bf16 v[32:35], v[68:71], v[208:211], v[32:35]
    buffer_store_dwordx4 v[144:147], v156, s[24:27], s59 offen sc1
    v_cvt_pk_bf16_f32 v126, v121, v121
    v_and_b32 v126, 0xffff0000, v126
    v_mfma_f32_16x16x32_bf16 v[36:39], v[68:71], v[212:215], v[36:39]
    ds_read_b128 v[108:111], v4 offset:0
    v_rcp_f32 v125, v126
    s_waitcnt vmcnt(11) lgkmcnt(6)
    v_mfma_f32_16x16x32_bf16 v[8:11], v[72:75], v[216:219], v[8:11]
    s_nop 0
    v_cvt_pk_bf16_f32 v136, -v124, -v124
    v_mfma_f32_16x16x32_bf16 v[12:15], v[72:75], v[220:223], v[12:15]
    ds_read_b128 v[112:115], v4 offset:1024
    v_cvt_pk_bf16_f32 v137, v126, v126
    v_mfma_f32_16x16x32_bf16 v[16:19], v[76:79], v[216:219], v[16:19]
    buffer_load_dwordx4 a[184:187], v2, s[24:27], s55 offen offset:3072 sc1
    v_mov_b32 v138, 0
    v_mov_b32 v139, 0
    v_mfma_f32_16x16x32_bf16 v[20:23], v[76:79], v[220:223], v[20:23]
    ds_read_b128 v[116:119], v4 offset:2048
    v_mul_f32 v128, 0x3b000000, v128
    v_mfma_f32_16x16x32_bf16 v[24:27], v[80:83], v[216:219], v[24:27]
    buffer_load_dwordx4 a[188:191], v2, s[24:27], s56 offen offset:3072 sc1
    v_mul_f32 v129, 0x3b000000, v129
    v_fma_f32 v129, -v128, v128, v129
    v_mfma_f32_16x16x32_bf16 v[28:31], v[80:83], v[220:223], v[28:31]
    ds_read_b128 v[64:67], v4 offset:6144
    v_max_f32 v129, 0, v129
    v_mfma_f32_16x16x32_bf16 v[32:35], v[84:87], v[216:219], v[32:35]
    buffer_store_dwordx4 v[148:151], v156, s[24:27], s59 offen offset:512 sc1
    v_cvt_pk_bf16_f32 v132, v128, v128
    v_and_b32 v132, 0xffff0000, v132
    v_mfma_f32_16x16x32_bf16 v[36:39], v[84:87], v[220:223], v[36:39]
    ds_read_b128 v[68:71], v4 offset:7168
    v_cvt_pk_bf16_f32 v129, v129, v129
    s_waitcnt vmcnt(12) lgkmcnt(6)
    v_mfma_f32_16x16x32_bf16 v[8:11], v[88:91], v[224:227], v[8:11]
    v_and_b32 v129, 0xffff0000, v129
    v_add_f32 v129, 0x3727c5ac, v129
    v_mfma_f32_16x16x32_bf16 v[12:15], v[88:91], v[228:231], v[12:15]
    ds_read_b128 v[72:75], v4 offset:8192
    v_cvt_pk_bf16_f32 v129, v129, v129
    v_mfma_f32_16x16x32_bf16 v[16:19], v[92:95], v[224:227], v[16:19]
    s_add_u32 s55, s55, 4096
    buffer_load_dwordx4 a[192:195], v2, s[24:27], s55 offen offset:0 sc1
    v_and_b32 v129, 0xffff0000, v129
    v_sqrt_f32 v129, v129
    v_mfma_f32_16x16x32_bf16 v[20:23], v[92:95], v[228:231], v[20:23]
    ds_read_b128 v[76:79], v4 offset:9216
    s_nop 0
    v_mfma_f32_16x16x32_bf16 v[24:27], v[96:99], v[224:227], v[24:27]
    s_add_u32 s56, s56, 4096
    buffer_load_dwordx4 a[196:199], v2, s[24:27], s56 offen offset:0 sc1
    v_cvt_pk_bf16_f32 v134, v129, v129
    v_and_b32 v134, 0xffff0000, v134
    v_mfma_f32_16x16x32_bf16 v[28:31], v[96:99], v[228:231], v[28:31]
    ds_read_b128 v[80:83], v4 offset:13312
    v_rcp_f32 v133, v134
    v_mfma_f32_16x16x32_bf16 v[32:35], v[100:103], v[224:227], v[32:35]
    s_nop 0
    v_cvt_pk_bf16_f32 v140, -v132, -v132
    v_mfma_f32_16x16x32_bf16 v[36:39], v[100:103], v[228:231], v[36:39]
    ds_read_b128 v[84:87], v4 offset:14336
    v_cvt_pk_bf16_f32 v141, v134, v134
    s_waitcnt vmcnt(12) lgkmcnt(6)
    v_mfma_f32_16x16x32_bf16 v[8:11], v[104:107], v[232:235], v[8:11]
    v_mov_b32 v142, 0
    v_mov_b32 v143, 0
    v_mfma_f32_16x16x32_bf16 v[12:15], v[104:107], v[236:239], v[12:15]
    ds_read_b128 v[88:91], v4 offset:15360
    v_lshlrev_b32 v154, 2, v3
    v_mfma_f32_16x16x32_bf16 v[16:19], v[108:111], v[232:235], v[16:19]
    buffer_load_dwordx4 a[200:203], v2, s[24:27], s55 offen offset:1024 sc1
    s_lshl_b32 s41, s3, 7
    v_add_u32 v154, s41, v154
    v_mfma_f32_16x16x32_bf16 v[20:23], v[108:111], v[236:239], v[20:23]
    ds_read_b128 v[92:95], v4 offset:16384
    v_add_u32 v154, 131072, v154
    v_mfma_f32_16x16x32_bf16 v[24:27], v[112:115], v[232:235], v[24:27]
    buffer_load_dwordx4 a[204:207], v2, s[24:27], s56 offen offset:1024 sc1
    v_mfma_f32_16x16x32_bf16 v[28:31], v[112:115], v[236:239], v[28:31]
    ds_read_b128 v[96:99], v4 offset:57344
    v_mfma_f32_16x16x32_bf16 v[32:35], v[116:119], v[232:235], v[32:35]
    v_mfma_f32_16x16x32_bf16 v[36:39], v[116:119], v[236:239], v[36:39]
    ds_read_b128 v[100:103], v4 offset:58368
    s_waitcnt vmcnt(12) lgkmcnt(6)
    v_mfma_f32_16x16x32_bf16 v[8:11], v[64:67], v[240:243], v[8:11]
    v_mfma_f32_16x16x32_bf16 v[12:15], v[64:67], v[244:247], v[12:15]
    ds_read_b128 v[104:107], v4 offset:59392
    v_mfma_f32_16x16x32_bf16 v[16:19], v[68:71], v[240:243], v[16:19]
    buffer_load_dwordx4 a[208:211], v2, s[24:27], s55 offen offset:2048 sc1
    v_mfma_f32_16x16x32_bf16 v[20:23], v[68:71], v[244:247], v[20:23]
    ds_read_b128 v[108:111], v4 offset:60416
    v_mfma_f32_16x16x32_bf16 v[24:27], v[72:75], v[240:243], v[24:27]
    buffer_load_dwordx4 a[212:215], v2, s[24:27], s56 offen offset:2048 sc1
    v_mfma_f32_16x16x32_bf16 v[28:31], v[72:75], v[244:247], v[28:31]
    ds_read_b128 v[112:115], v5 offset:6144
    v_mfma_f32_16x16x32_bf16 v[32:35], v[76:79], v[240:243], v[32:35]
    v_mfma_f32_16x16x32_bf16 v[36:39], v[76:79], v[244:247], v[36:39]
    ds_read_b128 v[116:119], v5 offset:7168
    s_waitcnt vmcnt(12) lgkmcnt(6)
    v_mfma_f32_16x16x32_bf16 v[8:11], v[80:83], v[248:251], v[8:11]
    v_mfma_f32_16x16x32_bf16 v[12:15], v[80:83], v[252:255], v[12:15]
    ds_read_b128 v[64:67], v5 offset:8192
    v_mfma_f32_16x16x32_bf16 v[16:19], v[84:87], v[248:251], v[16:19]
    buffer_load_dwordx4 a[216:219], v2, s[24:27], s55 offen offset:3072 sc1
    v_mfma_f32_16x16x32_bf16 v[20:23], v[84:87], v[252:255], v[20:23]
    ds_read_b128 v[68:71], v5 offset:13312
    v_mfma_f32_16x16x32_bf16 v[24:27], v[88:91], v[248:251], v[24:27]
    buffer_load_dwordx4 a[220:223], v2, s[24:27], s56 offen offset:3072 sc1
    v_mfma_f32_16x16x32_bf16 v[28:31], v[88:91], v[252:255], v[28:31]
    ds_read_b128 v[72:75], v5 offset:14336
    v_mfma_f32_16x16x32_bf16 v[32:35], v[92:95], v[248:251], v[32:35]
    v_mfma_f32_16x16x32_bf16 v[36:39], v[92:95], v[252:255], v[36:39]
    ds_read_b128 v[76:79], v5 offset:15360
    s_waitcnt lgkmcnt(6)
    s_nop 1
    v_mfma_f32_16x16x32_bf16 v[8:11], v[96:99], v[136:139], v[8:11]
    v_mfma_f32_16x16x32_bf16 v[12:15], v[96:99], v[140:143], v[12:15]
    ds_read_b128 v[80:83], v5 offset:20480
    v_mfma_f32_16x16x32_bf16 v[16:19], v[100:103], v[136:139], v[16:19]
    v_mfma_f32_16x16x32_bf16 v[20:23], v[100:103], v[140:143], v[20:23]
    ds_read_b128 v[84:87], v5 offset:21504
    v_mfma_f32_16x16x32_bf16 v[24:27], v[104:107], v[136:139], v[24:27]
    v_mfma_f32_16x16x32_bf16 v[28:31], v[104:107], v[140:143], v[28:31]
    ds_read_b128 v[88:91], v5 offset:22528
    v_mfma_f32_16x16x32_bf16 v[32:35], v[108:111], v[136:139], v[32:35]
    v_mfma_f32_16x16x32_bf16 v[36:39], v[108:111], v[140:143], v[36:39]
    ds_read_b128 v[92:95], v5 offset:27648
    s_waitcnt lgkmcnt(7)
    v_mfma_f32_16x16x32_bf16 v[40:43], v[112:115], a[224:227], 0
    ds_write_b32 v154, v125
    ds_write_b32 v154, v133 offset:64
    v_mfma_f32_16x16x32_bf16 v[44:47], v[112:115], a[228:231], 0
    ds_read_b128 v[96:99], v5 offset:28672
    v_lshlrev_b32 v158, 8, v3
    v_mfma_f32_16x16x32_bf16 v[48:51], v[116:119], a[224:227], 0
    v_mov_b32 v159, s98
    s_lshl_b32 s50, s40, 12
    v_mfma_f32_16x16x32_bf16 v[52:55], v[116:119], a[228:231], 0
    ds_read_b128 v[100:103], v5 offset:29696
    s_add_u32 s50, s50, 28311552
    v_mfma_f32_16x16x32_bf16 v[56:59], v[64:67], a[224:227], 0
    v_mfma_f32_16x16x32_bf16 v[60:63], v[64:67], a[228:231], 0
    ds_read_b128 v[104:107], v2 offset:4096
    s_waitcnt lgkmcnt(7)
    v_mfma_f32_16x16x32_bf16 v[40:43], v[68:71], a[232:235], v[40:43]
    v_cvt_pk_bf16_f32 v8, v8, v9
    v_cvt_pk_bf16_f32 v9, v10, v11
    v_mfma_f32_16x16x32_bf16 v[44:47], v[68:71], a[236:239], v[44:47]
    ds_read_b128 v[108:111], v2 offset:5120
    v_cvt_pk_bf16_f32 v10, v12, v13
    v_mfma_f32_16x16x32_bf16 v[48:51], v[72:75], a[232:235], v[48:51]
    v_cvt_pk_bf16_f32 v11, v14, v15
    v_pk_max_i16 v8, v8, 0
    v_mfma_f32_16x16x32_bf16 v[52:55], v[72:75], a[236:239], v[52:55]
    ds_read_b128 v[112:115], v2 offset:6144
    v_pk_max_i16 v9, v9, 0
    v_mfma_f32_16x16x32_bf16 v[56:59], v[76:79], a[232:235], v[56:59]
    v_pk_max_i16 v10, v10, 0
    v_pk_max_i16 v11, v11, 0
    v_mfma_f32_16x16x32_bf16 v[60:63], v[76:79], a[236:239], v[60:63]
    ds_read_b128 v[116:119], v2 offset:11264
    v_cvt_pk_bf16_f32 v16, v16, v17
    s_waitcnt lgkmcnt(7)
    v_mfma_f32_16x16x32_bf16 v[40:43], v[80:83], a[240:243], v[40:43]
    v_cvt_pk_bf16_f32 v17, v18, v19
    v_cvt_pk_bf16_f32 v18, v20, v21
    v_mfma_f32_16x16x32_bf16 v[44:47], v[80:83], a[244:247], v[44:47]
    ds_read_b128 v[64:67], v2 offset:12288
    v_cvt_pk_bf16_f32 v19, v22, v23
    v_mfma_f32_16x16x32_bf16 v[48:51], v[84:87], a[240:243], v[48:51]
    v_pk_max_i16 v16, v16, 0
    v_pk_max_i16 v17, v17, 0
    v_mfma_f32_16x16x32_bf16 v[52:55], v[84:87], a[244:247], v[52:55]
    ds_read_b128 v[68:71], v2 offset:13312
    v_pk_max_i16 v18, v18, 0
    v_mfma_f32_16x16x32_bf16 v[56:59], v[88:91], a[240:243], v[56:59]
    v_pk_max_i16 v19, v19, 0
    v_permlane16_swap_b32 v8, v10
    v_mfma_f32_16x16x32_bf16 v[60:63], v[88:91], a[244:247], v[60:63]
    ds_read_b128 v[72:75], v2 offset:18432
    v_permlane16_swap_b32 v9, v11
    s_waitcnt lgkmcnt(7)
    v_mfma_f32_16x16x32_bf16 v[40:43], v[92:95], a[248:251], v[40:43]
    buffer_store_dwordx4 v[8:11], v2, s[24:27], s42 offen offset:0 sc1
    v_cvt_pk_bf16_f32 v24, v24, v25
    v_mfma_f32_16x16x32_bf16 v[44:47], v[92:95], a[252:255], v[44:47]
    ds_read_b128 v[76:79], v2 offset:19456
    v_cvt_pk_bf16_f32 v25, v26, v27
    v_mfma_f32_16x16x32_bf16 v[48:51], v[96:99], a[248:251], v[48:51]
    v_cvt_pk_bf16_f32 v26, v28, v29
    v_cvt_pk_bf16_f32 v27, v30, v31
    v_mfma_f32_16x16x32_bf16 v[52:55], v[96:99], a[252:255], v[52:55]
    ds_read_b128 v[80:83], v2 offset:20480
    v_pk_max_i16 v24, v24, 0
    v_mfma_f32_16x16x32_bf16 v[56:59], v[100:103], a[248:251], v[56:59]
    v_pk_max_i16 v25, v25, 0
    v_pk_max_i16 v26, v26, 0
    v_mfma_f32_16x16x32_bf16 v[60:63], v[100:103], a[252:255], v[60:63]
    ds_read_b128 v[84:87], v2 offset:25600
    v_pk_max_i16 v27, v27, 0
    s_waitcnt lgkmcnt(7)
    v_mfma_f32_16x16x32_bf16 v[40:43], v[104:107], v[160:163], v[40:43]
    v_permlane16_swap_b32 v16, v18
    v_permlane16_swap_b32 v17, v19
    v_mfma_f32_16x16x32_bf16 v[44:47], v[104:107], v[164:167], v[44:47]
    ds_read_b128 v[88:91], v2 offset:26624
    buffer_store_dwordx4 v[16:19], v2, s[24:27], s42 offen offset:1024 sc1
    v_mfma_f32_16x16x32_bf16 v[48:51], v[108:111], v[160:163], v[48:51]
    v_cvt_pk_bf16_f32 v32, v32, v33
    v_cvt_pk_bf16_f32 v33, v34, v35
    v_mfma_f32_16x16x32_bf16 v[52:55], v[108:111], v[164:167], v[52:55]
    ds_read_b128 v[92:95], v2 offset:27648
    v_cvt_pk_bf16_f32 v34, v36, v37
    v_mfma_f32_16x16x32_bf16 v[56:59], v[112:115], v[160:163], v[56:59]
    v_cvt_pk_bf16_f32 v35, v38, v39
    v_pk_max_i16 v32, v32, 0
    v_mfma_f32_16x16x32_bf16 v[60:63], v[112:115], v[164:167], v[60:63]
    ds_read_b128 v[96:99], v2 offset:32768
    v_pk_max_i16 v33, v33, 0
    s_waitcnt lgkmcnt(7)
    v_mfma_f32_16x16x32_bf16 v[40:43], v[116:119], v[168:171], v[40:43]
    v_pk_max_i16 v34, v34, 0
    v_pk_max_i16 v35, v35, 0
    v_mfma_f32_16x16x32_bf16 v[44:47], v[116:119], v[172:175], v[44:47]
    ds_read_b128 v[100:103], v2 offset:33792
    v_permlane16_swap_b32 v24, v26
    v_mfma_f32_16x16x32_bf16 v[48:51], v[64:67], v[168:171], v[48:51]
    v_permlane16_swap_b32 v25, v27
    buffer_store_dwordx4 v[24:27], v2, s[24:27], s42 offen offset:2048 sc1
    v_mfma_f32_16x16x32_bf16 v[52:55], v[64:67], v[172:175], v[52:55]
    ds_read_b128 v[104:107], v2 offset:34816
    v_permlane16_swap_b32 v32, v34
    v_mfma_f32_16x16x32_bf16 v[56:59], v[68:71], v[168:171], v[56:59]
    v_permlane16_swap_b32 v33, v35
    buffer_store_dwordx4 v[32:35], v2, s[24:27], s42 offen offset:3072 sc1
    v_mfma_f32_16x16x32_bf16 v[60:63], v[68:71], v[172:175], v[60:63]
    ds_read_b128 v[108:111], v2 offset:39936
    s_lshl_b32 s51, s57, 8
    s_waitcnt lgkmcnt(7)
    v_mfma_f32_16x16x32_bf16 v[40:43], v[72:75], v[176:179], v[40:43]
    s_add_u32 s51, s51, s50
    s_lshl_b32 s58, s36, 2
    v_mfma_f32_16x16x32_bf16 v[44:47], v[72:75], v[180:183], v[44:47]
    ds_read_b128 v[112:115], v2 offset:40960
    s_bfe_u32 s41, s37, 0x20001
    v_mfma_f32_16x16x32_bf16 v[48:51], v[76:79], v[176:179], v[48:51]
    s_add_u32 s58, s58, s41
    s_lshl_b32 s58, s58, 1
    v_mfma_f32_16x16x32_bf16 v[52:55], v[76:79], v[180:183], v[52:55]
    ds_read_b128 v[116:119], v2 offset:41984
    s_and_b32 s41, s3, 1
    v_mfma_f32_16x16x32_bf16 v[56:59], v[80:83], v[176:179], v[56:59]
    s_add_u32 s58, s58, s41
    s_xor_b32 s41, s58, 1
    v_mfma_f32_16x16x32_bf16 v[60:63], v[80:83], v[180:183], v[60:63]
    ds_read_b128 v[64:67], v2 offset:47104
    s_mul_i32 s46, s58, 114688
    s_waitcnt lgkmcnt(7)
    v_mfma_f32_16x16x32_bf16 v[40:43], v[84:87], v[184:187], v[40:43]
    s_mul_i32 s47, s41, 114688
    s_mul_i32 s41, s3, 28672
    v_mfma_f32_16x16x32_bf16 v[44:47], v[84:87], v[188:191], v[44:47]
    ds_read_b128 v[68:71], v2 offset:48128
    s_add_u32 s41, s41, 18939904
    v_mfma_f32_16x16x32_bf16 v[48:51], v[88:91], v[184:187], v[48:51]
    s_add_u32 s46, s46, s41
    s_add_u32 s47, s47, s41
    v_mfma_f32_16x16x32_bf16 v[52:55], v[88:91], v[188:191], v[52:55]
    ds_read_b128 v[72:75], v2 offset:49152
    v_mfma_f32_16x16x32_bf16 v[56:59], v[92:95], v[184:187], v[56:59]
    v_mfma_f32_16x16x32_bf16 v[60:63], v[92:95], v[188:191], v[60:63]
    ds_read_b128 v[76:79], v2 offset:54272
    s_waitcnt lgkmcnt(7)
    v_mfma_f32_16x16x32_bf16 v[40:43], v[96:99], v[192:195], v[40:43]
    v_mfma_f32_16x16x32_bf16 v[44:47], v[96:99], v[196:199], v[44:47]
    ds_read_b128 v[80:83], v2 offset:55296
    v_mfma_f32_16x16x32_bf16 v[48:51], v[100:103], v[192:195], v[48:51]
    v_mfma_f32_16x16x32_bf16 v[52:55], v[100:103], v[196:199], v[52:55]
    ds_read_b128 v[84:87], v2 offset:56320
    v_mfma_f32_16x16x32_bf16 v[56:59], v[104:107], v[192:195], v[56:59]
    v_mfma_f32_16x16x32_bf16 v[60:63], v[104:107], v[196:199], v[60:63]
    ds_read_b128 v[88:91], v2 offset:61440
    s_waitcnt lgkmcnt(7)
    v_mfma_f32_16x16x32_bf16 v[40:43], v[108:111], v[200:203], v[40:43]
    v_mfma_f32_16x16x32_bf16 v[44:47], v[108:111], v[204:207], v[44:47]
    ds_read_b128 v[92:95], v2 offset:62464
    v_mfma_f32_16x16x32_bf16 v[48:51], v[112:115], v[200:203], v[48:51]
    v_mfma_f32_16x16x32_bf16 v[52:55], v[112:115], v[204:207], v[52:55]
    ds_read_b128 v[96:99], v2 offset:63488
    v_mfma_f32_16x16x32_bf16 v[56:59], v[116:119], v[200:203], v[56:59]
    v_mfma_f32_16x16x32_bf16 v[60:63], v[116:119], v[204:207], v[60:63]
    ds_read_b128 v[100:103], v4 offset:3072
    s_waitcnt lgkmcnt(7)
    v_mfma_f32_16x16x32_bf16 v[40:43], v[64:67], v[208:211], v[40:43]
    v_mfma_f32_16x16x32_bf16 v[44:47], v[64:67], v[212:215], v[44:47]
    ds_read_b128 v[104:107], v4 offset:4096
    v_mfma_f32_16x16x32_bf16 v[48:51], v[68:71], v[208:211], v[48:51]
    v_mfma_f32_16x16x32_bf16 v[52:55], v[68:71], v[212:215], v[52:55]
    ds_read_b128 v[108:111], v4 offset:5120
    v_mfma_f32_16x16x32_bf16 v[56:59], v[72:75], v[208:211], v[56:59]
    v_mfma_f32_16x16x32_bf16 v[60:63], v[72:75], v[212:215], v[60:63]
    ds_read_b128 v[112:115], v4 offset:10240
    s_waitcnt lgkmcnt(7)
    v_mfma_f32_16x16x32_bf16 v[40:43], v[76:79], v[216:219], v[40:43]
    v_mfma_f32_16x16x32_bf16 v[44:47], v[76:79], v[220:223], v[44:47]
    ds_read_b128 v[116:119], v4 offset:11264
    v_mfma_f32_16x16x32_bf16 v[48:51], v[80:83], v[216:219], v[48:51]
    v_mfma_f32_16x16x32_bf16 v[52:55], v[80:83], v[220:223], v[52:55]
    ds_read_b128 v[64:67], v4 offset:12288
    v_mfma_f32_16x16x32_bf16 v[56:59], v[84:87], v[216:219], v[56:59]
    v_mfma_f32_16x16x32_bf16 v[60:63], v[84:87], v[220:223], v[60:63]
    ds_read_b128 v[68:71], v4 offset:17408
    s_waitcnt lgkmcnt(7)
    v_mfma_f32_16x16x32_bf16 v[40:43], v[88:91], v[224:227], v[40:43]
    v_mfma_f32_16x16x32_bf16 v[44:47], v[88:91], v[228:231], v[44:47]
    ds_read_b128 v[72:75], v4 offset:18432
    v_mfma_f32_16x16x32_bf16 v[48:51], v[92:95], v[224:227], v[48:51]
    v_mfma_f32_16x16x32_bf16 v[52:55], v[92:95], v[228:231], v[52:55]
    ds_read_b128 v[76:79], v4 offset:19456
    v_mfma_f32_16x16x32_bf16 v[56:59], v[96:99], v[224:227], v[56:59]
    v_mfma_f32_16x16x32_bf16 v[60:63], v[96:99], v[228:231], v[60:63]
    ds_read_b128 v[80:83], v4 offset:61440
    s_waitcnt lgkmcnt(7)
    v_mfma_f32_16x16x32_bf16 v[40:43], v[100:103], v[232:235], v[40:43]
    v_mfma_f32_16x16x32_bf16 v[44:47], v[100:103], v[236:239], v[44:47]
    ds_read_b128 v[84:87], v4 offset:62464
    v_mfma_f32_16x16x32_bf16 v[48:51], v[104:107], v[232:235], v[48:51]
    v_mfma_f32_16x16x32_bf16 v[52:55], v[104:107], v[236:239], v[52:55]
    ds_read_b128 v[88:91], v4 offset:63488
    v_mfma_f32_16x16x32_bf16 v[56:59], v[108:111], v[232:235], v[56:59]
    v_mfma_f32_16x16x32_bf16 v[60:63], v[108:111], v[236:239], v[60:63]
    s_waitcnt lgkmcnt(6)
    v_mfma_f32_16x16x32_bf16 v[40:43], v[112:115], v[240:243], v[40:43]
    v_mfma_f32_16x16x32_bf16 v[44:47], v[112:115], v[244:247], v[44:47]
    v_mfma_f32_16x16x32_bf16 v[48:51], v[116:119], v[240:243], v[48:51]
    v_mfma_f32_16x16x32_bf16 v[52:55], v[116:119], v[244:247], v[52:55]
    v_mfma_f32_16x16x32_bf16 v[56:59], v[64:67], v[240:243], v[56:59]
    v_mfma_f32_16x16x32_bf16 v[60:63], v[64:67], v[244:247], v[60:63]
    s_waitcnt lgkmcnt(3)
    s_waitcnt vmcnt(0)
    s_barrier
    s_cmp_lg_u32 s3, 0
    s_cbranch_scc1 L_f4a
    s_mov_b64 exec, 1
    s_cmp_eq_u32 s93, 0
    s_cbranch_scc1 L_f4a_slow
    buffer_store_dword v159, v158, s[24:27], s51 offen offset:0
    s_branch L_f4a_done
L_f4a_slow:
    buffer_store_dword v159, v158, s[24:27], s51 offen offset:0 sc1
L_f4a_done:
    s_mov_b64 exec, -1
L_f4a:
    v_mfma_f32_16x16x32_bf16 v[40:43], v[68:71], v[248:251], v[40:43]
    v_mfma_f32_16x16x32_bf16 v[44:47], v[68:71], v[252:255], v[44:47]
    v_mfma_f32_16x16x32_bf16 v[48:51], v[72:75], v[248:251], v[48:51]
    v_mfma_f32_16x16x32_bf16 v[52:55], v[72:75], v[252:255], v[52:55]
    v_mfma_f32_16x16x32_bf16 v[56:59], v[76:79], v[248:251], v[56:59]
    v_mfma_f32_16x16x32_bf16 v[60:63], v[76:79], v[252:255], v[60:63]
    s_waitcnt lgkmcnt(0)
    v_mfma_f32_16x16x32_bf16 v[40:43], v[80:83], v[136:139], v[40:43]
    v_mfma_f32_16x16x32_bf16 v[44:47], v[80:83], v[140:143], v[44:47]
    v_mfma_f32_16x16x32_bf16 v[48:51], v[84:87], v[136:139], v[48:51]
    v_mfma_f32_16x16x32_bf16 v[52:55], v[84:87], v[140:143], v[52:55]
    v_mfma_f32_16x16x32_bf16 v[56:59], v[88:91], v[136:139], v[56:59]
    v_mfma_f32_16x16x32_bf16 v[60:63], v[88:91], v[140:143], v[60:63]
    buffer_load_dword v157, v158, s[24:27], s50 offen sc1
    s_nop 4
    v_cvt_pk_bf16_f32 v40, v40, v41
    v_cvt_pk_bf16_f32 v41, v42, v43
    v_cvt_pk_bf16_f32 v42, v44, v45
    v_cvt_pk_bf16_f32 v43, v46, v47
    v_pk_max_i16 v40, v40, 0
    v_pk_max_i16 v41, v41, 0
    v_pk_max_i16 v42, v42, 0
    v_pk_max_i16 v43, v43, 0
    v_cvt_pk_bf16_f32 v48, v48, v49
    v_cvt_pk_bf16_f32 v49, v50, v51
    v_cvt_pk_bf16_f32 v50, v52, v53
    v_cvt_pk_bf16_f32 v51, v54, v55
    v_pk_max_i16 v48, v48, 0
    v_pk_max_i16 v49, v49, 0
    v_pk_max_i16 v50, v50, 0
    v_pk_max_i16 v51, v51, 0
    v_permlane16_swap_b32 v40, v42
    v_permlane16_swap_b32 v41, v43
    buffer_store_dwordx4 v[40:43], v2, s[24:27], s43 offen offset:0 sc1
    v_cvt_pk_bf16_f32 v56, v56, v57
    v_cvt_pk_bf16_f32 v57, v58, v59
    v_cvt_pk_bf16_f32 v58, v60, v61
    v_cvt_pk_bf16_f32 v59, v62, v63
    v_pk_max_i16 v56, v56, 0
    v_pk_max_i16 v57, v57, 0
    v_pk_max_i16 v58, v58, 0
    v_pk_max_i16 v59, v59, 0
    v_permlane16_swap_b32 v48, v50
    v_permlane16_swap_b32 v49, v51
    buffer_store_dwordx4 v[48:51], v2, s[24:27], s43 offen offset:1024 sc1
    s_nop 1
    v_permlane16_swap_b32 v56, v58
    v_permlane16_swap_b32 v57, v59
    buffer_store_dwordx4 v[56:59], v2, s[24:27], s43 offen offset:2048 sc1
    s_waitcnt vmcnt(3)
    v_cmp_ne_u32 vcc, s98, v157
    s_nop 1
    s_cbranch_vccnz L_p4a_spin
L_p4a_ok:
    s_add_u32 s44, s46, 0
    s_add_u32 s45, s47, 0
    buffer_load_dwordx4 v[72:75], v2, s[24:27], s44 offen offset:0 sc1
    buffer_load_dwordx4 v[76:79], v2, s[24:27], s45 offen offset:0 sc1
    buffer_load_dwordx4 v[80:83], v2, s[24:27], s44 offen offset:1024 sc1
    buffer_load_dwordx4 v[84:87], v2, s[24:27], s45 offen offset:1024 sc1
    buffer_load_dwordx4 v[88:91], v2, s[24:27], s44 offen offset:2048 sc1
    buffer_load_dwordx4 v[92:95], v2, s[24:27], s45 offen offset:2048 sc1
    buffer_load_dwordx4 v[96:99], v2, s[24:27], s44 offen offset:3072 sc1
    buffer_load_dwordx4 v[100:103], v2, s[24:27], s45 offen offset:3072 sc1
    s_add_u32 s44, s46, 7168
    s_add_u32 s45, s47, 7168
    buffer_load_dwordx4 v[104:107], v2, s[24:27], s44 offen offset:0 sc1
    buffer_load_dwordx4 v[108:111], v2, s[24:27], s45 offen offset:0 sc1
    buffer_load_dwordx4 v[112:115], v2, s[24:27], s44 offen offset:1024 sc1
    buffer_load_dwordx4 v[116:119], v2, s[24:27], s45 offen offset:1024 sc1
    v_lshrrev_b32 v250, 5, v1
    v_and_b32 v251, 31, v1
    v_lshlrev_b32 v252, 4, v250
    s_and_b32 s41, s52, 7
    s_lshl_b32 s41, s41, 7
    s_add_u32 s41, s41, 89088
    v_add_u32 v252, s41, v252
    v_lshrrev_b32 v249, 4, v251
    v_lshlrev_b32 v249, 14, v249
    v_and_b32 v254, 15, v251
    v_lshl_add_u32 v249, v254, 4, v249
    v_lshl_add_u32 v249, v250, 8, v249
    s_lshl_b32 s42, s58, 15
    s_lshl_b32 s41, s52, 10
    s_add_u32 s43, s42, s41
    s_add_u32 s43, s43, 12648448
    s_and_b32 s41, s58, 3
    s_lshl_b32 s41, s41, 7
    s_add_u32 s41, s41, 131072
    v_lshlrev_b32 v254, 2, v251
    v_add_u32 v254, s41, v254
    v_lshlrev_b32 v253, 10, v251
    v_lshl_add_u32 v253, v250, 4, v253
    s_lshl_b32 s41, s52, 6
    s_add_u32 s42, s42, s41
    ds_read_b128 v[224:227], v252 offset:0
    ds_read_b128 v[228:231], v252 offset:32
    ds_read_b128 v[232:235], v252 offset:64
    ds_read_b128 v[236:239], v252 offset:96
    ds_read_b32 v248, v254
    s_waitcnt vmcnt(10)
    v_mfma_f32_32x32x16_bf16 v[8:23], a[0:3], v[72:75], 0
    buffer_load_dwordx4 v[120:123], v2, s[24:27], s44 offen offset:2048 sc1
    buffer_load_dwordx4 v[124:127], v2, s[24:27], s45 offen offset:2048 sc1
    v_mfma_f32_32x32x16_bf16 v[24:39], a[0:3], v[76:79], 0
    v_mfma_f32_32x32x16_bf16 v[40:55], a[4:7], v[72:75], 0
    v_mfma_f32_32x32x16_bf16 v[56:71], a[4:7], v[76:79], 0
    s_waitcnt lgkmcnt(0)
    v_mul_f32 v224, v248, v224
    v_mul_f32 v225, v248, v225
    s_waitcnt vmcnt(10)
    s_barrier
    s_cmp_lg_u32 s3, 0
    s_cbranch_scc1 L_f4b
    s_mov_b64 exec, 1
    s_cmp_eq_u32 s93, 0
    s_cbranch_scc1 L_f4b_slow
    buffer_store_dword v159, v158, s[24:27], s51 offen offset:128
    s_branch L_f4b_done
L_f4b_slow:
    buffer_store_dword v159, v158, s[24:27], s51 offen offset:128 sc1
L_f4b_done:
    s_mov_b64 exec, -1
L_f4b:
    v_mfma_f32_32x32x16_bf16 v[8:23], a[8:11], v[80:83], v[8:23]
    buffer_load_dwordx4 v[128:131], v2, s[24:27], s44 offen offset:3072 sc1
    buffer_load_dwordx4 v[132:135], v2, s[24:27], s45 offen offset:3072 sc1
    v_mfma_f32_32x32x16_bf16 v[24:39], a[8:11], v[84:87], v[24:39]
    v_mfma_f32_32x32x16_bf16 v[40:55], a[12:15], v[80:83], v[40:55]
    v_mfma_f32_32x32x16_bf16 v[56:71], a[12:15], v[84:87], v[56:71]
    v_mul_f32 v226, v248, v226
    v_mul_f32 v227, v248, v227
    v_mul_f32 v228, v248, v228
    s_waitcnt vmcnt(10)
    v_mfma_f32_32x32x16_bf16 v[8:23], a[16:19], v[88:91], v[8:23]
    s_add_u32 s44, s46, 14336
    s_add_u32 s45, s47, 14336
    buffer_load_dwordx4 v[136:139], v2, s[24:27], s44 offen offset:0 sc1
    buffer_load_dwordx4 v[140:143], v2, s[24:27], s45 offen offset:0 sc1
    v_mfma_f32_32x32x16_bf16 v[24:39], a[16:19], v[92:95], v[24:39]
    v_mfma_f32_32x32x16_bf16 v[40:55], a[20:23], v[88:91], v[40:55]
    v_mfma_f32_32x32x16_bf16 v[56:71], a[20:23], v[92:95], v[56:71]
    v_mul_f32 v229, v248, v229
    v_mul_f32 v230, v248, v230
    v_mul_f32 v231, v248, v231
    s_waitcnt vmcnt(10)
    v_mfma_f32_32x32x16_bf16 v[8:23], a[24:27], v[96:99], v[8:23]
    buffer_load_dwordx4 v[144:147], v2, s[24:27], s44 offen offset:1024 sc1
    buffer_load_dwordx4 v[148:151], v2, s[24:27], s45 offen offset:1024 sc1
    v_mfma_f32_32x32x16_bf16 v[24:39], a[24:27], v[100:103], v[24:39]
    v_mfma_f32_32x32x16_bf16 v[40:55], a[28:31], v[96:99], v[40:55]
    v_mfma_f32_32x32x16_bf16 v[56:71], a[28:31], v[100:103], v[56:71]
    v_mul_f32 v232, v248, v232
    v_mul_f32 v233, v248, v233
    v_mul_f32 v234, v248, v234
    s_waitcnt vmcnt(10)
    v_mfma_f32_32x32x16_bf16 v[8:23], a[56:59], v[104:107], v[8:23]
    buffer_load_dword v157, v158, s[24:27], s50 offen offset:128 sc1
    buffer_load_dwordx4 v[72:75], v2, s[24:27], s44 offen offset:2048 sc1
    buffer_load_dwordx4 v[76:79], v2, s[24:27], s45 offen offset:2048 sc1
    v_mfma_f32_32x32x16_bf16 v[24:39], a[56:59], v[108:111], v[24:39]
    v_mfma_f32_32x32x16_bf16 v[40:55], a[60:63], v[104:107], v[40:55]
    v_mfma_f32_32x32x16_bf16 v[56:71], a[60:63], v[108:111], v[56:71]
    v_mul_f32 v235, v248, v235
    v_mul_f32 v236, v248, v236
    v_mul_f32 v237, v248, v237
    s_waitcnt vmcnt(11)
    v_mfma_f32_32x32x16_bf16 v[8:23], a[64:67], v[112:115], v[8:23]
    buffer_load_dwordx4 v[80:83], v2, s[24:27], s44 offen offset:3072 sc1
    buffer_load_dwordx4 v[84:87], v2, s[24:27], s45 offen offset:3072 sc1
    v_mfma_f32_32x32x16_bf16 v[24:39], a[64:67], v[116:119], v[24:39]
    v_mfma_f32_32x32x16_bf16 v[40:55], a[68:71], v[112:115], v[40:55]
    v_mfma_f32_32x32x16_bf16 v[56:71], a[68:71], v[116:119], v[56:71]
    v_mul_f32 v238, v248, v238
    v_mul_f32 v239, v248, v239
    s_xor_b32 s56, s3, 1
    s_waitcnt vmcnt(11)
    v_mfma_f32_32x32x16_bf16 v[8:23], a[72:75], v[120:123], v[8:23]
    s_add_u32 s44, s46, 21504
    s_add_u32 s45, s47, 21504
    buffer_load_dwordx4 v[88:91], v2, s[24:27], s44 offen offset:0 sc1
    buffer_load_dwordx4 v[92:95], v2, s[24:27], s45 offen offset:0 sc1
    v_mfma_f32_32x32x16_bf16 v[24:39], a[72:75], v[124:127], v[24:39]
    v_mfma_f32_32x32x16_bf16 v[40:55], a[76:79], v[120:123], v[40:55]
    v_mfma_f32_32x32x16_bf16 v[56:71], a[76:79], v[124:127], v[56:71]
    s_mul_i32 s56, s56, 12288
    s_add_u32 s56, s56, 0
    v_add_u32 v4, s56, v2
    s_waitcnt vmcnt(11)
    v_mfma_f32_32x32x16_bf16 v[8:23], a[80:83], v[128:131], v[8:23]
    buffer_load_dwordx4 v[96:99], v2, s[24:27], s44 offen offset:1024 sc1
    buffer_load_dwordx4 v[100:103], v2, s[24:27], s45 offen offset:1024 sc1
    v_mfma_f32_32x32x16_bf16 v[24:39], a[80:83], v[132:135], v[24:39]
    v_mfma_f32_32x32x16_bf16 v[40:55], a[84:87], v[128:131], v[40:55]
    v_mfma_f32_32x32x16_bf16 v[56:71], a[84:87], v[132:135], v[56:71]
    s_xor_b32 s56, s3, 2
    s_mul_i32 s56, s56, 12288
    s_add_u32 s56, s56, 4096
    s_waitcnt vmcnt(11)
    v_mfma_f32_32x32x16_bf16 v[8:23], a[112:115], v[136:139], v[8:23]
    buffer_load_dwordx4 v[104:107], v2, s[24:27], s44 offen offset:2048 sc1
    buffer_load_dwordx4 v[108:111], v2, s[24:27], s45 offen offset:2048 sc1
    v_mfma_f32_32x32x16_bf16 v[24:39], a[112:115], v[140:143], v[24:39]
    v_mfma_f32_32x32x16_bf16 v[40:55], a[116:119], v[136:139], v[40:55]
    v_mfma_f32_32x32x16_bf16 v[56:71], a[116:119], v[140:143], v[56:71]
    v_add_u32 v5, s56, v2
    s_xor_b32 s56, s3, 3
    s_mul_i32 s56, s56, 12288
    s_waitcnt vmcnt(11)
    v_mfma_f32_32x32x16_bf16 v[8:23], a[120:123], v[144:147], v[8:23]
    buffer_load_dwordx4 v[112:115], v2, s[24:27], s44 offen offset:3072 sc1
    buffer_load_dwordx4 v[116:119], v2, s[24:27], s45 offen offset:3072 sc1
    v_mfma_f32_32x32x16_bf16 v[24:39], a[120:123], v[148:151], v[24:39]
    v_mfma_f32_32x32x16_bf16 v[40:55], a[124:127], v[144:147], v[40:55]
    v_mfma_f32_32x32x16_bf16 v[56:71], a[124:127], v[148:151], v[56:71]
    s_add_u32 s56, s56, 8192
    v_add_u32 v6, s56, v2
    s_mul_i32 s56, s3, 12288
    s_waitcnt vmcnt(10)
    v_cmp_ne_u32 vcc, s98, v157
    v_mfma_f32_32x32x16_bf16 v[8:23], a[128:131], v[72:75], v[8:23]
    v_mfma_f32_32x32x16_bf16 v[24:39], a[128:131], v[76:79], v[24:39]
    s_cbranch_vccnz L_p4b_spin
L_p4b_ok:
    s_add_u32 s44, s46, 4096
    s_add_u32 s45, s47, 4096
    buffer_load_dwordx4 v[120:123], v2, s[24:27], s44 offen offset:0 sc1
    buffer_load_dwordx4 v[124:127], v2, s[24:27], s45 offen offset:0 sc1
    v_mfma_f32_32x32x16_bf16 v[40:55], a[132:135], v[72:75], v[40:55]
    v_mfma_f32_32x32x16_bf16 v[56:71], a[132:135], v[76:79], v[56:71]
    v_add_u32 v3, s56, v2
    s_waitcnt vmcnt(10)
    v_mfma_f32_32x32x16_bf16 v[8:23], a[136:139], v[80:83], v[8:23]
    buffer_load_dwordx4 v[128:131], v2, s[24:27], s44 offen offset:1024 sc1
    buffer_load_dwordx4 v[132:135], v2, s[24:27], s45 offen offset:1024 sc1
    v_mfma_f32_32x32x16_bf16 v[24:39], a[136:139], v[84:87], v[24:39]
    v_mfma_f32_32x32x16_bf16 v[40:55], a[140:143], v[80:83], v[40:55]
    v_mfma_f32_32x32x16_bf16 v[56:71], a[140:143], v[84:87], v[56:71]
    s_waitcnt vmcnt(10)
    v_mfma_f32_32x32x16_bf16 v[8:23], a[168:171], v[88:91], v[8:23]
    buffer_load_dwordx4 v[136:139], v2, s[24:27], s44 offen offset:2048 sc1
    buffer_load_dwordx4 v[140:143], v2, s[24:27], s45 offen offset:2048 sc1
    v_mfma_f32_32x32x16_bf16 v[24:39], a[168:171], v[92:95], v[24:39]
    v_mfma_f32_32x32x16_bf16 v[40:55], a[172:175], v[88:91], v[40:55]
    v_mfma_f32_32x32x16_bf16 v[56:71], a[172:175], v[92:95], v[56:71]
    s_waitcnt vmcnt(10)
    v_mfma_f32_32x32x16_bf16 v[8:23], a[176:179], v[96:99], v[8:23]
    s_add_u32 s44, s46, 11264
    s_add_u32 s45, s47, 11264
    buffer_load_dwordx4 v[144:147], v2, s[24:27], s44 offen offset:0 sc1
    buffer_load_dwordx4 v[148:151], v2, s[24:27], s45 offen offset:0 sc1
    v_mfma_f32_32x32x16_bf16 v[24:39], a[176:179], v[100:103], v[24:39]
    v_mfma_f32_32x32x16_bf16 v[40:55], a[180:183], v[96:99], v[40:55]
    v_mfma_f32_32x32x16_bf16 v[56:71], a[180:183], v[100:103], v[56:71]
    s_waitcnt vmcnt(10)
    v_mfma_f32_32x32x16_bf16 v[8:23], a[184:187], v[104:107], v[8:23]
    buffer_load_dwordx4 v[72:75], v2, s[24:27], s44 offen offset:1024 sc1
    buffer_load_dwordx4 v[76:79], v2, s[24:27], s45 offen offset:1024 sc1
    v_mfma_f32_32x32x16_bf16 v[24:39], a[184:187], v[108:111], v[24:39]
    v_mfma_f32_32x32x16_bf16 v[40:55], a[188:191], v[104:107], v[40:55]
    buffer_load_dwordx4 v[240:243], v249, s[24:27], s43 offen offset:0 sc1
    v_mfma_f32_32x32x16_bf16 v[56:71], a[188:191], v[108:111], v[56:71]
    s_waitcnt vmcnt(11)
    v_mfma_f32_32x32x16_bf16 v[8:23], a[192:195], v[112:115], v[8:23]
    buffer_load_dwordx4 v[80:83], v2, s[24:27], s44 offen offset:2048 sc1
    buffer_load_dwordx4 v[84:87], v2, s[24:27], s45 offen offset:2048 sc1
    v_mfma_f32_32x32x16_bf16 v[24:39], a[192:195], v[116:119], v[24:39]
    v_mfma_f32_32x32x16_bf16 v[40:55], a[196:199], v[112:115], v[40:55]
    buffer_load_dwordx4 v[244:247], v249, s[24:27], s43 offen offset:512 sc1
    v_mfma_f32_32x32x16_bf16 v[56:71], a[196:199], v[116:119], v[56:71]
    s_waitcnt vmcnt(12)
    v_mfma_f32_32x32x16_bf16 v[8:23], a[32:35], v[120:123], v[8:23]
    s_add_u32 s44, s46, 18432
    s_add_u32 s45, s47, 18432
    buffer_load_dwordx4 v[88:91], v2, s[24:27], s44 offen offset:0 sc1
    buffer_load_dwordx4 v[92:95], v2, s[24:27], s45 offen offset:0 sc1
    v_mfma_f32_32x32x16_bf16 v[24:39], a[32:35], v[124:127], v[24:39]
    v_mfma_f32_32x32x16_bf16 v[40:55], a[36:39], v[120:123], v[40:55]
    v_mfma_f32_32x32x16_bf16 v[56:71], a[36:39], v[124:127], v[56:71]
    s_waitcnt vmcnt(12)
    v_mfma_f32_32x32x16_bf16 v[8:23], a[40:43], v[128:131], v[8:23]
    buffer_load_dwordx4 v[96:99], v2, s[24:27], s44 offen offset:1024 sc1
    buffer_load_dwordx4 v[100:103], v2, s[24:27], s45 offen offset:1024 sc1
    v_mfma_f32_32x32x16_bf16 v[24:39], a[40:43], v[132:135], v[24:39]
    v_mfma_f32_32x32x16_bf16 v[40:55], a[44:47], v[128:131], v[40:55]
    v_mfma_f32_32x32x16_bf16 v[56:71], a[44:47], v[132:135], v[56:71]
    s_waitcnt vmcnt(12)
    v_mfma_f32_32x32x16_bf16 v[8:23], a[48:51], v[136:139], v[8:23]
    buffer_load_dwordx4 v[104:107], v2, s[24:27], s44 offen offset:2048 sc1
    buffer_load_dwordx4 v[108:111], v2, s[24:27], s45 offen offset:2048 sc1
    v_mfma_f32_32x32x16_bf16 v[24:39], a[48:51], v[140:143], v[24:39]
    v_mfma_f32_32x32x16_bf16 v[40:55], a[52:55], v[136:139], v[40:55]
    v_mfma_f32_32x32x16_bf16 v[56:71], a[52:55], v[140:143], v[56:71]
    s_waitcnt vmcnt(12)
    v_mfma_f32_32x32x16_bf16 v[8:23], a[88:91], v[144:147], v[8:23]
    s_add_u32 s44, s46, 25600
    s_add_u32 s45, s47, 25600
    buffer_load_dwordx4 v[112:115], v2, s[24:27], s44 offen offset:0 sc1
    buffer_load_dwordx4 v[116:119], v2, s[24:27], s45 offen offset:0 sc1
    v_mfma_f32_32x32x16_bf16 v[24:39], a[88:91], v[148:151], v[24:39]
    v_mfma_f32_32x32x16_bf16 v[40:55], a[92:95], v[144:147], v[40:55]
    v_mfma_f32_32x32x16_bf16 v[56:71], a[92:95], v[148:151], v[56:71]
    s_waitcnt vmcnt(12)
    v_mfma_f32_32x32x16_bf16 v[8:23], a[96:99], v[72:75], v[8:23]
    buffer_load_dwordx4 v[120:123], v2, s[24:27], s44 offen offset:1024 sc1
    buffer_load_dwordx4 v[124:127], v2, s[24:27], s45 offen offset:1024 sc1
    v_mfma_f32_32x32x16_bf16 v[24:39], a[96:99], v[76:79], v[24:39]
    v_mfma_f32_32x32x16_bf16 v[40:55], a[100:103], v[72:75], v[40:55]
    v_mfma_f32_32x32x16_bf16 v[56:71], a[100:103], v[76:79], v[56:71]
    s_waitcnt vmcnt(11)
    v_mfma_f32_32x32x16_bf16 v[8:23], a[104:107], v[80:83], v[8:23]
    buffer_load_dwordx4 v[128:131], v2, s[24:27], s44 offen offset:2048 sc1
    buffer_load_dwordx4 v[132:135], v2, s[24:27], s45 offen offset:2048 sc1
    v_mfma_f32_32x32x16_bf16 v[24:39], a[104:107], v[84:87], v[24:39]
    v_mfma_f32_32x32x16_bf16 v[40:55], a[108:111], v[80:83], v[40:55]
    v_mfma_f32_32x32x16_bf16 v[56:71], a[108:111], v[84:87], v[56:71]
    s_waitcnt vmcnt(10)
    v_mfma_f32_32x32x16_bf16 v[8:23], a[144:147], v[88:91], v[8:23]
    v_mfma_f32_32x32x16_bf16 v[24:39], a[144:147], v[92:95], v[24:39]
    v_mfma_f32_32x32x16_bf16 v[40:55], a[148:151], v[88:91], v[40:55]
    v_mfma_f32_32x32x16_bf16 v[56:71], a[148:151], v[92:95], v[56:71]
    s_waitcnt vmcnt(8)
    v_mfma_f32_32x32x16_bf16 v[8:23], a[152:155], v[96:99], v[8:23]
    v_mfma_f32_32x32x16_bf16 v[24:39], a[152:155], v[100:103], v[24:39]
    v_mfma_f32_32x32x16_bf16 v[40:55], a[156:159], v[96:99], v[40:55]
    v_mfma_f32_32x32x16_bf16 v[56:71], a[156:159], v[100:103], v[56:71]
    s_waitcnt vmcnt(6)
    v_mfma_f32_32x32x16_bf16 v[8:23], a[160:163], v[104:107], v[8:23]
    v_mfma_f32_32x32x16_bf16 v[24:39], a[160:163], v[108:111], v[24:39]
    v_mfma_f32_32x32x16_bf16 v[40:55], a[164:167], v[104:107], v[40:55]
    v_mfma_f32_32x32x16_bf16 v[56:71], a[164:167], v[108:111], v[56:71]
    s_waitcnt vmcnt(4)
    v_mfma_f32_32x32x16_bf16 v[8:23], a[200:203], v[112:115], v[8:23]
    v_mfma_f32_32x32x16_bf16 v[24:39], a[200:203], v[116:119], v[24:39]
    v_mfma_f32_32x32x16_bf16 v[40:55], a[204:207], v[112:115], v[40:55]
    v_mfma_f32_32x32x16_bf16 v[56:71], a[204:207], v[116:119], v[56:71]
    s_waitcnt vmcnt(2)
    v_mfma_f32_32x32x16_bf16 v[8:23], a[208:211], v[120:123], v[8:23]
    v_mfma_f32_32x32x16_bf16 v[24:39], a[208:211], v[124:127], v[24:39]
    v_mfma_f32_32x32x16_bf16 v[40:55], a[212:215], v[120:123], v[40:55]
    v_mfma_f32_32x32x16_bf16 v[56:71], a[212:215], v[124:127], v[56:71]
    s_waitcnt vmcnt(0)
    v_mfma_f32_32x32x16_bf16 v[8:23], a[216:219], v[128:131], v[8:23]
    v_mfma_f32_32x32x16_bf16 v[24:39], a[216:219], v[132:135], v[24:39]
    v_mfma_f32_32x32x16_bf16 v[40:55], a[220:223], v[128:131], v[40:55]
    v_mfma_f32_32x32x16_bf16 v[56:71], a[220:223], v[132:135], v[56:71]
    v_lshlrev_b32 v160, 16, v240
    v_and_b32 v161, 0xffff0000, v240
    v_lshlrev_b32 v162, 16, v241
    v_and_b32 v163, 0xffff0000, v241
    v_lshlrev_b32 v164, 16, v242
    v_and_b32 v165, 0xffff0000, v242
    v_lshlrev_b32 v166, 16, v243
    v_and_b32 v167, 0xffff0000, v243
    v_lshlrev_b32 v168, 16, v244
    v_and_b32 v169, 0xffff0000, v244
    ds_write_b128 v4, v[24:27] offset:0
    ds_write_b128 v4, v[28:31] offset:1024
    ds_write_b128 v4, v[32:35] offset:2048
    ds_write_b128 v4, v[36:39] offset:3072
    ds_write_b128 v5, v[40:43] offset:0
    ds_write_b128 v5, v[44:47] offset:1024
    ds_write_b128 v5, v[48:51] offset:2048
    ds_write_b128 v5, v[52:55] offset:3072
    ds_write_b128 v6, v[56:59] offset:0
    ds_write_b128 v6, v[60:63] offset:1024
    ds_write_b128 v6, v[64:67] offset:2048
    ds_write_b128 v6, v[68:71] offset:3072
    v_lshlrev_b32 v170, 16, v245
    v_and_b32 v171, 0xffff0000, v245
    v_lshlrev_b32 v172, 16, v246
    v_and_b32 v173, 0xffff0000, v246
    v_lshlrev_b32 v174, 16, v247
    v_and_b32 v175, 0xffff0000, v247
    s_waitcnt lgkmcnt(0)
    s_barrier
    ds_read_b128 v[176:179], v3 offset:0
    ds_read_b128 v[180:183], v3 offset:1024
    ds_read_b128 v[184:187], v3 offset:2048
    ds_read_b128 v[188:191], v3 offset:3072
    ds_read_b128 v[192:195], v3 offset:4096
    ds_read_b128 v[196:199], v3 offset:5120
    ds_read_b128 v[200:203], v3 offset:6144
    ds_read_b128 v[204:207], v3 offset:7168
    ds_read_b128 v[208:211], v3 offset:8192
    ds_read_b128 v[212:215], v3 offset:9216
    ds_read_b128 v[216:219], v3 offset:10240
    ds_read_b128 v[220:223], v3 offset:11264
    s_waitcnt lgkmcnt(8)
    v_pk_add_f32 v[8:9], v[8:9], v[176:177]
    v_pk_add_f32 v[10:11], v[10:11], v[178:179]
    v_pk_add_f32 v[12:13], v[12:13], v[180:181]
    v_pk_add_f32 v[14:15], v[14:15], v[182:183]
    v_pk_add_f32 v[16:17], v[16:17], v[184:185]
    v_pk_add_f32 v[18:19], v[18:19], v[186:187]
    v_pk_add_f32 v[20:21], v[20:21], v[188:189]
    v_pk_add_f32 v[22:23], v[22:23], v[190:191]
    s_waitcnt lgkmcnt(4)
    v_pk_add_f32 v[8:9], v[8:9], v[192:193]
    v_pk_add_f32 v[10:11], v[10:11], v[194:195]
    v_pk_add_f32 v[12:13], v[12:13], v[196:197]
    v_pk_add_f32 v[14:15], v[14:15], v[198:199]
    v_pk_add_f32 v[16:17], v[16:17], v[200:201]
    v_pk_add_f32 v[18:19], v[18:19], v[202:203]
    v_pk_add_f32 v[20:21], v[20:21], v[204:205]
    v_pk_add_f32 v[22:23], v[22:23], v[206:207]
    s_waitcnt lgkmcnt(0)
    v_pk_add_f32 v[8:9], v[8:9], v[208:209]
    v_pk_add_f32 v[10:11], v[10:11], v[210:211]
    v_pk_add_f32 v[12:13], v[12:13], v[212:213]
    v_pk_add_f32 v[14:15], v[14:15], v[214:215]
    v_pk_add_f32 v[16:17], v[16:17], v[216:217]
    v_pk_add_f32 v[18:19], v[18:19], v[218:219]
    v_pk_add_f32 v[20:21], v[20:21], v[220:221]
    v_pk_add_f32 v[22:23], v[22:23], v[222:223]
    v_pk_fma_f32 v[8:9], v[224:225], v[8:9], v[160:161]
    v_pk_fma_f32 v[10:11], v[226:227], v[10:11], v[162:163]
    v_pk_fma_f32 v[12:13], v[228:229], v[12:13], v[164:165]
    v_pk_fma_f32 v[14:15], v[230:231], v[14:15], v[166:167]
    v_pk_fma_f32 v[16:17], v[232:233], v[16:17], v[168:169]
    v_pk_fma_f32 v[18:19], v[234:235], v[18:19], v[170:171]
    v_pk_fma_f32 v[20:21], v[236:237], v[20:21], v[172:173]
    v_pk_fma_f32 v[22:23], v[238:239], v[22:23], v[174:175]
    v_cvt_pk_bf16_f32 v176, v8, v9
    v_cvt_pk_bf16_f32 v177, v10, v11
    v_cvt_pk_bf16_f32 v178, v12, v13
    v_cvt_pk_bf16_f32 v179, v14, v15
    v_cvt_pk_bf16_f32 v180, v16, v17
    v_cvt_pk_bf16_f32 v181, v18, v19
    v_cvt_pk_bf16_f32 v182, v20, v21
    v_cvt_pk_bf16_f32 v183, v22, v23
    s_nop 0
    v_permlane32_swap_b32 v176, v178
    v_permlane32_swap_b32 v177, v179
    buffer_store_dwordx4 v[176:179], v253, s[32:35], s42 offen offset:0
    v_permlane32_swap_b32 v180, v182
    v_permlane32_swap_b32 v181, v183
    buffer_store_dwordx4 v[180:183], v253, s[32:35], s42 offen offset:32
    s_endpgm
L_att_fallback:
    s_mov_b32 s42, 0
    s_mov_b32 s43, s47
    v_mov_b32 v6, 0xff800000
    v_mov_b32 v7, 0xff800000
L_att_maxloop:
    buffer_load_dwordx4 v[16:19], v2, s[24:27], s43 offen sc1
    s_add_u32 s43, s43, 2048
    s_waitcnt vmcnt(0)
    v_mfma_f32_32x32x16_bf16 v[36:51], v[16:19], v[8:11], 0
    v_mfma_f32_32x32x16_bf16 v[52:67], v[16:19], v[12:15], 0
    s_nop 10
    v_max3_f32 v6, v6, v36, v37
    v_max3_f32 v6, v6, v38, v39
    v_max3_f32 v6, v6, v40, v41
    v_max3_f32 v6, v6, v42, v43
    v_max3_f32 v6, v6, v44, v45
    v_max3_f32 v6, v6, v46, v47
    v_max3_f32 v6, v6, v48, v49
    v_max3_f32 v6, v6, v50, v51
    v_max3_f32 v7, v7, v52, v53
    v_max3_f32 v7, v7, v54, v55
    v_max3_f32 v7, v7, v56, v57
    v_max3_f32 v7, v7, v58, v59
    v_max3_f32 v7, v7, v60, v61
    v_max3_f32 v7, v7, v62, v63
    v_max3_f32 v7, v7, v64, v65
    v_max3_f32 v7, v7, v66, v67
    s_add_u32 s42, s42, 1
    s_cmp_lt_u32 s42, 64
    s_cbranch_scc1 L_att_maxloop
    s_nop 0
    v_permlane32_swap_b32 v6, v7
    v_max_f32 v6, v6, v7
    v_mov_b32 v7, v6
    s_nop 1
    v_permlane32_swap_b32 v6, v7
    v_sub_f32 v6, 0, v6
    v_sub_f32 v7, 0, v7
    v_mov_b32 v108, v6
    v_mov_b32 v124, v7
    v_mov_b32 v76, 0
    v_mov_b32 v92, 0
    v_mov_b32 v109, v6
    v_mov_b32 v125, v7
    v_mov_b32 v77, 0
    v_mov_b32 v93, 0
    v_mov_b32 v110, v6
    v_mov_b32 v126, v7
    v_mov_b32 v78, 0
    v_mov_b32 v94, 0
    v_mov_b32 v111, v6
    v_mov_b32 v127, v7
    v_mov_b32 v79, 0
    v_mov_b32 v95, 0
    v_mov_b32 v112, v6
    v_mov_b32 v128, v7
    v_mov_b32 v80, 0
    v_mov_b32 v96, 0
    v_mov_b32 v113, v6
    v_mov_b32 v129, v7
    v_mov_b32 v81, 0
    v_mov_b32 v97, 0
    v_mov_b32 v114, v6
    v_mov_b32 v130, v7
    v_mov_b32 v82, 0
    v_mov_b32 v98, 0
    v_mov_b32 v115, v6
    v_mov_b32 v131, v7
    v_mov_b32 v83, 0
    v_mov_b32 v99, 0
    v_mov_b32 v116, v6
    v_mov_b32 v132, v7
    v_mov_b32 v84, 0
    v_mov_b32 v100, 0
    v_mov_b32 v117, v6
    v_mov_b32 v133, v7
    v_mov_b32 v85, 0
    v_mov_b32 v101, 0
    v_mov_b32 v118, v6
    v_mov_b32 v134, v7
    v_mov_b32 v86, 0
    v_mov_b32 v102, 0
    v_mov_b32 v119, v6
    v_mov_b32 v135, v7
    v_mov_b32 v87, 0
    v_mov_b32 v103, 0
    v_mov_b32 v120, v6
    v_mov_b32 v136, v7
    v_mov_b32 v88, 0
    v_mov_b32 v104, 0
    v_mov_b32 v121, v6
    v_mov_b32 v137, v7
    v_mov_b32 v89, 0
    v_mov_b32 v105, 0
    v_mov_b32 v122, v6
    v_mov_b32 v138, v7
    v_mov_b32 v90, 0
    v_mov_b32 v106, 0
    v_mov_b32 v123, v6
    v_mov_b32 v139, v7
    v_mov_b32 v91, 0
    v_mov_b32 v107, 0
    s_mov_b32 s42, 0
    s_mov_b32 s43, s47
L_att_redo:
    buffer_load_dwordx4 v[16:19], v2, s[24:27], s43 offen sc1
    s_mov_b64 exec, s[48:49]
    buffer_load_dwordx4 v[20:23], v3, s[24:27], s43 offen sc1
    buffer_load_dwordx4 v[24:27], v3, s[24:27], s43 offen offset:512 sc1
    s_mov_b64 exec, -1
    s_add_u32 s43, s43, 2048
    s_waitcnt vmcnt(0)
    v_mfma_f32_32x32x16_bf16 v[36:51], v[16:19], v[8:11], v[108:123]
    v_mfma_f32_32x32x16_bf16 v[52:67], v[16:19], v[12:15], v[124:139]
    s_nop 10
    v_exp_f32 v36, v36
    v_exp_f32 v37, v37
    v_exp_f32 v38, v38
    v_exp_f32 v39, v39
    v_exp_f32 v40, v40
    v_exp_f32 v41, v41
    v_exp_f32 v42, v42
    v_exp_f32 v43, v43
    v_exp_f32 v44, v44
    v_exp_f32 v45, v45
    v_exp_f32 v46, v46
    v_exp_f32 v47, v47
    v_exp_f32 v48, v48
    v_exp_f32 v49, v49
    v_exp_f32 v50, v50
    v_exp_f32 v51, v51
    s_nop 0
    v_cvt_pk_bf16_f32 v68, v36, v37
    v_cvt_pk_bf16_f32 v69, v38, v39
    v_cvt_pk_bf16_f32 v70, v40, v41
    v_cvt_pk_bf16_f32 v71, v42, v43
    v_cvt_pk_bf16_f32 v72, v44, v45
    v_cvt_pk_bf16_f32 v73, v46, v47
    v_cvt_pk_bf16_f32 v74, v48, v49
    v_cvt_pk_bf16_f32 v75, v50, v51
    s_nop 1
    v_mfma_f32_32x32x16_bf16 v[76:91], v[20:23], v[68:71], v[76:91]
    v_mfma_f32_32x32x16_bf16 v[76:91], v[24:27], v[72:75], v[76:91]
    v_exp_f32 v52, v52
    v_exp_f32 v53, v53
    v_exp_f32 v54, v54
    v_exp_f32 v55, v55
    v_exp_f32 v56, v56
    v_exp_f32 v57, v57
    v_exp_f32 v58, v58
    v_exp_f32 v59, v59
    v_exp_f32 v60, v60
    v_exp_f32 v61, v61
    v_exp_f32 v62, v62
    v_exp_f32 v63, v63
    v_exp_f32 v64, v64
    v_exp_f32 v65, v65
    v_exp_f32 v66, v66
    v_exp_f32 v67, v67
    s_nop 0
    v_cvt_pk_bf16_f32 v68, v52, v53
    v_cvt_pk_bf16_f32 v69, v54, v55
    v_cvt_pk_bf16_f32 v70, v56, v57
    v_cvt_pk_bf16_f32 v71, v58, v59
    v_cvt_pk_bf16_f32 v72, v60, v61
    v_cvt_pk_bf16_f32 v73, v62, v63
    v_cvt_pk_bf16_f32 v74, v64, v65
    v_cvt_pk_bf16_f32 v75, v66, v67
    s_nop 1
    v_mfma_f32_32x32x16_bf16 v[92:107], v[20:23], v[68:71], v[92:107]
    v_mfma_f32_32x32x16_bf16 v[92:107], v[24:27], v[72:75], v[92:107]
    s_add_u32 s42, s42, 1
    s_cmp_lt_u32 s42, 64
    s_cbranch_scc1 L_att_redo
    s_nop 10
    s_branch L_att_fin
L_zspin:
    s_load_dword s98, s[48:49], 64
    s_waitcnt lgkmcnt(0)
    s_cmp_lg_u32 s98, 0
    s_cbranch_scc1 L_zpoll_out
    s_sleep 6
    s_load_dword s98, s[48:49], 128
    s_waitcnt lgkmcnt(0)
    s_cmp_lg_u32 s98, 0
    s_cbranch_scc1 L_zpoll_out
    s_sleep 6
    s_load_dword s98, s[48:49], 192
    s_waitcnt lgkmcnt(0)
    s_cmp_lg_u32 s98, 0
    s_cbranch_scc1 L_zpoll_out
    s_sleep 6
    s_mov_b32 s4, 0x40000
    v_mov_b32 v14, 0
L_zspin2:
    buffer_load_dword v13, v14, s[48:51], 0 offen sc1
    s_waitcnt vmcnt(0)
    v_readfirstlane_b32 s98, v13
    s_sub_u32 s4, s4, 1
    s_cbranch_scc1 L_zpoll_out
    s_sleep 8
    s_cmp_eq_u32 s98, 0
    s_cbranch_scc1 L_zspin2
    s_branch L_zpoll_out
L_mod_spin:
    s_mov_b32 s39, 0x40000
L_mod_spin2:
    s_lshl_b32 s38, s3, 11
    s_add_u32 s38, s38, 32768
    buffer_load_dwordx4 v[24:27], v2, s[24:27], s38 offen offset:0 sc1
    buffer_load_dwordx4 v[28:31], v2, s[24:27], s38 offen offset:1024 sc1
    s_add_u32 s38, s38, 8192
    buffer_load_dwordx4 v[32:35], v2, s[24:27], s38 offen offset:0 sc1
    buffer_load_dwordx4 v[36:39], v2, s[24:27], s38 offen offset:1024 sc1
    s_add_u32 s38, s38, 8192
    buffer_load_dwordx4 v[40:43], v2, s[24:27], s38 offen offset:0 sc1
    buffer_load_dwordx4 v[44:47], v2, s[24:27], s38 offen offset:1024 sc1
    s_add_u32 s38, s38, 8192
    buffer_load_dwordx4 v[48:51], v2, s[24:27], s38 offen offset:0 sc1
    buffer_load_dwordx4 v[52:55], v2, s[24:27], s38 offen offset:1024 sc1
    s_sub_u32 s39, s39, 1
    s_waitcnt vmcnt(0)
    v_and_b32 v252, v25, v27
    v_or_b32 v253, v25, v27
    v_bitop3_b32 v252, v252, v29, v31 bitop3:0x80
    v_or3_b32 v253, v253, v29, v31
    v_bitop3_b32 v252, v252, v33, v35 bitop3:0x80
    v_or3_b32 v253, v253, v33, v35
    v_bitop3_b32 v252, v252, v37, v39 bitop3:0x80
    v_or3_b32 v253, v253, v37, v39
    v_bitop3_b32 v252, v252, v41, v43 bitop3:0x80
    v_or3_b32 v253, v253, v41, v43
    v_bitop3_b32 v252, v252, v45, v47 bitop3:0x80
    v_or3_b32 v253, v253, v45, v47
    v_bitop3_b32 v252, v252, v49, v51 bitop3:0x80
    v_or3_b32 v253, v253, v49, v51
    v_bitop3_b32 v252, v252, v53, v55 bitop3:0x80
    v_or3_b32 v253, v253, v53, v55
    v_xor_b32 v252, s98, v252
    v_xor_b32 v253, s98, v253
    v_or_b32 v252, v252, v253
    v_cmp_ne_u32 vcc, 0, v252
    s_cbranch_scc1 L_mod_ok
    s_sleep 4
    s_cbranch_vccnz L_mod_spin2
    s_branch L_mod_ok
L_xid_retry:
    s_mov_b32 s39, 0x40000
    s_mov_b32 s53, 28377088
L_xid_spin:
    buffer_load_dwordx4 v[150:153], v155, s[24:27], s53 offen sc1
    s_sub_u32 s39, s39, 1
    s_waitcnt vmcnt(0)
    v_xor_b32 v150, s98, v150
    v_xor_b32 v151, s98, v151
    v_xor_b32 v152, s98, v152
    v_xor_b32 v153, s98, v153
    v_or3_b32 v154, v150, v151, v152
    v_or_b32 v154, v154, v153
    v_cmp_lt_u32 vcc, 0, v154
    s_cbranch_scc1 L_xid_ok
    s_sleep 32
    s_cbranch_vccnz L_xid_spin
    s_branch L_xid_ok
L_mid_retry:
    s_mov_b32 s39, 0x40000
    s_mov_b32 s53, 28385280
L_mid_spin:
    buffer_load_dwordx4 v[150:153], v155, s[24:27], s53 offen sc1
    s_sub_u32 s39, s39, 1
    s_waitcnt vmcnt(0)
    v_xor_b32 v150, s98, v150
    v_xor_b32 v151, s98, v151
    v_xor_b32 v152, s98, v152
    v_xor_b32 v153, s98, v153
    v_or3_b32 v154, v150, v151, v152
    v_or_b32 v154, v154, v153
    v_cmp_lt_u32 vcc, 15, v154
    s_cbranch_scc1 L_mid_ok
    s_sleep 32
    s_cbranch_vccnz L_mid_spin
    s_branch L_mid_ok
L_p4a_spin:
    s_mov_b32 s39, 0x40000
L_p4a_spin2:
    buffer_load_dword v157, v158, s[24:27], s50 offen offset:0 sc1
    s_sub_u32 s39, s39, 1
    s_waitcnt vmcnt(0)
    v_cmp_ne_u32 vcc, s98, v157
    s_cbranch_scc1 L_p4a_ok
    s_nop 1
    s_cbranch_vccnz L_p4a_spin2
    s_branch L_p4a_ok
L_p4b_spin:
    s_mov_b32 s39, 0x40000
L_p4b_spin2:
    buffer_load_dword v157, v158, s[24:27], s50 offen offset:128 sc1
    s_sub_u32 s39, s39, 1
    s_waitcnt vmcnt(0)
    v_cmp_ne_u32 vcc, s98, v157
    s_cbranch_scc1 L_p4b_ok
    s_nop 1
    s_cbranch_vccnz L_p4b_spin2
    s_branch L_p4b_ok
L_end_adaLN_cond__mha_block__dense_activation_relu__prompt_kernel:
    s_endpgm
    .fill (65536 + L_pc_here - .) / 4 + 64, 4, 0xbf810000
.section .rodata,"a"
.p2align 6
.amdhsa_kernel adaLN_cond__mha_block__dense_activation_relu__prompt_kernel
  .amdhsa_next_free_vgpr 512
  .amdhsa_next_free_sgpr 102
  .amdhsa_accum_offset 256
  .amdhsa_group_segment_fixed_size 0
  .amdhsa_kernarg_size 88
  .amdhsa_user_sgpr_count 2
  .amdhsa_user_sgpr_kernarg_segment_ptr 1
  .amdhsa_system_sgpr_workgroup_id_x 1
.end_amdhsa_kernel
```
